```python
import torch

def _softmax(x, axis=-1):
    return torch.softmax(x, dim=axis)
def _gelu(x):
    return torch.nn.functional.gelu(x, approximate="tanh")
def _silu(x):
    return torch.nn.functional.silu(x)
def _sigmoid(x):
    return torch.sigmoid(x)
def _layernorm(x, axis=-1, eps=1e-5):
    m = x.mean(dim=axis, keepdim=True)
    v = x.var(dim=axis, keepdim=True, unbiased=False)
    return (x - m) / torch.sqrt(v + eps)
def _scatter_add(tgt, idx, src, axis=0):
    return tgt.clone().index_add_(axis, idx, src)
def _segment_sum(src, seg, n):
    out = torch.zeros((n,) + src.shape[1:], dtype=src.dtype)
    return out.index_add_(0, seg, src)
def _pad(x, pw):
    flat = tuple(v for pair in reversed(pw) for v in pair)
    return torch.nn.functional.pad(x, flat)

kernel_name = 'sequential_preLN__linear_attn_block__glu_gated_bilinear__prompt'

def setup_inputs():

    _w = (lambda a: (lambda t: t.to(torch.bfloat16) if t.is_floating_point() else t)(torch.as_tensor(a)))
    def _A_setup():
        B, S, D = 1, 2048, 576
        return {
            "x": _w((lambda *s: torch.randn(*s, dtype=torch.bfloat16) * 0.05)(B, S, D)),
            "wqkv": _w((lambda *s: torch.randn(*s, dtype=torch.bfloat16) * 0.05)(D, 3 * D)),
            "wo": _w((lambda *s: torch.randn(*s, dtype=torch.bfloat16) * 0.05)(D, D)),
        }
    _A_in = _A_setup()

    def _B_setup():
        B, S, D, F = 1, 2048, 576, 4608
        return {
            "x": _w((lambda *s: torch.randn(*s, dtype=torch.bfloat16) * 0.05)(B, S, D)),
            "w_gate": _w((lambda *s: torch.randn(*s, dtype=torch.bfloat16) * 0.4)(D, F) * (D ** -0.5)),
            "w_up": _w((lambda *s: torch.randn(*s, dtype=torch.bfloat16) * 0.4)(D, F) * (D ** -0.5)),
            "w_down": _w((lambda *s: torch.randn(*s, dtype=torch.bfloat16) * 0.4)(F, D) * (F ** -0.5)),
        }
    _B_in = _B_setup()

    return {
        "A_x": _A_in["x"],
        "A_wqkv": _A_in["wqkv"],
        "A_wo": _A_in["wo"],
        "B_x": _B_in["x"],
        "B_w_gate": _B_in["w_gate"],
        "B_w_up": _B_in["w_up"],
        "B_w_down": _B_in["w_down"],
    }

def reference(A_x, A_wqkv, A_wo, B_x, B_w_gate, B_w_up, B_w_down):
    def _A_ref(x, wqkv, wo):
        B, S, D = x.shape
        H = 32; Dh = D // H
        qkv = (lambda x, *d: x.permute(*d))((x @ wqkv).reshape(B, S, 3, H, Dh), 2, 0, 3, 1, 4)
        q, k, v = qkv[0], qkv[1], qkv[2]
        phi = lambda t: torch.where(t > 0, t + 1, torch.exp(t)) + 1e-6
        pq, pk = phi(q), phi(k)
        kv = torch.einsum("bhsd,bhse->bhde", pk, v)
        z = torch.einsum("bhsd->bhd", pk)
        num = torch.einsum("bhqd,bhde->bhqe", pq, kv)
        den = torch.einsum("bhqd,bhd->bhq", pq, z)[..., None] + 1e-6
        o = num / den
        return (lambda x, *d: x.permute(*d))(o, 0, 2, 1, 3).reshape(B, S, D) @ wo

    def _B_ref(x, w_gate, w_up, w_down):
        g = torch.einsum("bsd,df->bsf", x, w_gate)
        u = torch.einsum("bsd,df->bsf", x, w_up)
        h = g * u
        return torch.einsum("bsf,fd->bsd", h, w_down)

    x = A_x
    h = x + _A_ref(_layernorm(x, axis=-1), A_wqkv, A_wo)
    h2 = h + _B_ref(_layernorm(h, axis=-1), B_w_gate, B_w_up, B_w_down)
    return h2
```

```asm
; @launch grid=(256,1,1) block=(256,1,1) lds=163840
.amdgcn_target "amdgcn-amd-amdhsa--gfx950"
.text
.globl sequential_preLN__linear_attn_block__glu_gated_bilinear__prompt_kernel
.p2align 8
.type sequential_preLN__linear_attn_block__glu_gated_bilinear__prompt_kernel,@function
sequential_preLN__linear_attn_block__glu_gated_bilinear__prompt_kernel:
  s_cmp_ge_u32 s2, 256
  s_cbranch_scc1 MK_end
  s_load_dwordx4 s[16:19], s[0:1], 0
  s_load_dwordx2 s[24:25], s[0:1], 16
  s_load_dwordx4 s[20:23], s[0:1], 64
  s_load_dwordx4 s[84:87], s[0:1], 32
  s_load_dwordx2 s[82:83], s[0:1], 48
  s_memrealtime s[100:101]
  v_accvgpr_write_b32 a174, v0
  s_getpc_b64 s[74:75]
K1_pc:
  s_lshr_b32 s76, s2, 3
  s_and_b32 s76, s76, 31
  s_mul_i32 s76, s76, ((MK_end-K1_pc)/128+32)/32
  v_min_u32 v248, ((MK_end-K1_pc)/128+32)/32-1, v0
  v_add_u32 v248, s76, v248
  v_min_u32 v248, (MK_end-K1_pc)/128-1, v248
  v_lshlrev_b32 v248, 7, v248
  global_load_dword a41, v248, s[74:75]
  v_lshrrev_b32 v196, 6, v0
  v_and_b32 v218, 63, v0
  v_lshlrev_b32 v221, 4, v0
  v_readfirstlane_b32 s32, v196
  s_and_b32 s3, s2, 1
  s_lshl_b32 s3, s3, 3
  s_lshr_b32 s4, s2, 5
  s_add_u32 s33, s3, s4
  s_and_b32 s3, s2, 6
  s_lshl_b32 s3, s3, 1
  s_bfe_u32 s4, s2, 0x20003
  s_add_u32 s34, s3, s4
  v_and_b32 v219, 15, v218
  v_lshrrev_b32 v220, 4, v218
  s_movk_i32 s3, 1152
  v_xor_b32 v196, v219, v220
  v_lshlrev_b32 v196, 4, v196
  v_mul_u32_u24 v197, s3, v220
  v_add_u32 v184, v197, v196
  v_xor_b32 v198, 64, v196
  v_add_u32 v185, v197, v198
  v_xor_b32 v198, 128, v196
  v_add_u32 v186, v197, v198
  v_xor_b32 v198, 192, v196
  v_add_u32 v187, v197, v198
  s_lshl_b32 s4, s34, 2
  s_add_u32 s37, s4, s32
  s_mul_i32 s36, s37, 36864
  s_lshl_b32 s46, s32, 14
  s_add_u32 s46, s46, 92160
  s_mov_b32 s10, 1990656
  s_mov_b32 s11, 0x20000
  s_waitcnt lgkmcnt(0)
  s_mov_b32 s8, s18
  s_mov_b32 s9, s19
  s_mov_b32 s18, 2359296
  s_mov_b32 s19, 0x20000
  s_add_u32 m0, s46, 0
  s_add_u32 s5, s36, 0
  buffer_load_dwordx4 v184, s[16:19], s5 offen lds
  s_add_u32 m0, s46, 1024
  s_add_u32 s5, s36, 4608
  buffer_load_dwordx4 v185, s[16:19], s5 offen lds
  s_add_u32 m0, s46, 2048
  s_add_u32 s5, s36, 9216
  buffer_load_dwordx4 v186, s[16:19], s5 offen lds
  s_add_u32 m0, s46, 3072
  s_add_u32 s5, s36, 13824
  buffer_load_dwordx4 v187, s[16:19], s5 offen lds
  s_add_u32 m0, s46, 4096
  s_add_u32 s5, s36, 18432
  buffer_load_dwordx4 v184, s[16:19], s5 offen lds
  s_add_u32 m0, s46, 5120
  s_add_u32 s5, s36, 23040
  buffer_load_dwordx4 v185, s[16:19], s5 offen lds
  s_add_u32 m0, s46, 6144
  s_add_u32 s5, s36, 27648
  buffer_load_dwordx4 v186, s[16:19], s5 offen lds
  s_add_u32 m0, s46, 7168
  s_add_u32 s5, s36, 32256
  buffer_load_dwordx4 v187, s[16:19], s5 offen lds
  s_movk_i32 s6, 3456
  v_add_u32 v200, 0, v218
  v_mul_u32_u24 v201, 205, v200
  v_lshrrev_b32 v201, 11, v201
  v_mul_u32_u24 v203, 10, v201
  v_sub_u32 v203, v200, v203
  v_and_b32 v202, 3, v201
  v_bfe_u32 v200, v201, 2, 2
  v_lshl_add_u32 v202, v200, 3, v202
  v_lshrrev_b32 v200, 4, v201
  v_lshl_add_u32 v202, v200, 2, v202
  v_min_u32 v200, 8, v203
  v_lshlrev_b32 v200, 4, v200
  v_mad_u32_u24 v200, v201, s3, v200
  v_accvgpr_write_b32 a104, v200
  v_add_u32 v200, 3, v203
  v_lshrrev_b32 v200, 3, v200
  v_mul_u32_u24 v200, 1072, v200
  v_lshl_add_u32 v203, v203, 4, v200
  v_add_u32 v203, 1152, v203
  v_mad_u32_u24 v208, v202, s6, v203
  v_add_u32 v200, 64, v218
  v_mul_u32_u24 v201, 205, v200
  v_lshrrev_b32 v201, 11, v201
  v_mul_u32_u24 v203, 10, v201
  v_sub_u32 v203, v200, v203
  v_and_b32 v202, 3, v201
  v_bfe_u32 v200, v201, 2, 2
  v_lshl_add_u32 v202, v200, 3, v202
  v_lshrrev_b32 v200, 4, v201
  v_lshl_add_u32 v202, v200, 2, v202
  v_min_u32 v200, 8, v203
  v_lshlrev_b32 v200, 4, v200
  v_mad_u32_u24 v200, v201, s3, v200
  v_accvgpr_write_b32 a105, v200
  v_add_u32 v200, 3, v203
  v_lshrrev_b32 v200, 3, v200
  v_mul_u32_u24 v200, 1072, v200
  v_lshl_add_u32 v203, v203, 4, v200
  v_add_u32 v203, 1152, v203
  v_mad_u32_u24 v209, v202, s6, v203
  v_add_u32 v200, 128, v218
  v_mul_u32_u24 v201, 205, v200
  v_lshrrev_b32 v201, 11, v201
  v_mul_u32_u24 v203, 10, v201
  v_sub_u32 v203, v200, v203
  v_and_b32 v202, 3, v201
  v_bfe_u32 v200, v201, 2, 2
  v_lshl_add_u32 v202, v200, 3, v202
  v_lshrrev_b32 v200, 4, v201
  v_lshl_add_u32 v202, v200, 2, v202
  v_min_u32 v200, 8, v203
  v_lshlrev_b32 v200, 4, v200
  v_mad_u32_u24 v200, v201, s3, v200
  v_accvgpr_write_b32 a106, v200
  v_add_u32 v200, 3, v203
  v_lshrrev_b32 v200, 3, v200
  v_mul_u32_u24 v200, 1072, v200
  v_lshl_add_u32 v203, v203, 4, v200
  v_add_u32 v203, 1152, v203
  v_mad_u32_u24 v210, v202, s6, v203
  v_add_u32 v200, 192, v218
  v_mul_u32_u24 v201, 205, v200
  v_lshrrev_b32 v201, 11, v201
  v_mul_u32_u24 v203, 10, v201
  v_sub_u32 v203, v200, v203
  v_and_b32 v202, 3, v201
  v_bfe_u32 v200, v201, 2, 2
  v_lshl_add_u32 v202, v200, 3, v202
  v_lshrrev_b32 v200, 4, v201
  v_lshl_add_u32 v202, v200, 2, v202
  v_min_u32 v200, 8, v203
  v_lshlrev_b32 v200, 4, v200
  v_mad_u32_u24 v200, v201, s3, v200
  v_accvgpr_write_b32 a107, v200
  v_add_u32 v200, 3, v203
  v_lshrrev_b32 v200, 3, v200
  v_mul_u32_u24 v200, 1072, v200
  v_lshl_add_u32 v203, v203, 4, v200
  v_add_u32 v203, 1152, v203
  v_mad_u32_u24 v211, v202, s6, v203
  v_add_u32 v200, 256, v218
  v_mul_u32_u24 v201, 205, v200
  v_lshrrev_b32 v201, 11, v201
  v_mul_u32_u24 v203, 10, v201
  v_sub_u32 v203, v200, v203
  v_and_b32 v202, 3, v201
  v_bfe_u32 v200, v201, 2, 2
  v_lshl_add_u32 v202, v200, 3, v202
  v_lshrrev_b32 v200, 4, v201
  v_lshl_add_u32 v202, v200, 2, v202
  v_min_u32 v200, 8, v203
  v_lshlrev_b32 v200, 4, v200
  v_mad_u32_u24 v200, v201, s3, v200
  v_accvgpr_write_b32 a108, v200
  v_add_u32 v200, 3, v203
  v_lshrrev_b32 v200, 3, v200
  v_mul_u32_u24 v200, 1072, v200
  v_lshl_add_u32 v203, v203, 4, v200
  v_add_u32 v203, 1152, v203
  v_mad_u32_u24 v212, v202, s6, v203
  s_mul_i32 s7, s32, 110592
  s_mul_i32 s5, s33, 72
  s_and_b32 s5, s5, -16
  s_add_u32 s35, s5, s7
  s_mul_i32 s47, s32, 5120
  s_add_u32 m0, s47, 0
  s_add_u32 s7, s35, 0
  buffer_load_dwordx4 v208, s[8:11], s7 offen lds
  s_add_u32 m0, s47, 1024
  s_nop 0
  buffer_load_dwordx4 v209, s[8:11], s7 offen lds
  s_add_u32 m0, s47, 2048
  s_nop 0
  buffer_load_dwordx4 v210, s[8:11], s7 offen lds
  s_add_u32 m0, s47, 3072
  s_nop 0
  buffer_load_dwordx4 v211, s[8:11], s7 offen lds
  s_add_u32 m0, s47, 4096
  s_nop 0
  buffer_load_dwordx4 v212, s[8:11], s7 offen lds
  s_add_u32 m0, s46, 8192
  s_add_u32 s5, s36, 256
  buffer_load_dwordx4 v184, s[16:19], s5 offen lds
  s_add_u32 m0, s46, 9216
  s_add_u32 s5, s36, 4864
  buffer_load_dwordx4 v185, s[16:19], s5 offen lds
  s_add_u32 m0, s46, 10240
  s_add_u32 s5, s36, 9472
  buffer_load_dwordx4 v186, s[16:19], s5 offen lds
  s_add_u32 m0, s46, 11264
  s_add_u32 s5, s36, 14080
  buffer_load_dwordx4 v187, s[16:19], s5 offen lds
  s_add_u32 m0, s46, 12288
  s_add_u32 s5, s36, 18688
  buffer_load_dwordx4 v184, s[16:19], s5 offen lds
  s_add_u32 m0, s46, 13312
  s_add_u32 s5, s36, 23296
  buffer_load_dwordx4 v185, s[16:19], s5 offen lds
  s_add_u32 m0, s46, 14336
  s_add_u32 s5, s36, 27904
  buffer_load_dwordx4 v186, s[16:19], s5 offen lds
  s_add_u32 m0, s46, 15360
  s_add_u32 s5, s36, 32512
  buffer_load_dwordx4 v187, s[16:19], s5 offen lds
  s_add_u32 m0, s47, 20480
  s_add_u32 s7, s35, 442368
  buffer_load_dwordx4 v208, s[8:11], s7 offen lds
  s_add_u32 m0, s47, 21504
  s_nop 0
  buffer_load_dwordx4 v209, s[8:11], s7 offen lds
  s_add_u32 m0, s47, 22528
  s_nop 0
  buffer_load_dwordx4 v210, s[8:11], s7 offen lds
  s_add_u32 m0, s47, 23552
  s_nop 0
  buffer_load_dwordx4 v211, s[8:11], s7 offen lds
  s_add_u32 m0, s47, 24576
  s_nop 0
  buffer_load_dwordx4 v212, s[8:11], s7 offen lds
  v_lshrrev_b32 v197, 3, v218
  v_and_b32 v198, 7, v218
  v_lshlrev_b32 v198, 4, v198
  v_mad_u32_u24 v188, v197, s3, v198
  v_lshl_add_u32 v197, v219, 8, s46
  v_add_u32 v189, v197, v196
  v_xor_b32 v198, 64, v196
  v_add_u32 v190, v197, v198
  v_xor_b32 v198, 128, v196
  v_add_u32 v191, v197, v198
  v_xor_b32 v198, 192, v196
  v_add_u32 v192, v197, v198
  v_lshlrev_b32 v198, 4, v220
  v_lshl_add_u32 v198, v219, 7, v198
  v_add_u32 v193, s46, v198
  v_mov_b32 v244, 0x3f803f80
  v_mov_b32 v245, 0x3f803f80
  v_mov_b32 v246, 0x3f803f80
  v_mov_b32 v247, 0x3f803f80
  s_and_b32 s5, s33, 1
  s_lshl_b32 s5, s5, 3
  v_and_b32 v197, 3, v218
  v_lshl_add_u32 v197, v197, 3, s5
  v_lshrrev_b32 v198, 2, v218
  v_mul_u32_u24 v216, 160, v198
  v_add_u32 v216, v216, v197
  v_add_u32 v217, 46080, v216
  s_lshl_b32 s5, s32, 5
  v_add_u32 v240, s5, v216
  v_add_u32 v241, s5, v217
  v_mul_u32_u24 v252, 96, v198
  v_add_u32 v252, v252, v197
  v_add_u32 v252, 92160, v252
  s_mov_b32 s12, s22
  s_mov_b32 s13, s23
  s_mov_b32 s14, 268435456
  s_mov_b32 s15, 0x20000
  s_mov_b32 s22, 256
  s_mov_b32 s23, 0x20000
  s_mov_b32 s26, 663552
  s_mov_b32 s27, 0x20000
  v_min_u32 v236, 1, v218
  v_lshlrev_b32 v236, 28, v236
  s_or_b32 s100, s100, 1
  v_mov_b32 v248, s100
  s_or_b32 s5, s2, s32
  s_cmp_eq_u32 s5, 0
  s_cselect_b32 s5, 0, 268435456
  buffer_store_dword v248, v236, s[20:23], s5 offen sc1
  v_add_u32 v200, 0, v218
  v_mul_u32_u24 v201, 171, v200
  v_lshrrev_b32 v201, 10, v201
  v_mul_u32_u24 v203, 6, v201
  v_sub_u32 v203, v200, v203
  v_and_b32 v202, 3, v201
  v_bfe_u32 v200, v201, 2, 2
  v_lshl_add_u32 v202, v200, 3, v202
  v_lshrrev_b32 v200, 4, v201
  v_lshl_add_u32 v202, v200, 2, v202
  v_min_u32 v203, 4, v203
  v_lshlrev_b32 v203, 4, v203
  v_mad_u32_u24 v213, v202, s6, v203
  v_add_u32 v200, 64, v218
  v_mul_u32_u24 v201, 171, v200
  v_lshrrev_b32 v201, 10, v201
  v_mul_u32_u24 v203, 6, v201
  v_sub_u32 v203, v200, v203
  v_and_b32 v202, 3, v201
  v_bfe_u32 v200, v201, 2, 2
  v_lshl_add_u32 v202, v200, 3, v202
  v_lshrrev_b32 v200, 4, v201
  v_lshl_add_u32 v202, v200, 2, v202
  v_min_u32 v203, 4, v203
  v_lshlrev_b32 v203, 4, v203
  v_mad_u32_u24 v214, v202, s6, v203
  v_add_u32 v200, 128, v218
  v_mul_u32_u24 v201, 171, v200
  v_lshrrev_b32 v201, 10, v201
  v_mul_u32_u24 v203, 6, v201
  v_sub_u32 v203, v200, v203
  v_and_b32 v202, 3, v201
  v_bfe_u32 v200, v201, 2, 2
  v_lshl_add_u32 v202, v200, 3, v202
  v_lshrrev_b32 v200, 4, v201
  v_lshl_add_u32 v202, v200, 2, v202
  v_min_u32 v203, 4, v203
  v_lshlrev_b32 v203, 4, v203
  v_mad_u32_u24 v215, v202, s6, v203
  v_cmp_gt_u32 vcc, 36, v218
  v_lshlrev_b32 v197, 5, v218
  v_mov_b32 v198, 268435456
  v_cndmask_b32 v239, v198, v197, vcc
  s_waitcnt vmcnt(19)
  ds_read_b128 v[0:3], v189 offset:0
  ds_read_b128 v[4:7], v189 offset:4096
  ds_read_b128 v[8:11], v190 offset:0
  ds_read_b128 v[12:15], v190 offset:4096
  ds_read_b128 v[16:19], v191 offset:0
  ds_read_b128 v[20:23], v191 offset:4096
  ds_read_b128 v[24:27], v192 offset:0
  ds_read_b128 v[28:31], v192 offset:4096
  s_waitcnt lgkmcnt(0)
  s_add_u32 m0, s46, 0
  s_add_u32 s5, s36, 512
  buffer_load_dwordx4 v184, s[16:19], s5 offen lds
  s_add_u32 m0, s46, 1024
  s_add_u32 s5, s36, 5120
  buffer_load_dwordx4 v185, s[16:19], s5 offen lds
  s_add_u32 m0, s46, 2048
  s_add_u32 s5, s36, 9728
  buffer_load_dwordx4 v186, s[16:19], s5 offen lds
  s_add_u32 m0, s46, 3072
  s_add_u32 s5, s36, 14336
  buffer_load_dwordx4 v187, s[16:19], s5 offen lds
  s_add_u32 m0, s46, 4096
  s_add_u32 s5, s36, 18944
  buffer_load_dwordx4 v184, s[16:19], s5 offen lds
  s_add_u32 m0, s46, 5120
  s_add_u32 s5, s36, 23552
  buffer_load_dwordx4 v185, s[16:19], s5 offen lds
  s_add_u32 m0, s46, 6144
  s_add_u32 s5, s36, 28160
  buffer_load_dwordx4 v186, s[16:19], s5 offen lds
  s_add_u32 m0, s46, 7168
  s_add_u32 s5, s36, 32768
  buffer_load_dwordx4 v187, s[16:19], s5 offen lds
  v_mfma_f32_16x16x32_bf16 a[56:59], v[244:247], v[0:3], 0
  v_mfma_f32_16x16x32_bf16 a[64:67], v[0:3], v[0:3], 0
  v_mfma_f32_16x16x32_bf16 a[60:63], v[244:247], v[4:7], 0
  v_mfma_f32_16x16x32_bf16 a[68:71], v[4:7], v[4:7], 0
  v_mfma_f32_16x16x32_bf16 a[56:59], v[244:247], v[8:11], a[56:59]
  v_mfma_f32_16x16x32_bf16 a[64:67], v[8:11], v[8:11], a[64:67]
  v_mfma_f32_16x16x32_bf16 a[60:63], v[244:247], v[12:15], a[60:63]
  v_mfma_f32_16x16x32_bf16 a[68:71], v[12:15], v[12:15], a[68:71]
  v_mfma_f32_16x16x32_bf16 a[56:59], v[244:247], v[16:19], a[56:59]
  v_mfma_f32_16x16x32_bf16 a[64:67], v[16:19], v[16:19], a[64:67]
  v_mfma_f32_16x16x32_bf16 a[60:63], v[244:247], v[20:23], a[60:63]
  v_mfma_f32_16x16x32_bf16 a[68:71], v[20:23], v[20:23], a[68:71]
  v_mfma_f32_16x16x32_bf16 a[56:59], v[244:247], v[24:27], a[56:59]
  v_mfma_f32_16x16x32_bf16 a[64:67], v[24:27], v[24:27], a[64:67]
  v_mfma_f32_16x16x32_bf16 a[60:63], v[244:247], v[28:31], a[60:63]
  v_mfma_f32_16x16x32_bf16 a[68:71], v[28:31], v[28:31], a[68:71]
  s_waitcnt vmcnt(22)
  s_barrier
  ds_read_b64_tr_b16 a[0:1], v216 offset:0
  ds_read_b64_tr_b16 a[2:3], v216 offset:2560
  ds_read_b64_tr_b16 a[4:5], v216 offset:32
  ds_read_b64_tr_b16 a[6:7], v216 offset:2592
  ds_read_b64_tr_b16 a[8:9], v216 offset:64
  ds_read_b64_tr_b16 a[10:11], v216 offset:2624
  ds_read_b64_tr_b16 a[12:13], v216 offset:96
  ds_read_b64_tr_b16 a[14:15], v216 offset:2656
  ds_read_b64_tr_b16 a[16:17], v216 offset:128
  ds_read_b64_tr_b16 a[18:19], v216 offset:2688
  s_waitcnt lgkmcnt(8)
  v_mfma_f32_16x16x32_bf16 v[144:147], v[0:3], a[0:3], 0
  ds_read_b64_tr_b16 a[20:21], v240 offset:0
  ds_read_b64_tr_b16 a[22:23], v240 offset:2560
  v_mfma_f32_16x16x32_bf16 v[148:151], v[4:7], a[0:3], 0
  s_waitcnt lgkmcnt(8)
  s_add_u32 m0, s47, 40960
  s_add_u32 s7, s35, 884736
  buffer_load_dwordx4 v208, s[8:11], s7 offen lds
  v_mfma_f32_16x16x32_bf16 v[152:155], v[0:3], a[4:7], 0
  ds_read_b64_tr_b16 a[0:1], v216 offset:5120
  ds_read_b64_tr_b16 a[2:3], v216 offset:7680
  v_mfma_f32_16x16x32_bf16 v[156:159], v[4:7], a[4:7], 0
  s_waitcnt lgkmcnt(8)
  s_waitcnt vmcnt(15)
  ds_read_b128 v[32:35], v189 offset:8192
  v_mfma_f32_16x16x32_bf16 v[160:163], v[0:3], a[8:11], 0
  ds_read_b64_tr_b16 a[4:5], v216 offset:5152
  ds_read_b64_tr_b16 a[6:7], v216 offset:7712
  v_mfma_f32_16x16x32_bf16 v[164:167], v[4:7], a[8:11], 0
  s_waitcnt lgkmcnt(9)
  ds_read_b128 v[36:39], v189 offset:12288
  s_add_u32 m0, s47, 41984
  s_nop 0
  buffer_load_dwordx4 v209, s[8:11], s7 offen lds
  v_mfma_f32_16x16x32_bf16 v[168:171], v[0:3], a[12:15], 0
  ds_read_b64_tr_b16 a[8:9], v216 offset:5184
  ds_read_b64_tr_b16 a[10:11], v216 offset:7744
  v_mfma_f32_16x16x32_bf16 v[172:175], v[4:7], a[12:15], 0
  s_waitcnt lgkmcnt(10)
  ds_read_b128 v[40:43], v190 offset:8192
  v_mfma_f32_16x16x32_bf16 v[176:179], v[0:3], a[16:19], 0
  ds_read_b64_tr_b16 a[12:13], v216 offset:5216
  ds_read_b64_tr_b16 a[14:15], v216 offset:7776
  v_mfma_f32_16x16x32_bf16 v[180:183], v[4:7], a[16:19], 0
  v_mfma_f32_16x16x32_bf16 a[52:55], v[244:247], a[16:19], 0
  s_waitcnt lgkmcnt(11)
  ds_read_b128 v[44:47], v190 offset:12288
  s_add_u32 m0, s47, 43008
  s_nop 0
  buffer_load_dwordx4 v210, s[8:11], s7 offen lds
  v_mfma_f32_16x16x32_bf16 a[48:51], a[20:23], v[244:247], 0
  ds_read_b64_tr_b16 a[16:17], v216 offset:5248
  ds_read_b64_tr_b16 a[18:19], v216 offset:7808
  s_waitcnt lgkmcnt(12)
  ds_read_b128 v[48:51], v191 offset:8192
  v_mfma_f32_16x16x32_bf16 v[144:147], v[8:11], a[0:3], v[144:147]
  ds_read_b64_tr_b16 a[20:21], v240 offset:5120
  ds_read_b64_tr_b16 a[22:23], v240 offset:7680
  v_mfma_f32_16x16x32_bf16 v[148:151], v[12:15], a[0:3], v[148:151]
  s_waitcnt lgkmcnt(12)
  ds_read_b128 v[52:55], v191 offset:12288
  s_add_u32 m0, s47, 44032
  s_nop 0
  buffer_load_dwordx4 v211, s[8:11], s7 offen lds
  v_mfma_f32_16x16x32_bf16 v[152:155], v[8:11], a[4:7], v[152:155]
  ds_read_b64_tr_b16 a[0:1], v216 offset:10240
  ds_read_b64_tr_b16 a[2:3], v216 offset:12800
  v_mfma_f32_16x16x32_bf16 v[156:159], v[12:15], a[4:7], v[156:159]
  s_waitcnt lgkmcnt(12)
  ds_read_b128 v[56:59], v192 offset:8192
  v_mfma_f32_16x16x32_bf16 v[160:163], v[8:11], a[8:11], v[160:163]
  ds_read_b64_tr_b16 a[4:5], v216 offset:10272
  ds_read_b64_tr_b16 a[6:7], v216 offset:12832
  v_mfma_f32_16x16x32_bf16 v[164:167], v[12:15], a[8:11], v[164:167]
  s_waitcnt lgkmcnt(12)
  ds_read_b128 v[60:63], v192 offset:12288
  s_add_u32 m0, s47, 45056
  s_nop 0
  buffer_load_dwordx4 v212, s[8:11], s7 offen lds
  v_mfma_f32_16x16x32_bf16 v[168:171], v[8:11], a[12:15], v[168:171]
  ds_read_b64_tr_b16 a[8:9], v216 offset:10304
  ds_read_b64_tr_b16 a[10:11], v216 offset:12864
  v_mfma_f32_16x16x32_bf16 v[172:175], v[12:15], a[12:15], v[172:175]
  s_waitcnt lgkmcnt(12)
  v_accvgpr_write_b32 a44, 0
  v_accvgpr_write_b32 a45, 0
  v_mfma_f32_16x16x32_bf16 v[176:179], v[8:11], a[16:19], v[176:179]
  ds_read_b64_tr_b16 a[12:13], v216 offset:10336
  ds_read_b64_tr_b16 a[14:15], v216 offset:12896
  v_mfma_f32_16x16x32_bf16 v[180:183], v[12:15], a[16:19], v[180:183]
  v_mfma_f32_16x16x32_bf16 a[52:55], v[244:247], a[16:19], a[52:55]
  s_waitcnt lgkmcnt(11)
  v_accvgpr_write_b32 a46, 0
  v_accvgpr_write_b32 a47, 0
  v_mfma_f32_16x16x32_bf16 a[48:51], a[20:23], v[244:247], a[48:51]
  ds_read_b64_tr_b16 a[16:17], v216 offset:10368
  ds_read_b64_tr_b16 a[18:19], v216 offset:12928
  s_waitcnt lgkmcnt(10)
  s_lshl_b32 s5, s2, 2
  s_add_u32 s38, s5, s32
  s_mul_i32 s5, s38, 1152
  buffer_load_dwordx4 a[32:35], v239, s[24:27], s5 offen
  v_mfma_f32_16x16x32_bf16 v[144:147], v[16:19], a[0:3], v[144:147]
  ds_read_b64_tr_b16 a[20:21], v240 offset:10240
  ds_read_b64_tr_b16 a[22:23], v240 offset:12800
  v_mfma_f32_16x16x32_bf16 v[148:151], v[20:23], a[0:3], v[148:151]
  s_waitcnt lgkmcnt(9)
  buffer_load_dwordx4 a[36:39], v239, s[24:27], s5 offen offset:16
  v_mfma_f32_16x16x32_bf16 v[152:155], v[16:19], a[4:7], v[152:155]
  ds_read_b64_tr_b16 a[0:1], v216 offset:15360
  ds_read_b64_tr_b16 a[2:3], v216 offset:17920
  v_mfma_f32_16x16x32_bf16 v[156:159], v[20:23], a[4:7], v[156:159]
  s_waitcnt lgkmcnt(8)
  v_min_u32 v202, 1, v220
  v_lshlrev_b32 v202, 28, v202
  v_mfma_f32_16x16x32_bf16 v[160:163], v[16:19], a[8:11], v[160:163]
  ds_read_b64_tr_b16 a[4:5], v216 offset:15392
  ds_read_b64_tr_b16 a[6:7], v216 offset:17952
  v_mfma_f32_16x16x32_bf16 v[164:167], v[20:23], a[8:11], v[164:167]
  s_waitcnt lgkmcnt(8)
  v_lshl_add_u32 v238, v219, 2, v202
  s_lshl_b32 s43, s32, 8
  v_mfma_f32_16x16x32_bf16 v[168:171], v[16:19], a[12:15], v[168:171]
  ds_read_b64_tr_b16 a[8:9], v216 offset:15424
  ds_read_b64_tr_b16 a[10:11], v216 offset:17984
  v_mfma_f32_16x16x32_bf16 v[172:175], v[20:23], a[12:15], v[172:175]
  v_mfma_f32_16x16x32_bf16 a[56:59], v[244:247], v[32:35], a[56:59]
  v_mfma_f32_16x16x32_bf16 a[64:67], v[32:35], v[32:35], a[64:67]
  s_waitcnt lgkmcnt(8)
  s_add_u32 m0, s46, 8192
  s_add_u32 s5, s36, 768
  buffer_load_dwordx4 v184, s[16:19], s5 offen lds
  v_mfma_f32_16x16x32_bf16 v[176:179], v[16:19], a[16:19], v[176:179]
  ds_read_b64_tr_b16 a[12:13], v216 offset:15456
  ds_read_b64_tr_b16 a[14:15], v216 offset:18016
  v_mfma_f32_16x16x32_bf16 v[180:183], v[20:23], a[16:19], v[180:183]
  v_mfma_f32_16x16x32_bf16 a[52:55], v[244:247], a[16:19], a[52:55]
  v_mfma_f32_16x16x32_bf16 a[60:63], v[244:247], v[36:39], a[60:63]
  v_mfma_f32_16x16x32_bf16 a[68:71], v[36:39], v[36:39], a[68:71]
  s_waitcnt lgkmcnt(8)
  s_add_u32 m0, s46, 9216
  s_add_u32 s5, s36, 5376
  buffer_load_dwordx4 v185, s[16:19], s5 offen lds
  v_mfma_f32_16x16x32_bf16 a[48:51], a[20:23], v[244:247], a[48:51]
  ds_read_b64_tr_b16 a[16:17], v216 offset:15488
  ds_read_b64_tr_b16 a[18:19], v216 offset:18048
  v_mfma_f32_16x16x32_bf16 a[56:59], v[244:247], v[40:43], a[56:59]
  v_mfma_f32_16x16x32_bf16 a[64:67], v[40:43], v[40:43], a[64:67]
  s_waitcnt lgkmcnt(8)
  s_add_u32 m0, s46, 10240
  s_add_u32 s5, s36, 9984
  buffer_load_dwordx4 v186, s[16:19], s5 offen lds
  v_mfma_f32_16x16x32_bf16 v[144:147], v[24:27], a[0:3], v[144:147]
  ds_read_b64_tr_b16 a[20:21], v240 offset:15360
  ds_read_b64_tr_b16 a[22:23], v240 offset:17920
  v_mfma_f32_16x16x32_bf16 v[148:151], v[28:31], a[0:3], v[148:151]
  s_waitcnt vmcnt(19) lgkmcnt(8)
  s_barrier
  s_add_u32 m0, s46, 11264
  s_add_u32 s5, s36, 14592
  buffer_load_dwordx4 v187, s[16:19], s5 offen lds
  v_mfma_f32_16x16x32_bf16 v[152:155], v[24:27], a[4:7], v[152:155]
  ds_read_b64_tr_b16 a[0:1], v216 offset:20480
  ds_read_b64_tr_b16 a[2:3], v216 offset:23040
  v_mfma_f32_16x16x32_bf16 v[156:159], v[28:31], a[4:7], v[156:159]
  s_waitcnt lgkmcnt(8)
  s_add_u32 m0, s46, 12288
  s_add_u32 s5, s36, 19200
  buffer_load_dwordx4 v184, s[16:19], s5 offen lds
  v_mfma_f32_16x16x32_bf16 v[160:163], v[24:27], a[8:11], v[160:163]
  ds_read_b64_tr_b16 a[4:5], v216 offset:20512
  ds_read_b64_tr_b16 a[6:7], v216 offset:23072
  v_mfma_f32_16x16x32_bf16 v[164:167], v[28:31], a[8:11], v[164:167]
  s_waitcnt lgkmcnt(8)
  s_add_u32 m0, s46, 13312
  s_add_u32 s5, s36, 23808
  buffer_load_dwordx4 v185, s[16:19], s5 offen lds
  v_mfma_f32_16x16x32_bf16 v[168:171], v[24:27], a[12:15], v[168:171]
  ds_read_b64_tr_b16 a[8:9], v216 offset:20544
  ds_read_b64_tr_b16 a[10:11], v216 offset:23104
  v_mfma_f32_16x16x32_bf16 v[172:175], v[28:31], a[12:15], v[172:175]
  v_mfma_f32_16x16x32_bf16 a[60:63], v[244:247], v[44:47], a[60:63]
  v_mfma_f32_16x16x32_bf16 a[68:71], v[44:47], v[44:47], a[68:71]
  s_waitcnt lgkmcnt(8)
  s_add_u32 m0, s46, 14336
  s_add_u32 s5, s36, 28416
  buffer_load_dwordx4 v186, s[16:19], s5 offen lds
  v_mfma_f32_16x16x32_bf16 v[176:179], v[24:27], a[16:19], v[176:179]
  ds_read_b64_tr_b16 a[12:13], v216 offset:20576
  ds_read_b64_tr_b16 a[14:15], v216 offset:23136
  v_mfma_f32_16x16x32_bf16 v[180:183], v[28:31], a[16:19], v[180:183]
  v_mfma_f32_16x16x32_bf16 a[52:55], v[244:247], a[16:19], a[52:55]
  v_mfma_f32_16x16x32_bf16 a[56:59], v[244:247], v[48:51], a[56:59]
  v_mfma_f32_16x16x32_bf16 a[64:67], v[48:51], v[48:51], a[64:67]
  s_waitcnt lgkmcnt(8)
  s_add_u32 m0, s46, 15360
  s_add_u32 s5, s36, 33024
  buffer_load_dwordx4 v187, s[16:19], s5 offen lds
  v_mfma_f32_16x16x32_bf16 a[48:51], a[20:23], v[244:247], a[48:51]
  ds_read_b64_tr_b16 a[16:17], v216 offset:20608
  ds_read_b64_tr_b16 a[18:19], v216 offset:23168
  v_mfma_f32_16x16x32_bf16 a[60:63], v[244:247], v[52:55], a[60:63]
  v_mfma_f32_16x16x32_bf16 a[68:71], v[52:55], v[52:55], a[68:71]
  s_waitcnt lgkmcnt(8)
  s_add_u32 s43, s43, 157696
  v_lshl_add_u32 v242, v219, 2, s43
  v_mfma_f32_16x16x32_bf16 v[144:147], v[32:35], a[0:3], v[144:147]
  ds_read_b64_tr_b16 a[20:21], v240 offset:20480
  ds_read_b64_tr_b16 a[22:23], v240 offset:23040
  v_mfma_f32_16x16x32_bf16 v[148:151], v[36:39], a[0:3], v[148:151]
  s_waitcnt lgkmcnt(8)
  s_add_u32 m0, s47, 61440
  s_add_u32 s7, s35, 1327104
  buffer_load_dwordx4 v208, s[8:11], s7 offen lds
  v_mfma_f32_16x16x32_bf16 v[152:155], v[32:35], a[4:7], v[152:155]
  ds_read_b64_tr_b16 a[0:1], v216 offset:25600
  ds_read_b64_tr_b16 a[2:3], v216 offset:28160
  v_mfma_f32_16x16x32_bf16 v[156:159], v[36:39], a[4:7], v[156:159]
  s_waitcnt lgkmcnt(8)
  s_waitcnt vmcnt(16)
  ds_read_b128 v[64:67], v189 offset:0
  v_mfma_f32_16x16x32_bf16 v[160:163], v[32:35], a[8:11], v[160:163]
  ds_read_b64_tr_b16 a[4:5], v216 offset:25632
  ds_read_b64_tr_b16 a[6:7], v216 offset:28192
  v_mfma_f32_16x16x32_bf16 v[164:167], v[36:39], a[8:11], v[164:167]
  s_waitcnt lgkmcnt(9)
  ds_read_b128 v[68:71], v189 offset:4096
  s_add_u32 m0, s47, 62464
  s_nop 0
  buffer_load_dwordx4 v209, s[8:11], s7 offen lds
  v_mfma_f32_16x16x32_bf16 v[168:171], v[32:35], a[12:15], v[168:171]
  ds_read_b64_tr_b16 a[8:9], v216 offset:25664
  ds_read_b64_tr_b16 a[10:11], v216 offset:28224
  v_mfma_f32_16x16x32_bf16 v[172:175], v[36:39], a[12:15], v[172:175]
  v_mfma_f32_16x16x32_bf16 a[56:59], v[244:247], v[56:59], a[56:59]
  v_mfma_f32_16x16x32_bf16 a[64:67], v[56:59], v[56:59], a[64:67]
  s_waitcnt lgkmcnt(10)
  ds_read_b128 v[72:75], v190 offset:0
  v_mfma_f32_16x16x32_bf16 v[176:179], v[32:35], a[16:19], v[176:179]
  ds_read_b64_tr_b16 a[12:13], v216 offset:25696
  ds_read_b64_tr_b16 a[14:15], v216 offset:28256
  v_mfma_f32_16x16x32_bf16 v[180:183], v[36:39], a[16:19], v[180:183]
  v_mfma_f32_16x16x32_bf16 a[52:55], v[244:247], a[16:19], a[52:55]
  v_mfma_f32_16x16x32_bf16 a[60:63], v[244:247], v[60:63], a[60:63]
  v_mfma_f32_16x16x32_bf16 a[68:71], v[60:63], v[60:63], a[68:71]
  s_waitcnt lgkmcnt(11)
  ds_read_b128 v[76:79], v190 offset:4096
  s_add_u32 m0, s47, 63488
  s_nop 0
  buffer_load_dwordx4 v210, s[8:11], s7 offen lds
  v_mfma_f32_16x16x32_bf16 a[48:51], a[20:23], v[244:247], a[48:51]
  ds_read_b64_tr_b16 a[16:17], v216 offset:25728
  ds_read_b64_tr_b16 a[18:19], v216 offset:28288
  s_waitcnt lgkmcnt(12)
  ds_read_b128 v[80:83], v191 offset:0
  v_mfma_f32_16x16x32_bf16 v[144:147], v[40:43], a[0:3], v[144:147]
  ds_read_b64_tr_b16 a[20:21], v240 offset:25600
  ds_read_b64_tr_b16 a[22:23], v240 offset:28160
  v_mfma_f32_16x16x32_bf16 v[148:151], v[44:47], a[0:3], v[148:151]
  s_waitcnt lgkmcnt(12)
  ds_read_b128 v[84:87], v191 offset:4096
  s_add_u32 m0, s47, 64512
  s_nop 0
  buffer_load_dwordx4 v211, s[8:11], s7 offen lds
  v_mfma_f32_16x16x32_bf16 v[152:155], v[40:43], a[4:7], v[152:155]
  ds_read_b64_tr_b16 a[0:1], v216 offset:30720
  ds_read_b64_tr_b16 a[2:3], v216 offset:33280
  v_mfma_f32_16x16x32_bf16 v[156:159], v[44:47], a[4:7], v[156:159]
  s_waitcnt lgkmcnt(12)
  ds_read_b128 v[88:91], v192 offset:0
  v_mfma_f32_16x16x32_bf16 v[160:163], v[40:43], a[8:11], v[160:163]
  ds_read_b64_tr_b16 a[4:5], v216 offset:30752
  ds_read_b64_tr_b16 a[6:7], v216 offset:33312
  v_mfma_f32_16x16x32_bf16 v[164:167], v[44:47], a[8:11], v[164:167]
  s_waitcnt lgkmcnt(12)
  ds_read_b128 v[92:95], v192 offset:4096
  s_add_u32 m0, s47, 65536
  s_nop 0
  buffer_load_dwordx4 v212, s[8:11], s7 offen lds
  v_mfma_f32_16x16x32_bf16 v[168:171], v[40:43], a[12:15], v[168:171]
  ds_read_b64_tr_b16 a[8:9], v216 offset:30784
  ds_read_b64_tr_b16 a[10:11], v216 offset:33344
  v_mfma_f32_16x16x32_bf16 v[172:175], v[44:47], a[12:15], v[172:175]
  s_waitcnt lgkmcnt(12)
  v_lshl_add_u32 v243, v220, 4, s43
  s_lshl_b32 s43, s32, 6
  v_mfma_f32_16x16x32_bf16 v[176:179], v[40:43], a[16:19], v[176:179]
  ds_read_b64_tr_b16 a[12:13], v216 offset:30816
  ds_read_b64_tr_b16 a[14:15], v216 offset:33376
  v_mfma_f32_16x16x32_bf16 v[180:183], v[44:47], a[16:19], v[180:183]
  v_mfma_f32_16x16x32_bf16 a[52:55], v[244:247], a[16:19], a[52:55]
  s_waitcnt lgkmcnt(11)
  s_add_u32 s43, s43, 158720
  v_lshl_add_u32 v253, v220, 4, s43
  v_mfma_f32_16x16x32_bf16 a[48:51], a[20:23], v[244:247], a[48:51]
  ds_read_b64_tr_b16 a[16:17], v216 offset:30848
  ds_read_b64_tr_b16 a[18:19], v216 offset:33408
  s_waitcnt lgkmcnt(10)
  s_movk_i32 s42, 208
  s_mul_i32 s43, s32, 9984
  v_mfma_f32_16x16x32_bf16 v[144:147], v[48:51], a[0:3], v[144:147]
  ds_read_b64_tr_b16 a[20:21], v240 offset:30720
  ds_read_b64_tr_b16 a[22:23], v240 offset:33280
  v_mfma_f32_16x16x32_bf16 v[148:151], v[52:55], a[0:3], v[148:151]
  s_waitcnt lgkmcnt(9)
  v_lshlrev_b32 v196, 4, v220
  v_mad_u32_u24 v233, v219, s42, v196
  v_mfma_f32_16x16x32_bf16 v[152:155], v[48:51], a[4:7], v[152:155]
  ds_read_b64_tr_b16 a[0:1], v216 offset:35840
  ds_read_b64_tr_b16 a[2:3], v216 offset:38400
  v_mfma_f32_16x16x32_bf16 v[156:159], v[52:55], a[4:7], v[156:159]
  s_waitcnt lgkmcnt(8)
  v_add_u32 v233, s43, v233
  v_lshrrev_b32 v200, 4, v221
  v_mfma_f32_16x16x32_bf16 v[160:163], v[48:51], a[8:11], v[160:163]
  ds_read_b64_tr_b16 a[4:5], v216 offset:35872
  ds_read_b64_tr_b16 a[6:7], v216 offset:38432
  v_mfma_f32_16x16x32_bf16 v[164:167], v[52:55], a[8:11], v[164:167]
  s_waitcnt lgkmcnt(8)
  v_min_u32 v200, 189, v200
  v_mul_u32_u24 v201, 205, v200
  v_mfma_f32_16x16x32_bf16 v[168:171], v[48:51], a[12:15], v[168:171]
  ds_read_b64_tr_b16 a[8:9], v216 offset:35904
  ds_read_b64_tr_b16 a[10:11], v216 offset:38464
  v_mfma_f32_16x16x32_bf16 v[172:175], v[52:55], a[12:15], v[172:175]
  v_mfma_f32_16x16x32_bf16 a[56:59], v[244:247], v[64:67], a[56:59]
  v_mfma_f32_16x16x32_bf16 a[64:67], v[64:67], v[64:67], a[64:67]
  s_waitcnt lgkmcnt(8)
  s_add_u32 m0, s46, 0
  s_add_u32 s5, s36, 1024
  buffer_load_dwordx4 v188, s[16:19], s5 offen lds
  v_mfma_f32_16x16x32_bf16 v[176:179], v[48:51], a[16:19], v[176:179]
  ds_read_b64_tr_b16 a[12:13], v216 offset:35936
  ds_read_b64_tr_b16 a[14:15], v216 offset:38496
  v_mfma_f32_16x16x32_bf16 v[180:183], v[52:55], a[16:19], v[180:183]
  v_mfma_f32_16x16x32_bf16 a[52:55], v[244:247], a[16:19], a[52:55]
  v_mfma_f32_16x16x32_bf16 a[60:63], v[244:247], v[68:71], a[60:63]
  v_mfma_f32_16x16x32_bf16 a[68:71], v[68:71], v[68:71], a[68:71]
  s_waitcnt lgkmcnt(8)
  s_add_u32 m0, s46, 1024
  s_add_u32 s5, s36, 10240
  buffer_load_dwordx4 v188, s[16:19], s5 offen lds
  v_mfma_f32_16x16x32_bf16 a[48:51], a[20:23], v[244:247], a[48:51]
  ds_read_b64_tr_b16 a[16:17], v216 offset:35968
  ds_read_b64_tr_b16 a[18:19], v216 offset:38528
  v_mfma_f32_16x16x32_bf16 a[56:59], v[244:247], v[72:75], a[56:59]
  v_mfma_f32_16x16x32_bf16 a[64:67], v[72:75], v[72:75], a[64:67]
  s_waitcnt lgkmcnt(8)
  s_add_u32 m0, s46, 2048
  s_add_u32 s5, s36, 19456
  buffer_load_dwordx4 v188, s[16:19], s5 offen lds
  v_mfma_f32_16x16x32_bf16 v[144:147], v[56:59], a[0:3], v[144:147]
  ds_read_b64_tr_b16 a[20:21], v240 offset:35840
  ds_read_b64_tr_b16 a[22:23], v240 offset:38400
  v_mfma_f32_16x16x32_bf16 v[148:151], v[60:63], a[0:3], v[148:151]
  s_waitcnt vmcnt(18) lgkmcnt(8)
  s_barrier
  s_add_u32 m0, s46, 3072
  s_add_u32 s5, s36, 28672
  buffer_load_dwordx4 v188, s[16:19], s5 offen lds
  v_mfma_f32_16x16x32_bf16 v[152:155], v[56:59], a[4:7], v[152:155]
  ds_read_b64_tr_b16 a[0:1], v216 offset:40960
  ds_read_b64_tr_b16 a[2:3], v216 offset:43520
  v_mfma_f32_16x16x32_bf16 v[156:159], v[60:63], a[4:7], v[156:159]
  s_waitcnt lgkmcnt(8)
  v_lshrrev_b32 v201, 10, v201
  v_mul_u32_u24 v203, 5, v201
  v_mfma_f32_16x16x32_bf16 v[160:163], v[56:59], a[8:11], v[160:163]
  ds_read_b64_tr_b16 a[4:5], v216 offset:40992
  ds_read_b64_tr_b16 a[6:7], v216 offset:43552
  v_mfma_f32_16x16x32_bf16 v[164:167], v[60:63], a[8:11], v[164:167]
  s_waitcnt lgkmcnt(8)
  v_sub_u32 v203, v200, v203
  v_add_u32 v228, 13, v201
  v_mfma_f32_16x16x32_bf16 v[168:171], v[56:59], a[12:15], v[168:171]
  ds_read_b64_tr_b16 a[8:9], v216 offset:41024
  ds_read_b64_tr_b16 a[10:11], v216 offset:43584
  v_mfma_f32_16x16x32_bf16 v[172:175], v[60:63], a[12:15], v[172:175]
  v_mfma_f32_16x16x32_bf16 a[60:63], v[244:247], v[76:79], a[60:63]
  v_mfma_f32_16x16x32_bf16 a[68:71], v[76:79], v[76:79], a[68:71]
  s_waitcnt lgkmcnt(8)
  v_lshrrev_b32 v228, 5, v228
  v_mul_u32_u24 v204, 19, v228
  v_mfma_f32_16x16x32_bf16 v[176:179], v[56:59], a[16:19], v[176:179]
  ds_read_b64_tr_b16 a[12:13], v216 offset:41056
  ds_read_b64_tr_b16 a[14:15], v216 offset:43616
  v_mfma_f32_16x16x32_bf16 v[180:183], v[60:63], a[16:19], v[180:183]
  v_mfma_f32_16x16x32_bf16 a[52:55], v[244:247], a[16:19], a[52:55]
  v_mfma_f32_16x16x32_bf16 a[56:59], v[244:247], v[80:83], a[56:59]
  v_mfma_f32_16x16x32_bf16 a[64:67], v[80:83], v[80:83], a[64:67]
  s_waitcnt lgkmcnt(8)
  v_sub_u32 v204, v201, v204
  v_sub_u32 v227, v201, v228
  v_mfma_f32_16x16x32_bf16 a[48:51], a[20:23], v[244:247], a[48:51]
  ds_read_b64_tr_b16 a[16:17], v216 offset:41088
  ds_read_b64_tr_b16 a[18:19], v216 offset:43648
  v_mfma_f32_16x16x32_bf16 a[60:63], v[244:247], v[84:87], a[60:63]
  v_mfma_f32_16x16x32_bf16 a[68:71], v[84:87], v[84:87], a[68:71]
  s_waitcnt lgkmcnt(8)
  v_cmp_eq_u32 vcc, 18, v204
  v_add_u32 v206, 8, v227
  v_mfma_f32_16x16x32_bf16 v[144:147], v[64:67], a[0:3], v[144:147]
  ds_read_b64_tr_b16 a[20:21], v240 offset:40960
  ds_read_b64_tr_b16 a[22:23], v240 offset:43520
  v_mfma_f32_16x16x32_bf16 v[148:151], v[68:71], a[0:3], v[148:151]
  s_waitcnt lgkmcnt(8)
  s_cmp_lt_u32 s32, 2
  s_cbranch_scc0 K1_nok4
  s_add_u32 m0, s47, 81920
  s_add_u32 s7, s35, 1769472
  buffer_load_dwordx4 v208, s[8:11], s7 offen lds
  s_add_u32 m0, s47, 82944
  s_nop 0
  buffer_load_dwordx4 v209, s[8:11], s7 offen lds
  s_add_u32 m0, s47, 83968
  s_nop 0
  buffer_load_dwordx4 v210, s[8:11], s7 offen lds
  s_add_u32 m0, s47, 84992
  s_nop 0
  buffer_load_dwordx4 v211, s[8:11], s7 offen lds
  s_add_u32 m0, s47, 86016
  s_nop 0
  buffer_load_dwordx4 v212, s[8:11], s7 offen lds
K1_nok4:
  v_mfma_f32_16x16x32_bf16 v[152:155], v[64:67], a[4:7], v[152:155]
  ds_read_b64_tr_b16 a[0:1], v217 offset:0
  ds_read_b64_tr_b16 a[2:3], v217 offset:2560
  v_mfma_f32_16x16x32_bf16 v[156:159], v[68:71], a[4:7], v[156:159]
  s_waitcnt lgkmcnt(8)
  s_waitcnt vmcnt(9)
  ds_read_b128 v[96:99], v189 offset:8192
  v_mfma_f32_16x16x32_bf16 v[160:163], v[64:67], a[8:11], v[160:163]
  ds_read_b64_tr_b16 a[4:5], v217 offset:32
  ds_read_b64_tr_b16 a[6:7], v217 offset:2592
  v_mfma_f32_16x16x32_bf16 v[164:167], v[68:71], a[8:11], v[164:167]
  s_waitcnt lgkmcnt(9)
  ds_read_b128 v[100:103], v189 offset:12288
  v_mfma_f32_16x16x32_bf16 v[168:171], v[64:67], a[12:15], v[168:171]
  ds_read_b64_tr_b16 a[8:9], v217 offset:64
  ds_read_b64_tr_b16 a[10:11], v217 offset:2624
  v_mfma_f32_16x16x32_bf16 v[172:175], v[68:71], a[12:15], v[172:175]
  v_mfma_f32_16x16x32_bf16 a[56:59], v[244:247], v[88:91], a[56:59]
  v_mfma_f32_16x16x32_bf16 a[64:67], v[88:91], v[88:91], a[64:67]
  s_waitcnt lgkmcnt(10)
  ds_read_b128 v[104:107], v190 offset:8192
  v_mfma_f32_16x16x32_bf16 v[176:179], v[64:67], a[16:19], v[176:179]
  ds_read_b64_tr_b16 a[12:13], v217 offset:96
  ds_read_b64_tr_b16 a[14:15], v217 offset:2656
  v_mfma_f32_16x16x32_bf16 v[180:183], v[68:71], a[16:19], v[180:183]
  v_mfma_f32_16x16x32_bf16 a[52:55], v[244:247], a[16:19], a[52:55]
  v_mfma_f32_16x16x32_bf16 a[60:63], v[244:247], v[92:95], a[60:63]
  v_mfma_f32_16x16x32_bf16 a[68:71], v[92:95], v[92:95], a[68:71]
  s_waitcnt lgkmcnt(11)
  ds_read_b128 v[108:111], v190 offset:12288
  v_mfma_f32_16x16x32_bf16 a[48:51], a[20:23], v[244:247], a[48:51]
  ds_read_b64_tr_b16 a[16:17], v217 offset:128
  ds_read_b64_tr_b16 a[18:19], v217 offset:2688
  s_waitcnt lgkmcnt(12)
  ds_read_b128 v[112:115], v191 offset:8192
  v_mfma_f32_16x16x32_bf16 v[144:147], v[72:75], a[0:3], v[144:147]
  ds_read_b64_tr_b16 a[20:21], v241 offset:0
  ds_read_b64_tr_b16 a[22:23], v241 offset:2560
  v_mfma_f32_16x16x32_bf16 v[148:151], v[76:79], a[0:3], v[148:151]
  s_waitcnt lgkmcnt(12)
  ds_read_b128 v[116:119], v191 offset:12288
  v_mfma_f32_16x16x32_bf16 v[152:155], v[72:75], a[4:7], v[152:155]
  ds_read_b64_tr_b16 a[0:1], v217 offset:5120
  ds_read_b64_tr_b16 a[2:3], v217 offset:7680
  v_mfma_f32_16x16x32_bf16 v[156:159], v[76:79], a[4:7], v[156:159]
  s_waitcnt lgkmcnt(12)
  ds_read_b128 v[120:123], v192 offset:8192
  v_mfma_f32_16x16x32_bf16 v[160:163], v[72:75], a[8:11], v[160:163]
  ds_read_b64_tr_b16 a[4:5], v217 offset:5152
  ds_read_b64_tr_b16 a[6:7], v217 offset:7712
  v_mfma_f32_16x16x32_bf16 v[164:167], v[76:79], a[8:11], v[164:167]
  s_waitcnt lgkmcnt(12)
  ds_read_b128 v[124:127], v192 offset:12288
  v_mfma_f32_16x16x32_bf16 v[168:171], v[72:75], a[12:15], v[168:171]
  ds_read_b64_tr_b16 a[8:9], v217 offset:5184
  ds_read_b64_tr_b16 a[10:11], v217 offset:7744
  v_mfma_f32_16x16x32_bf16 v[172:175], v[76:79], a[12:15], v[172:175]
  s_waitcnt lgkmcnt(12)
  v_add_u32 v207, 48, v228
  v_cndmask_b32 v227, v227, v207, vcc
  v_mfma_f32_16x16x32_bf16 v[176:179], v[72:75], a[16:19], v[176:179]
  ds_read_b64_tr_b16 a[12:13], v217 offset:5216
  ds_read_b64_tr_b16 a[14:15], v217 offset:7776
  v_mfma_f32_16x16x32_bf16 v[180:183], v[76:79], a[16:19], v[180:183]
  v_mfma_f32_16x16x32_bf16 a[52:55], v[244:247], a[16:19], a[52:55]
  s_waitcnt lgkmcnt(11)
  v_mov_b32 v207, 4
  v_cndmask_b32 v206, v206, v207, vcc
  v_mfma_f32_16x16x32_bf16 a[48:51], a[20:23], v[244:247], a[48:51]
  ds_read_b64_tr_b16 a[16:17], v217 offset:5248
  ds_read_b64_tr_b16 a[18:19], v217 offset:7808
  s_waitcnt lgkmcnt(10)
  v_lshl_add_u32 v230, v228, 2, v203
  v_lshlrev_b32 v205, 4, v230
  v_mfma_f32_16x16x32_bf16 v[144:147], v[80:83], a[0:3], v[144:147]
  ds_read_b64_tr_b16 a[20:21], v241 offset:5120
  ds_read_b64_tr_b16 a[22:23], v241 offset:7680
  v_mfma_f32_16x16x32_bf16 v[148:151], v[84:87], a[0:3], v[148:151]
  s_waitcnt lgkmcnt(9)
  v_mad_u32_u24 v226, v206, s42, v205
  v_cmp_lt_u32 vcc, 3039, v221
  v_mfma_f32_16x16x32_bf16 v[152:155], v[80:83], a[4:7], v[152:155]
  ds_read_b64_tr_b16 a[0:1], v217 offset:10240
  ds_read_b64_tr_b16 a[2:3], v217 offset:12800
  v_mfma_f32_16x16x32_bf16 v[156:159], v[84:87], a[4:7], v[156:159]
  s_waitcnt lgkmcnt(8)
  v_mov_b32 v196, 268435456
  s_nop 0
  v_mfma_f32_16x16x32_bf16 v[160:163], v[80:83], a[8:11], v[160:163]
  ds_read_b64_tr_b16 a[4:5], v217 offset:10272
  ds_read_b64_tr_b16 a[6:7], v217 offset:12832
  v_mfma_f32_16x16x32_bf16 v[164:167], v[84:87], a[8:11], v[164:167]
  s_waitcnt lgkmcnt(8)
  v_cndmask_b32 v237, v221, v196, vcc
  v_mfma_f32_16x16x32_bf16 v[168:171], v[80:83], a[12:15], v[168:171]
  ds_read_b64_tr_b16 a[8:9], v217 offset:10304
  ds_read_b64_tr_b16 a[10:11], v217 offset:12864
  v_mfma_f32_16x16x32_bf16 v[172:175], v[84:87], a[12:15], v[172:175]
  v_mfma_f32_16x16x32_bf16 a[56:59], v[244:247], v[96:99], a[56:59]
  v_mfma_f32_16x16x32_bf16 a[64:67], v[96:99], v[96:99], a[64:67]
  s_waitcnt lgkmcnt(8)
  s_waitcnt vmcnt(17)
  v_accvgpr_read_b32 v196, a32
  v_mfma_f32_16x16x32_bf16 v[176:179], v[80:83], a[16:19], v[176:179]
  ds_read_b64_tr_b16 a[12:13], v217 offset:10336
  ds_read_b64_tr_b16 a[14:15], v217 offset:12896
  v_mfma_f32_16x16x32_bf16 v[180:183], v[84:87], a[16:19], v[180:183]
  v_mfma_f32_16x16x32_bf16 a[52:55], v[244:247], a[16:19], a[52:55]
  v_mfma_f32_16x16x32_bf16 a[60:63], v[244:247], v[100:103], a[60:63]
  v_mfma_f32_16x16x32_bf16 a[68:71], v[100:103], v[100:103], a[68:71]
  s_waitcnt lgkmcnt(8)
  s_lshl_b32 s5, s2, 12
  s_add_u32 s5, s5, 6422528
  s_cmp_lt_u32 s2, 4
  s_cselect_b32 s5, s5, 268435456
  buffer_store_dwordx4 a[44:47], v221, s[12:15], s5 offen sc1
  v_mfma_f32_16x16x32_bf16 a[48:51], a[20:23], v[244:247], a[48:51]
  ds_read_b64_tr_b16 a[16:17], v217 offset:10368
  ds_read_b64_tr_b16 a[18:19], v217 offset:12928
  v_mfma_f32_16x16x32_bf16 a[56:59], v[244:247], v[104:107], a[56:59]
  v_mfma_f32_16x16x32_bf16 a[64:67], v[104:107], v[104:107], a[64:67]
  s_waitcnt lgkmcnt(8)
  v_accvgpr_read_b32 v197, a33
  v_accvgpr_read_b32 v198, a34
  v_mfma_f32_16x16x32_bf16 v[144:147], v[88:91], a[0:3], v[144:147]
  ds_read_b64_tr_b16 a[20:21], v241 offset:10240
  ds_read_b64_tr_b16 a[22:23], v241 offset:12800
  v_mfma_f32_16x16x32_bf16 v[148:151], v[92:95], a[0:3], v[148:151]
  s_waitcnt vmcnt(5) lgkmcnt(8)
  s_barrier
  buffer_load_dword a42, off, s[20:23], 0 sc1
  v_mfma_f32_16x16x32_bf16 v[152:155], v[88:91], a[4:7], v[152:155]
  ds_read_b64_tr_b16 a[0:1], v217 offset:15360
  ds_read_b64_tr_b16 a[2:3], v217 offset:17920
  v_mfma_f32_16x16x32_bf16 v[156:159], v[92:95], a[4:7], v[156:159]
  s_waitcnt lgkmcnt(8)
  v_accvgpr_read_b32 v199, a35
  v_accvgpr_read_b32 v200, a36
  v_mfma_f32_16x16x32_bf16 v[160:163], v[88:91], a[8:11], v[160:163]
  ds_read_b64_tr_b16 a[4:5], v217 offset:15392
  ds_read_b64_tr_b16 a[6:7], v217 offset:17952
  v_mfma_f32_16x16x32_bf16 v[164:167], v[92:95], a[8:11], v[164:167]
  s_waitcnt lgkmcnt(8)
  v_accvgpr_read_b32 v201, a37
  v_accvgpr_read_b32 v202, a38
  v_mfma_f32_16x16x32_bf16 v[168:171], v[88:91], a[12:15], v[168:171]
  ds_read_b64_tr_b16 a[8:9], v217 offset:15424
  ds_read_b64_tr_b16 a[10:11], v217 offset:17984
  v_mfma_f32_16x16x32_bf16 v[172:175], v[92:95], a[12:15], v[172:175]
  v_mfma_f32_16x16x32_bf16 a[60:63], v[244:247], v[108:111], a[60:63]
  v_mfma_f32_16x16x32_bf16 a[68:71], v[108:111], v[108:111], a[68:71]
  s_waitcnt lgkmcnt(8)
  v_accvgpr_read_b32 v203, a39
  v_mov_b32 v204, 0
  v_mfma_f32_16x16x32_bf16 v[176:179], v[88:91], a[16:19], v[176:179]
  ds_read_b64_tr_b16 a[12:13], v217 offset:15456
  ds_read_b64_tr_b16 a[14:15], v217 offset:18016
  v_mfma_f32_16x16x32_bf16 v[180:183], v[92:95], a[16:19], v[180:183]
  v_mfma_f32_16x16x32_bf16 a[52:55], v[244:247], a[16:19], a[52:55]
  v_mfma_f32_16x16x32_bf16 a[56:59], v[244:247], v[112:115], a[56:59]
  v_mfma_f32_16x16x32_bf16 a[64:67], v[112:115], v[112:115], a[64:67]
  s_waitcnt lgkmcnt(8)
  v_dot2c_f32_bf16 v204, v196, v244
  v_dot2c_f32_bf16 v204, v197, v244
  v_mfma_f32_16x16x32_bf16 a[48:51], a[20:23], v[244:247], a[48:51]
  ds_read_b64_tr_b16 a[16:17], v217 offset:15488
  ds_read_b64_tr_b16 a[18:19], v217 offset:18048
  v_mfma_f32_16x16x32_bf16 a[60:63], v[244:247], v[116:119], a[60:63]
  v_mfma_f32_16x16x32_bf16 a[68:71], v[116:119], v[116:119], a[68:71]
  s_waitcnt lgkmcnt(8)
  v_dot2c_f32_bf16 v204, v198, v244
  v_dot2c_f32_bf16 v204, v199, v244
  v_mfma_f32_16x16x32_bf16 v[144:147], v[96:99], a[0:3], v[144:147]
  ds_read_b64_tr_b16 a[20:21], v241 offset:15360
  ds_read_b64_tr_b16 a[22:23], v241 offset:17920
  v_mfma_f32_16x16x32_bf16 v[148:151], v[100:103], a[0:3], v[148:151]
  s_waitcnt lgkmcnt(8)
  v_dot2c_f32_bf16 v204, v200, v244
  v_dot2c_f32_bf16 v204, v201, v244
  v_mfma_f32_16x16x32_bf16 v[152:155], v[96:99], a[4:7], v[152:155]
  ds_read_b64_tr_b16 a[0:1], v217 offset:20480
  ds_read_b64_tr_b16 a[2:3], v217 offset:23040
  v_mfma_f32_16x16x32_bf16 v[156:159], v[100:103], a[4:7], v[156:159]
  s_waitcnt lgkmcnt(8)
  s_waitcnt vmcnt(2)
  ds_read_b128 v[128:131], v193 offset:0
  v_mfma_f32_16x16x32_bf16 v[160:163], v[96:99], a[8:11], v[160:163]
  ds_read_b64_tr_b16 a[4:5], v217 offset:20512
  ds_read_b64_tr_b16 a[6:7], v217 offset:23072
  v_mfma_f32_16x16x32_bf16 v[164:167], v[100:103], a[8:11], v[164:167]
  s_waitcnt lgkmcnt(9)
  ds_read_b128 v[132:135], v193 offset:2048
  v_mfma_f32_16x16x32_bf16 v[168:171], v[96:99], a[12:15], v[168:171]
  ds_read_b64_tr_b16 a[8:9], v217 offset:20544
  ds_read_b64_tr_b16 a[10:11], v217 offset:23104
  v_mfma_f32_16x16x32_bf16 v[172:175], v[100:103], a[12:15], v[172:175]
  v_mfma_f32_16x16x32_bf16 a[56:59], v[244:247], v[120:123], a[56:59]
  v_mfma_f32_16x16x32_bf16 a[64:67], v[120:123], v[120:123], a[64:67]
  s_waitcnt lgkmcnt(10)
  ds_read_b128 v[136:139], v193 offset:64
  v_mfma_f32_16x16x32_bf16 v[176:179], v[96:99], a[16:19], v[176:179]
  ds_read_b64_tr_b16 a[12:13], v217 offset:20576
  ds_read_b64_tr_b16 a[14:15], v217 offset:23136
  v_mfma_f32_16x16x32_bf16 v[180:183], v[100:103], a[16:19], v[180:183]
  v_mfma_f32_16x16x32_bf16 a[52:55], v[244:247], a[16:19], a[52:55]
  v_mfma_f32_16x16x32_bf16 a[60:63], v[244:247], v[124:127], a[60:63]
  v_mfma_f32_16x16x32_bf16 a[68:71], v[124:127], v[124:127], a[68:71]
  s_waitcnt lgkmcnt(11)
  ds_read_b128 v[140:143], v193 offset:2112
  v_mfma_f32_16x16x32_bf16 a[48:51], a[20:23], v[244:247], a[48:51]
  ds_read_b64_tr_b16 a[16:17], v217 offset:20608
  ds_read_b64_tr_b16 a[18:19], v217 offset:23168
  s_waitcnt lgkmcnt(12)
  v_dot2c_f32_bf16 v204, v202, v244
  v_dot2c_f32_bf16 v204, v203, v244
  v_mfma_f32_16x16x32_bf16 v[144:147], v[104:107], a[0:3], v[144:147]
  ds_read_b64_tr_b16 a[20:21], v241 offset:20480
  ds_read_b64_tr_b16 a[22:23], v241 offset:23040
  v_mfma_f32_16x16x32_bf16 v[148:151], v[108:111], a[0:3], v[148:151]
  s_waitcnt lgkmcnt(11)
  s_nop 2
  v_add_f32 v204, v204, v204 row_ror:8
  s_nop 1
  v_mfma_f32_16x16x32_bf16 v[152:155], v[104:107], a[4:7], v[152:155]
  ds_read_b64_tr_b16 a[0:1], v217 offset:25600
  ds_read_b64_tr_b16 a[2:3], v217 offset:28160
  v_mfma_f32_16x16x32_bf16 v[156:159], v[108:111], a[4:7], v[156:159]
  s_waitcnt lgkmcnt(10)
  v_add_f32 v204, v204, v204 row_ror:4
  s_nop 1
  v_add_f32 v204, v204, v204 row_ror:2
  s_nop 1
  v_mfma_f32_16x16x32_bf16 v[160:163], v[104:107], a[8:11], v[160:163]
  ds_read_b64_tr_b16 a[4:5], v217 offset:25632
  ds_read_b64_tr_b16 a[6:7], v217 offset:28192
  v_mfma_f32_16x16x32_bf16 v[164:167], v[108:111], a[8:11], v[164:167]
  s_waitcnt lgkmcnt(9)
  v_add_f32 v204, v204, v204 row_ror:1
  s_nop 1
  v_mov_b32 v205, v204
  s_nop 1
  v_mfma_f32_16x16x32_bf16 v[168:171], v[104:107], a[12:15], v[168:171]
  ds_read_b64_tr_b16 a[8:9], v217 offset:25664
  ds_read_b64_tr_b16 a[10:11], v217 offset:28224
  v_mfma_f32_16x16x32_bf16 v[172:175], v[108:111], a[12:15], v[172:175]
  s_waitcnt lgkmcnt(8)
  v_permlane16_swap_b32 v204, v205
  v_add_f32 v204, v204, v205
  v_mfma_f32_16x16x32_bf16 v[176:179], v[104:107], a[16:19], v[176:179]
  ds_read_b64_tr_b16 a[12:13], v217 offset:25696
  ds_read_b64_tr_b16 a[14:15], v217 offset:28256
  v_mfma_f32_16x16x32_bf16 v[180:183], v[108:111], a[16:19], v[180:183]
  v_mfma_f32_16x16x32_bf16 a[52:55], v[244:247], a[16:19], a[52:55]
  s_waitcnt lgkmcnt(8)
  v_mov_b32 v205, v204
  s_nop 1
  v_permlane32_swap_b32 v204, v205
  v_mfma_f32_16x16x32_bf16 a[48:51], a[20:23], v[244:247], a[48:51]
  ds_read_b64_tr_b16 a[16:17], v217 offset:25728
  ds_read_b64_tr_b16 a[18:19], v217 offset:28288
  v_mfma_f32_16x16x32_bf16 a[56:59], v[244:247], v[128:131], a[56:59]
  v_mfma_f32_16x16x32_bf16 a[64:67], v[128:131], v[128:131], a[64:67]
  s_waitcnt lgkmcnt(8)
  s_cmp_lt_u32 s32, 2
  s_cbranch_scc0 K1_noq4
  s_add_u32 m0, s46, 12288
  s_add_u32 s7, s35, 1769472
  buffer_load_dwordx4 v213, s[8:11], s7 offen lds
  s_add_u32 m0, s46, 13312
  s_nop 0
  buffer_load_dwordx4 v214, s[8:11], s7 offen lds
  s_add_u32 m0, s46, 14336
  s_nop 0
  buffer_load_dwordx4 v215, s[8:11], s7 offen lds
K1_noq4:
  v_mfma_f32_16x16x32_bf16 v[144:147], v[112:115], a[0:3], v[144:147]
  ds_read_b64_tr_b16 a[20:21], v241 offset:25600
  ds_read_b64_tr_b16 a[22:23], v241 offset:28160
  v_mfma_f32_16x16x32_bf16 v[148:151], v[116:119], a[0:3], v[148:151]
  s_waitcnt lgkmcnt(8)
  s_add_u32 m0, s46, 0
  s_add_u32 s7, s35, 0
  buffer_load_dwordx4 v213, s[8:11], s7 offen lds
  v_mfma_f32_16x16x32_bf16 v[152:155], v[112:115], a[4:7], v[152:155]
  ds_read_b64_tr_b16 a[0:1], v217 offset:30720
  ds_read_b64_tr_b16 a[2:3], v217 offset:33280
  v_mfma_f32_16x16x32_bf16 v[156:159], v[116:119], a[4:7], v[156:159]
  s_waitcnt lgkmcnt(8)
  s_add_u32 m0, s46, 1024
  s_nop 0
  buffer_load_dwordx4 v214, s[8:11], s7 offen lds
  v_mfma_f32_16x16x32_bf16 v[160:163], v[112:115], a[8:11], v[160:163]
  ds_read_b64_tr_b16 a[4:5], v217 offset:30752
  ds_read_b64_tr_b16 a[6:7], v217 offset:33312
  v_mfma_f32_16x16x32_bf16 v[164:167], v[116:119], a[8:11], v[164:167]
  s_waitcnt lgkmcnt(8)
  s_add_u32 m0, s46, 2048
  s_nop 0
  buffer_load_dwordx4 v215, s[8:11], s7 offen lds
  v_mfma_f32_16x16x32_bf16 v[168:171], v[112:115], a[12:15], v[168:171]
  ds_read_b64_tr_b16 a[8:9], v217 offset:30784
  ds_read_b64_tr_b16 a[10:11], v217 offset:33344
  v_mfma_f32_16x16x32_bf16 v[172:175], v[116:119], a[12:15], v[172:175]
  v_mfma_f32_16x16x32_bf16 a[60:63], v[244:247], v[132:135], a[60:63]
  v_mfma_f32_16x16x32_bf16 a[68:71], v[132:135], v[132:135], a[68:71]
  s_waitcnt lgkmcnt(8)
  s_add_u32 m0, s46, 3072
  s_add_u32 s7, s35, 442368
  buffer_load_dwordx4 v213, s[8:11], s7 offen lds
  v_mfma_f32_16x16x32_bf16 v[176:179], v[112:115], a[16:19], v[176:179]
  ds_read_b64_tr_b16 a[12:13], v217 offset:30816
  ds_read_b64_tr_b16 a[14:15], v217 offset:33376
  v_mfma_f32_16x16x32_bf16 v[180:183], v[116:119], a[16:19], v[180:183]
  v_mfma_f32_16x16x32_bf16 a[52:55], v[244:247], a[16:19], a[52:55]
  v_mfma_f32_16x16x32_bf16 a[56:59], v[244:247], v[136:139], a[56:59]
  v_mfma_f32_16x16x32_bf16 a[64:67], v[136:139], v[136:139], a[64:67]
  s_waitcnt lgkmcnt(8)
  s_add_u32 m0, s46, 4096
  s_nop 0
  buffer_load_dwordx4 v214, s[8:11], s7 offen lds
  v_mfma_f32_16x16x32_bf16 a[48:51], a[20:23], v[244:247], a[48:51]
  ds_read_b64_tr_b16 a[16:17], v217 offset:30848
  ds_read_b64_tr_b16 a[18:19], v217 offset:33408
  v_mfma_f32_16x16x32_bf16 a[60:63], v[244:247], v[140:143], a[60:63]
  v_mfma_f32_16x16x32_bf16 a[68:71], v[140:143], v[140:143], a[68:71]
  s_waitcnt lgkmcnt(8)
  s_add_u32 m0, s46, 5120
  s_nop 0
  buffer_load_dwordx4 v215, s[8:11], s7 offen lds
  v_mfma_f32_16x16x32_bf16 v[144:147], v[120:123], a[0:3], v[144:147]
  ds_read_b64_tr_b16 a[20:21], v241 offset:30720
  ds_read_b64_tr_b16 a[22:23], v241 offset:33280
  v_mfma_f32_16x16x32_bf16 v[148:151], v[124:127], a[0:3], v[148:151]
  s_waitcnt vmcnt(8)
  s_waitcnt lgkmcnt(8)
  s_barrier
  s_add_u32 m0, s46, 6144
  s_add_u32 s7, s35, 884736
  buffer_load_dwordx4 v213, s[8:11], s7 offen lds
  v_mfma_f32_16x16x32_bf16 v[152:155], v[120:123], a[4:7], v[152:155]
  ds_read_b64_tr_b16 a[0:1], v217 offset:35840
  ds_read_b64_tr_b16 a[2:3], v217 offset:38400
  v_mfma_f32_16x16x32_bf16 v[156:159], v[124:127], a[4:7], v[156:159]
  s_waitcnt lgkmcnt(8)
  s_add_u32 m0, s46, 7168
  s_nop 0
  buffer_load_dwordx4 v214, s[8:11], s7 offen lds
  v_mfma_f32_16x16x32_bf16 v[160:163], v[120:123], a[8:11], v[160:163]
  ds_read_b64_tr_b16 a[4:5], v217 offset:35872
  ds_read_b64_tr_b16 a[6:7], v217 offset:38432
  v_mfma_f32_16x16x32_bf16 v[164:167], v[124:127], a[8:11], v[164:167]
  s_waitcnt lgkmcnt(8)
  s_add_u32 m0, s46, 8192
  s_nop 0
  buffer_load_dwordx4 v215, s[8:11], s7 offen lds
  v_mfma_f32_16x16x32_bf16 v[168:171], v[120:123], a[12:15], v[168:171]
  ds_read_b64_tr_b16 a[8:9], v217 offset:35904
  ds_read_b64_tr_b16 a[10:11], v217 offset:38464
  v_mfma_f32_16x16x32_bf16 v[172:175], v[124:127], a[12:15], v[172:175]
  s_waitcnt lgkmcnt(8)
  s_add_u32 m0, s46, 9216
  s_add_u32 s7, s35, 1327104
  buffer_load_dwordx4 v213, s[8:11], s7 offen lds
  v_mfma_f32_16x16x32_bf16 v[176:179], v[120:123], a[16:19], v[176:179]
  ds_read_b64_tr_b16 a[12:13], v217 offset:35936
  ds_read_b64_tr_b16 a[14:15], v217 offset:38496
  v_mfma_f32_16x16x32_bf16 v[180:183], v[124:127], a[16:19], v[180:183]
  v_mfma_f32_16x16x32_bf16 a[52:55], v[244:247], a[16:19], a[52:55]
  s_waitcnt lgkmcnt(8)
  s_add_u32 m0, s46, 10240
  s_nop 0
  buffer_load_dwordx4 v214, s[8:11], s7 offen lds
  v_mfma_f32_16x16x32_bf16 a[48:51], a[20:23], v[244:247], a[48:51]
  ds_read_b64_tr_b16 a[16:17], v217 offset:35968
  ds_read_b64_tr_b16 a[18:19], v217 offset:38528
  s_waitcnt lgkmcnt(8)
  s_add_u32 m0, s46, 11264
  s_nop 0
  buffer_load_dwordx4 v215, s[8:11], s7 offen lds
  v_mfma_f32_16x16x32_bf16 v[144:147], v[128:131], a[0:3], v[144:147]
  ds_read_b64_tr_b16 a[20:21], v241 offset:35840
  ds_read_b64_tr_b16 a[22:23], v241 offset:38400
  v_mfma_f32_16x16x32_bf16 v[148:151], v[132:135], a[0:3], v[148:151]
  s_waitcnt lgkmcnt(8)
  v_add_f32 v204, v204, v205
  v_mul_f32 v204, 0x3ae38e39, v204
  v_mfma_f32_16x16x32_bf16 v[152:155], v[128:131], a[4:7], v[152:155]
  ds_read_b64_tr_b16 a[0:1], v217 offset:40960
  ds_read_b64_tr_b16 a[2:3], v217 offset:43520
  v_mfma_f32_16x16x32_bf16 v[156:159], v[132:135], a[4:7], v[156:159]
  s_waitcnt lgkmcnt(8)
  v_cvt_pk_bf16_f32 v204, v204, v204
  s_lshr_b32 s44, s38, 5
  v_mfma_f32_16x16x32_bf16 v[160:163], v[128:131], a[8:11], v[160:163]
  ds_read_b64_tr_b16 a[4:5], v217 offset:40992
  ds_read_b64_tr_b16 a[6:7], v217 offset:43552
  v_mfma_f32_16x16x32_bf16 v[164:167], v[132:135], a[8:11], v[164:167]
  s_waitcnt lgkmcnt(8)
  s_lshl_b32 s44, s44, 6
  s_bfe_u32 s45, s38, 0x20002
  v_mfma_f32_16x16x32_bf16 v[168:171], v[128:131], a[12:15], v[168:171]
  ds_read_b64_tr_b16 a[8:9], v217 offset:41024
  ds_read_b64_tr_b16 a[10:11], v217 offset:43584
  v_mfma_f32_16x16x32_bf16 v[172:175], v[132:135], a[12:15], v[172:175]
  s_waitcnt lgkmcnt(8)
  s_lshl_b32 s45, s45, 4
  s_add_u32 s44, s44, s45
  v_mfma_f32_16x16x32_bf16 v[176:179], v[128:131], a[16:19], v[176:179]
  ds_read_b64_tr_b16 a[12:13], v217 offset:41056
  ds_read_b64_tr_b16 a[14:15], v217 offset:43616
  v_mfma_f32_16x16x32_bf16 v[180:183], v[132:135], a[16:19], v[180:183]
  v_mfma_f32_16x16x32_bf16 a[52:55], v[244:247], a[16:19], a[52:55]
  s_waitcnt lgkmcnt(8)
  s_bfe_u32 s45, s38, 0x10004
  s_lshl_b32 s45, s45, 3
  v_mfma_f32_16x16x32_bf16 a[48:51], a[20:23], v[244:247], a[48:51]
  ds_read_b64_tr_b16 a[16:17], v217 offset:41088
  ds_read_b64_tr_b16 a[18:19], v217 offset:43648
  s_waitcnt lgkmcnt(8)
  s_add_u32 s44, s44, s45
  s_and_b32 s45, s38, 3
  v_mfma_f32_16x16x32_bf16 v[144:147], v[136:139], a[0:3], v[144:147]
  ds_read_b64_tr_b16 a[20:21], v241 offset:40960
  ds_read_b64_tr_b16 a[22:23], v241 offset:43520
  v_mfma_f32_16x16x32_bf16 v[148:151], v[140:143], a[0:3], v[148:151]
  s_waitcnt lgkmcnt(8)
  s_lshl_b32 s45, s45, 1
  s_add_u32 s44, s44, s45
  v_mfma_f32_16x16x32_bf16 v[152:155], v[136:139], a[4:7], v[152:155]
  v_mfma_f32_16x16x32_bf16 v[156:159], v[140:143], a[4:7], v[156:159]
  s_waitcnt lgkmcnt(6)
  s_add_u32 s44, s44, 6389760
  s_cmp_lt_u32 s2, 144
  s_cselect_b32 s44, s44, 268435456
  v_mfma_f32_16x16x32_bf16 v[160:163], v[136:139], a[8:11], v[160:163]
  v_mfma_f32_16x16x32_bf16 v[164:167], v[140:143], a[8:11], v[164:167]
  s_waitcnt lgkmcnt(4)
  s_cmp_eq_u32 s32, 3
  s_cbranch_scc0 K1_nopfb
  s_mov_b32 s30, 5308416
  s_mov_b32 s31, 0x20000
  s_cmp_ge_u32 s2, 116
  s_cselect_b32 s28, s86, s84
  s_cselect_b32 s29, s87, s85
  s_cselect_b32 s72, 116, 0
  s_sub_u32 s72, s2, s72
  s_mul_i32 s72, s72, 46080
  v_lshrrev_b32 v208, 5, v218
  v_mul_u32_u24 v208, 9216, v208
  v_bfe_u32 v209, v218, 3, 2
  v_mul_u32_u24 v209, 2304, v209
  v_add_u32 v208, v208, v209
  v_and_b32 v209, 7, v218
  v_lshl_add_u32 v208, v209, 7, v208
  s_add_u32 s73, s72, 0
  buffer_load_dword a40, v208, s[28:31], s73 offen
  s_add_u32 s73, s72, 18432
  buffer_load_dword a40, v208, s[28:31], s73 offen
  s_add_u32 s73, s72, 27648
  buffer_load_dword a40, v208, s[28:31], s73 offen
K1_nopfb:
  v_mfma_f32_16x16x32_bf16 v[168:171], v[136:139], a[12:15], v[168:171]
  v_mfma_f32_16x16x32_bf16 v[172:175], v[140:143], a[12:15], v[172:175]
  s_waitcnt lgkmcnt(2)
  buffer_store_short v204, v236, s[12:15], s44 offen sc1
  v_mfma_f32_16x16x32_bf16 v[176:179], v[136:139], a[16:19], v[176:179]
  v_mfma_f32_16x16x32_bf16 v[180:183], v[140:143], a[16:19], v[180:183]
  v_mfma_f32_16x16x32_bf16 a[52:55], v[244:247], a[16:19], a[52:55]
  s_waitcnt lgkmcnt(0)
  v_lshrrev_b32 v248, 2, v219
  v_cmp_eq_u32 s[74:75], v248, v220
  v_mfma_f32_16x16x32_bf16 a[48:51], a[20:23], v[244:247], a[48:51]
  v_and_b32 v248, 3, v219
  v_accvgpr_read_b32 v222, a56
  s_nop 7
  v_accvgpr_read_b32 v224, a64
  v_cmp_eq_u32 vcc, 1, v248
  v_accvgpr_read_b32 v249, a65
  s_nop 0
  v_cndmask_b32 v224, v224, v249, vcc
  v_cmp_eq_u32 vcc, 2, v248
  v_accvgpr_read_b32 v249, a66
  s_nop 0
  v_cndmask_b32 v224, v224, v249, vcc
  v_cmp_eq_u32 vcc, 3, v248
  v_accvgpr_read_b32 v249, a67
  s_nop 0
  v_cndmask_b32 v224, v224, v249, vcc
  v_cndmask_b32 v224, 0, v224, s[74:75]
  v_accvgpr_read_b32 v223, a60
  v_accvgpr_read_b32 v225, a68
  v_cmp_eq_u32 vcc, 1, v248
  v_accvgpr_read_b32 v249, a69
  s_nop 0
  v_cndmask_b32 v225, v225, v249, vcc
  v_cmp_eq_u32 vcc, 2, v248
  v_accvgpr_read_b32 v249, a70
  s_nop 0
  v_cndmask_b32 v225, v225, v249, vcc
  v_cmp_eq_u32 vcc, 3, v248
  v_accvgpr_read_b32 v249, a71
  s_nop 0
  v_cndmask_b32 v225, v225, v249, vcc
  v_cndmask_b32 v225, 0, v225, s[74:75]
  v_mov_b32 v248, v224
  v_mov_b32 v249, v225
  s_nop 1
  v_permlane32_swap_b32 v224, v248
  v_permlane32_swap_b32 v225, v249
  v_add_f32 v224, v224, v248
  v_add_f32 v225, v225, v249
  v_mov_b32 v248, v224
  v_mov_b32 v249, v225
  s_nop 1
  v_permlane16_swap_b32 v224, v248
  v_permlane16_swap_b32 v225, v249
  v_add_f32 v224, v224, v248
  v_add_f32 v225, v225, v249
  v_mul_f32 v222, 0x3ae38e39, v222
  v_mul_f32 v223, 0x3ae38e39, v223
  v_mul_f32 v224, 0x3ae38e39, v224
  v_mul_f32 v225, 0x3ae38e39, v225
  v_fma_f32 v224, -v222, v222, v224
  v_max_f32 v224, 0, v224
  v_add_f32 v224, 0x3727c5ac, v224
  v_rsq_f32 v224, v224
  v_fma_f32 v225, -v223, v223, v225
  v_max_f32 v225, 0, v225
  v_add_f32 v225, 0x3727c5ac, v225
  v_rsq_f32 v225, v225
  s_nop 0
  ds_write_b32 v242, v222 offset:0
  ds_write_b32 v242, v223 offset:64
  ds_write_b32 v242, v224 offset:128
  ds_write_b32 v242, v225 offset:192
  ds_write_b128 v253, a[48:51]
  ds_read_b128 v[184:187], v243 offset:0
  ds_read_b128 v[188:191], v243 offset:64
  ds_read_b128 v[192:195], v243 offset:128
  ds_read_b128 v[196:199], v243 offset:192
  v_lshlrev_b32 v248, 2, v219
  v_add_u32 v248, 158720, v248
  v_accvgpr_read_b32 v212, a52
  v_cmp_eq_u32 vcc, 4, v219
  s_waitcnt lgkmcnt(0)
  s_barrier
  ds_read_b32 v208, v248 offset:0
  ds_read_b32 v209, v248 offset:64
  ds_read_b32 v210, v248 offset:128
  ds_read_b32 v211, v248 offset:192
  v_mul_f32 v200, 0x3fb8aa3b, v192
  v_mul_f32 v201, 0x3fb8aa3b, v193
  v_mul_f32 v202, 0x3fb8aa3b, v194
  v_mul_f32 v203, 0x3fb8aa3b, v195
  v_mul_f32 v204, 0x3fb8aa3b, v196
  v_mul_f32 v205, 0x3fb8aa3b, v197
  v_mul_f32 v206, 0x3fb8aa3b, v198
  v_mul_f32 v207, 0x3fb8aa3b, v199
  s_waitcnt lgkmcnt(0)
  v_fma_f32 v144, -v184, v208, v144
  v_mul_f32 v248, v144, v200
  v_exp_f32 v248, v248
  v_fma_f32 v249, v144, v192, 1.0
  v_med3_f32 v248, v248, v249, 1.0
  v_add_f32 v248, 0x358637bd, v248
  v_fma_f32 v145, -v185, v208, v145
  v_mul_f32 v250, v145, v201
  v_exp_f32 v250, v250
  v_fma_f32 v251, v145, v193, 1.0
  v_med3_f32 v250, v250, v251, 1.0
  v_add_f32 v250, 0x358637bd, v250
  v_cvt_pk_bf16_f32 v144, v248, v250
  v_fma_f32 v146, -v186, v208, v146
  v_mul_f32 v240, v146, v202
  v_exp_f32 v240, v240
  v_fma_f32 v241, v146, v194, 1.0
  v_med3_f32 v240, v240, v241, 1.0
  v_add_f32 v240, 0x358637bd, v240
  v_fma_f32 v147, -v187, v208, v147
  v_mul_f32 v254, v147, v203
  v_exp_f32 v254, v254
  v_fma_f32 v255, v147, v195, 1.0
  v_med3_f32 v254, v254, v255, 1.0
  v_add_f32 v254, 0x358637bd, v254
  v_cvt_pk_bf16_f32 v145, v240, v254
  v_fma_f32 v148, -v188, v208, v148
  v_mul_f32 v248, v148, v204
  v_exp_f32 v248, v248
  v_fma_f32 v249, v148, v196, 1.0
  v_med3_f32 v248, v248, v249, 1.0
  v_add_f32 v248, 0x358637bd, v248
  v_fma_f32 v149, -v189, v208, v149
  v_mul_f32 v250, v149, v205
  v_exp_f32 v250, v250
  v_fma_f32 v251, v149, v197, 1.0
  v_med3_f32 v250, v250, v251, 1.0
  v_add_f32 v250, 0x358637bd, v250
  v_cvt_pk_bf16_f32 v146, v248, v250
  v_fma_f32 v150, -v190, v208, v150
  v_mul_f32 v240, v150, v206
  v_exp_f32 v240, v240
  v_fma_f32 v241, v150, v198, 1.0
  v_med3_f32 v240, v240, v241, 1.0
  v_add_f32 v240, 0x358637bd, v240
  v_fma_f32 v151, -v191, v208, v151
  v_mul_f32 v254, v151, v207
  v_exp_f32 v254, v254
  v_fma_f32 v255, v151, v199, 1.0
  v_med3_f32 v254, v254, v255, 1.0
  v_add_f32 v254, 0x358637bd, v254
  v_cvt_pk_bf16_f32 v147, v240, v254
  v_fma_f32 v152, -v184, v209, v152
  v_mul_f32 v248, v152, v200
  v_exp_f32 v248, v248
  v_fma_f32 v249, v152, v192, 1.0
  v_med3_f32 v248, v248, v249, 1.0
  v_add_f32 v248, 0x358637bd, v248
  v_fma_f32 v153, -v185, v209, v153
  v_mul_f32 v250, v153, v201
  v_exp_f32 v250, v250
  v_fma_f32 v251, v153, v193, 1.0
  v_med3_f32 v250, v250, v251, 1.0
  v_add_f32 v250, 0x358637bd, v250
  v_cvt_pk_bf16_f32 v152, v248, v250
  v_fma_f32 v154, -v186, v209, v154
  v_mul_f32 v240, v154, v202
  v_exp_f32 v240, v240
  v_fma_f32 v241, v154, v194, 1.0
  v_med3_f32 v240, v240, v241, 1.0
  v_add_f32 v240, 0x358637bd, v240
  v_fma_f32 v155, -v187, v209, v155
  v_mul_f32 v254, v155, v203
  v_exp_f32 v254, v254
  v_fma_f32 v255, v155, v195, 1.0
  v_med3_f32 v254, v254, v255, 1.0
  v_add_f32 v254, 0x358637bd, v254
  v_cvt_pk_bf16_f32 v153, v240, v254
  v_fma_f32 v156, -v188, v209, v156
  v_mul_f32 v248, v156, v204
  v_exp_f32 v248, v248
  v_fma_f32 v249, v156, v196, 1.0
  v_med3_f32 v248, v248, v249, 1.0
  v_add_f32 v248, 0x358637bd, v248
  v_fma_f32 v157, -v189, v209, v157
  v_mul_f32 v250, v157, v205
  v_exp_f32 v250, v250
  v_fma_f32 v251, v157, v197, 1.0
  v_med3_f32 v250, v250, v251, 1.0
  v_add_f32 v250, 0x358637bd, v250
  v_cvt_pk_bf16_f32 v154, v248, v250
  v_fma_f32 v158, -v190, v209, v158
  v_mul_f32 v240, v158, v206
  v_exp_f32 v240, v240
  v_fma_f32 v241, v158, v198, 1.0
  v_med3_f32 v240, v240, v241, 1.0
  v_add_f32 v240, 0x358637bd, v240
  v_fma_f32 v159, -v191, v209, v159
  v_mul_f32 v254, v159, v207
  v_exp_f32 v254, v254
  v_fma_f32 v255, v159, v199, 1.0
  v_med3_f32 v254, v254, v255, 1.0
  v_add_f32 v254, 0x358637bd, v254
  v_cvt_pk_bf16_f32 v155, v240, v254
  v_fma_f32 v160, -v184, v210, v160
  v_mul_f32 v248, v160, v200
  v_exp_f32 v248, v248
  v_fma_f32 v249, v160, v192, 1.0
  v_med3_f32 v248, v248, v249, 1.0
  v_add_f32 v248, 0x358637bd, v248
  v_fma_f32 v161, -v185, v210, v161
  v_mul_f32 v250, v161, v201
  v_exp_f32 v250, v250
  v_fma_f32 v251, v161, v193, 1.0
  v_med3_f32 v250, v250, v251, 1.0
  v_add_f32 v250, 0x358637bd, v250
  v_cvt_pk_bf16_f32 v214, v248, v250
  v_fma_f32 v162, -v186, v210, v162
  v_mul_f32 v240, v162, v202
  v_exp_f32 v240, v240
  v_fma_f32 v241, v162, v194, 1.0
  v_med3_f32 v240, v240, v241, 1.0
  v_add_f32 v240, 0x358637bd, v240
  v_fma_f32 v163, -v187, v210, v163
  v_mul_f32 v254, v163, v203
  v_exp_f32 v254, v254
  v_fma_f32 v255, v163, v195, 1.0
  v_med3_f32 v254, v254, v255, 1.0
  v_add_f32 v254, 0x358637bd, v254
  v_cvt_pk_bf16_f32 v215, v240, v254
  v_fma_f32 v164, -v188, v210, v164
  v_mul_f32 v248, v164, v204
  v_exp_f32 v248, v248
  v_fma_f32 v249, v164, v196, 1.0
  v_med3_f32 v248, v248, v249, 1.0
  v_add_f32 v248, 0x358637bd, v248
  v_fma_f32 v165, -v189, v210, v165
  v_mul_f32 v250, v165, v205
  v_exp_f32 v250, v250
  v_fma_f32 v251, v165, v197, 1.0
  v_med3_f32 v250, v250, v251, 1.0
  v_add_f32 v250, 0x358637bd, v250
  v_cvt_pk_bf16_f32 v216, v248, v250
  v_fma_f32 v166, -v190, v210, v166
  v_mul_f32 v240, v166, v206
  v_exp_f32 v240, v240
  v_fma_f32 v241, v166, v198, 1.0
  v_med3_f32 v240, v240, v241, 1.0
  v_add_f32 v240, 0x358637bd, v240
  v_fma_f32 v167, -v191, v210, v167
  v_mul_f32 v254, v167, v207
  v_exp_f32 v254, v254
  v_fma_f32 v255, v167, v199, 1.0
  v_med3_f32 v254, v254, v255, 1.0
  v_add_f32 v254, 0x358637bd, v254
  v_cvt_pk_bf16_f32 v217, v240, v254
  v_mul_f32 v160, v160, v192
  v_mul_f32 v161, v161, v193
  v_cvt_pk_bf16_f32 v160, v160, v161
  v_mul_f32 v162, v162, v194
  v_mul_f32 v163, v163, v195
  v_cvt_pk_bf16_f32 v161, v162, v163
  v_mul_f32 v164, v164, v196
  v_mul_f32 v165, v165, v197
  v_cvt_pk_bf16_f32 v162, v164, v165
  v_mul_f32 v166, v166, v198
  v_mul_f32 v167, v167, v199
  v_cvt_pk_bf16_f32 v163, v166, v167
  v_cndmask_b32 v160, v160, v244, vcc
  v_cndmask_b32 v161, v161, v244, vcc
  v_cndmask_b32 v162, v162, v244, vcc
  v_cndmask_b32 v163, v163, v244, vcc
  v_fma_f32 v168, -v184, v211, v168
  v_mul_f32 v168, v168, v192
  v_fma_f32 v169, -v185, v211, v169
  v_mul_f32 v169, v169, v193
  v_cvt_pk_bf16_f32 v168, v168, v169
  v_fma_f32 v170, -v186, v211, v170
  v_mul_f32 v170, v170, v194
  v_fma_f32 v171, -v187, v211, v171
  v_mul_f32 v171, v171, v195
  v_cvt_pk_bf16_f32 v169, v170, v171
  v_fma_f32 v172, -v188, v211, v172
  v_mul_f32 v172, v172, v196
  v_fma_f32 v173, -v189, v211, v173
  v_mul_f32 v173, v173, v197
  v_cvt_pk_bf16_f32 v170, v172, v173
  v_fma_f32 v174, -v190, v211, v174
  v_mul_f32 v174, v174, v198
  v_fma_f32 v175, -v191, v211, v175
  v_mul_f32 v175, v175, v199
  v_cvt_pk_bf16_f32 v171, v174, v175
  v_fma_f32 v176, -v184, v212, v176
  v_mul_f32 v176, v176, v192
  v_fma_f32 v177, -v185, v212, v177
  v_mul_f32 v177, v177, v193
  v_cvt_pk_bf16_f32 v176, v176, v177
  v_fma_f32 v178, -v186, v212, v178
  v_mul_f32 v178, v178, v194
  v_fma_f32 v179, -v187, v212, v179
  v_mul_f32 v179, v179, v195
  v_cvt_pk_bf16_f32 v177, v178, v179
  v_fma_f32 v180, -v188, v212, v180
  v_mul_f32 v180, v180, v196
  v_fma_f32 v181, -v189, v212, v181
  v_mul_f32 v181, v181, v197
  v_cvt_pk_bf16_f32 v178, v180, v181
  v_fma_f32 v182, -v190, v212, v182
  v_mul_f32 v182, v182, v198
  v_fma_f32 v183, -v191, v212, v183
  v_mul_f32 v183, v183, v199
  v_cvt_pk_bf16_f32 v179, v182, v183
  v_mfma_f32_16x16x32_bf16 a[72:75], v[144:147], v[160:163], 0
  v_mfma_f32_16x16x32_bf16 a[76:79], v[152:155], v[160:163], 0
  v_mfma_f32_16x16x32_bf16 a[80:83], v[214:217], v[160:163], 0
  v_mfma_f32_16x16x32_bf16 a[84:87], v[144:147], v[168:171], 0
  v_mfma_f32_16x16x32_bf16 a[88:91], v[152:155], v[168:171], 0
  v_mfma_f32_16x16x32_bf16 a[92:95], v[214:217], v[168:171], 0
  v_mfma_f32_16x16x32_bf16 a[96:99], v[152:155], v[176:179], 0
  v_mfma_f32_16x16x32_bf16 a[100:103], v[214:217], v[176:179], 0
  s_lshl_b32 s5, s33, 4
  s_mul_i32 s39, s5, 3072
  s_add_u32 s39, s39, 7340032
  s_mul_i32 s6, s34, 3072
  s_add_u32 s6, s6, s39
  s_lshl_b32 s5, s33, 7
  s_add_u32 s5, s5, 6438912
  s_lshl_b32 s7, s34, 2
  s_add_u32 s7, s7, s5
  ds_write_b128 v233, a[72:75] offset:0
  ds_write_b128 v233, a[76:79] offset:64
  ds_write_b128 v233, a[80:83] offset:128
  ds_write_b128 v233, a[84:87] offset:3328
  ds_write_b128 v233, a[88:91] offset:3392
  ds_write_b128 v233, a[92:95] offset:3456
  ds_write_b128 v233, a[96:99] offset:6720
  ds_write_b128 v233, a[100:103] offset:6784
  s_min_u32 s43, s32, 2
  s_lshl_b32 s43, s43, 5
  v_add_u32 v240, s43, v252
  s_cmp_eq_u32 s32, 3
  s_cbranch_scc1 K1_w3a
  s_waitcnt vmcnt(0)
K1_w3a:
  s_waitcnt vmcnt(3)
  s_waitcnt lgkmcnt(0)
  s_barrier
  s_cmp_eq_u32 s32, 3
  s_cbranch_scc1 K1_nopub
  ds_read_b128 v[144:147], v226 offset:0
  ds_read_b128 v[148:151], v226 offset:9984
  ds_read_b128 v[152:155], v226 offset:19968
  ds_read_b128 v[156:159], v226 offset:29952
  s_waitcnt lgkmcnt(2)
  v_add_f32 v144, v144, v148
  v_add_f32 v145, v145, v149
  v_add_f32 v146, v146, v150
  v_add_f32 v147, v147, v151
  s_waitcnt lgkmcnt(0)
  v_add_f32 v152, v152, v156
  v_add_f32 v153, v153, v157
  v_add_f32 v154, v154, v158
  v_add_f32 v155, v155, v159
  v_add_f32 v144, v144, v152
  v_add_f32 v145, v145, v153
  v_add_f32 v146, v146, v154
  v_add_f32 v147, v147, v155
  buffer_store_dwordx4 v[144:147], v237, s[12:15], s6 offen sc1
K1_nopub:
  ds_read_b64_tr_b16 a[0:1], v252 offset:0
  ds_read_b64_tr_b16 a[2:3], v252 offset:1536
  ds_read_b64_tr_b16 a[4:5], v252 offset:32
  ds_read_b64_tr_b16 a[6:7], v252 offset:1568
  ds_read_b64_tr_b16 a[8:9], v252 offset:64
  ds_read_b64_tr_b16 a[10:11], v252 offset:1600
  ds_read_b64_tr_b16 a[12:13], v240 offset:0
  ds_read_b64_tr_b16 a[14:15], v240 offset:1536
  ds_read_b64_tr_b16 a[16:17], v252 offset:16384
  ds_read_b64_tr_b16 a[18:19], v252 offset:17920
  s_waitcnt lgkmcnt(8)
  v_mfma_f32_16x16x32_bf16 v[184:187], a[0:3], v[0:3], 0
  ds_read_b64_tr_b16 a[20:21], v252 offset:16416
  ds_read_b64_tr_b16 a[22:23], v252 offset:17952
  v_mfma_f32_16x16x32_bf16 v[188:191], a[0:3], v[4:7], 0
  s_waitcnt lgkmcnt(8)
  v_mfma_f32_16x16x32_bf16 v[192:195], a[4:7], v[0:3], 0
  ds_read_b64_tr_b16 a[0:1], v252 offset:16448
  ds_read_b64_tr_b16 a[2:3], v252 offset:17984
  v_mfma_f32_16x16x32_bf16 v[196:199], a[4:7], v[4:7], 0
  s_waitcnt lgkmcnt(8)
  v_mfma_f32_16x16x32_bf16 v[200:203], a[8:11], v[0:3], 0
  ds_read_b64_tr_b16 a[4:5], v240 offset:16384
  ds_read_b64_tr_b16 a[6:7], v240 offset:17920
  v_mfma_f32_16x16x32_bf16 v[204:207], a[8:11], v[4:7], 0
  s_waitcnt lgkmcnt(8)
  v_mfma_f32_16x16x32_bf16 a[48:51], a[12:15], v[244:247], 0
  ds_read_b64_tr_b16 a[8:9], v252 offset:32768
  ds_read_b64_tr_b16 a[10:11], v252 offset:34304
  s_waitcnt lgkmcnt(8)
  v_mfma_f32_16x16x32_bf16 v[184:187], a[16:19], v[8:11], v[184:187]
  ds_read_b64_tr_b16 a[12:13], v252 offset:32800
  ds_read_b64_tr_b16 a[14:15], v252 offset:34336
  v_mfma_f32_16x16x32_bf16 v[188:191], a[16:19], v[12:15], v[188:191]
  s_waitcnt lgkmcnt(8)
  v_mfma_f32_16x16x32_bf16 v[192:195], a[20:23], v[8:11], v[192:195]
  ds_read_b64_tr_b16 a[16:17], v252 offset:32832
  ds_read_b64_tr_b16 a[18:19], v252 offset:34368
  v_mfma_f32_16x16x32_bf16 v[196:199], a[20:23], v[12:15], v[196:199]
  s_waitcnt lgkmcnt(8)
  v_mfma_f32_16x16x32_bf16 v[200:203], a[0:3], v[8:11], v[200:203]
  ds_read_b64_tr_b16 a[20:21], v240 offset:32768
  ds_read_b64_tr_b16 a[22:23], v240 offset:34304
  v_mfma_f32_16x16x32_bf16 v[204:207], a[0:3], v[12:15], v[204:207]
  s_waitcnt lgkmcnt(8)
  v_mfma_f32_16x16x32_bf16 a[48:51], a[4:7], v[244:247], a[48:51]
  ds_read_b64_tr_b16 a[0:1], v252 offset:49152
  ds_read_b64_tr_b16 a[2:3], v252 offset:50688
  s_waitcnt lgkmcnt(8)
  v_mfma_f32_16x16x32_bf16 v[184:187], a[8:11], v[16:19], v[184:187]
  ds_read_b64_tr_b16 a[4:5], v252 offset:49184
  ds_read_b64_tr_b16 a[6:7], v252 offset:50720
  v_mfma_f32_16x16x32_bf16 v[188:191], a[8:11], v[20:23], v[188:191]
  s_waitcnt lgkmcnt(8)
  v_mfma_f32_16x16x32_bf16 v[192:195], a[12:15], v[16:19], v[192:195]
  ds_read_b64_tr_b16 a[8:9], v252 offset:49216
  ds_read_b64_tr_b16 a[10:11], v252 offset:50752
  v_mfma_f32_16x16x32_bf16 v[196:199], a[12:15], v[20:23], v[196:199]
  s_waitcnt lgkmcnt(8)
  v_mfma_f32_16x16x32_bf16 v[200:203], a[16:19], v[16:19], v[200:203]
  ds_read_b64_tr_b16 a[12:13], v240 offset:49152
  ds_read_b64_tr_b16 a[14:15], v240 offset:50688
  v_mfma_f32_16x16x32_bf16 v[204:207], a[16:19], v[20:23], v[204:207]
  s_waitcnt lgkmcnt(8)
  v_mfma_f32_16x16x32_bf16 a[48:51], a[20:23], v[244:247], a[48:51]
  ds_read_b64_tr_b16 a[16:17], v252 offset:3072
  ds_read_b64_tr_b16 a[18:19], v252 offset:4608
  s_waitcnt lgkmcnt(8)
  v_mfma_f32_16x16x32_bf16 v[184:187], a[0:3], v[24:27], v[184:187]
  ds_read_b64_tr_b16 a[20:21], v252 offset:3104
  ds_read_b64_tr_b16 a[22:23], v252 offset:4640
  v_mfma_f32_16x16x32_bf16 v[188:191], a[0:3], v[28:31], v[188:191]
  s_waitcnt lgkmcnt(8)
  v_mfma_f32_16x16x32_bf16 v[192:195], a[4:7], v[24:27], v[192:195]
  ds_read_b64_tr_b16 a[0:1], v252 offset:3136
  ds_read_b64_tr_b16 a[2:3], v252 offset:4672
  v_mfma_f32_16x16x32_bf16 v[196:199], a[4:7], v[28:31], v[196:199]
  s_waitcnt lgkmcnt(8)
  v_mfma_f32_16x16x32_bf16 v[200:203], a[8:11], v[24:27], v[200:203]
  ds_read_b64_tr_b16 a[4:5], v240 offset:3072
  ds_read_b64_tr_b16 a[6:7], v240 offset:4608
  v_mfma_f32_16x16x32_bf16 v[204:207], a[8:11], v[28:31], v[204:207]
  s_waitcnt lgkmcnt(8)
  s_cmp_eq_u32 s32, 3
  s_cbranch_scc1 K1_w3b
  s_waitcnt vmcnt(0)
K1_w3b:
  s_waitcnt vmcnt(3)
  s_barrier
  s_cmp_eq_u32 s32, 0
  s_cbranch_scc0 K1_flagged
  v_accvgpr_read_b32 v168, a42
  s_nop 0
K1_tag:
  v_readfirstlane_b32 s100, v168
  s_cmp_lg_u32 s100, 0
  s_cbranch_scc1 K1_gottag
  buffer_load_dword v168, off, s[20:23], 0 sc1
  s_waitcnt vmcnt(0)
  s_branch K1_tag
K1_gottag:
  buffer_store_dword v168, v236, s[12:15], s7 offen sc1
K1_flagged:
  v_mfma_f32_16x16x32_bf16 a[48:51], a[12:15], v[244:247], a[48:51]
  ds_read_b64_tr_b16 a[8:9], v252 offset:19456
  ds_read_b64_tr_b16 a[10:11], v252 offset:20992
  s_waitcnt lgkmcnt(8)
  s_lshl_b32 s6, s37, 7
  s_add_u32 s6, s6, 6299648
  v_mfma_f32_16x16x32_bf16 v[184:187], a[16:19], v[32:35], v[184:187]
  ds_read_b64_tr_b16 a[12:13], v252 offset:19488
  ds_read_b64_tr_b16 a[14:15], v252 offset:21024
  v_mfma_f32_16x16x32_bf16 v[188:191], a[16:19], v[36:39], v[188:191]
  s_waitcnt lgkmcnt(8)
  s_cmp_eq_u32 s33, 0
  s_cselect_b32 s6, s6, 268435456
  v_mfma_f32_16x16x32_bf16 v[192:195], a[20:23], v[32:35], v[192:195]
  ds_read_b64_tr_b16 a[16:17], v252 offset:19520
  ds_read_b64_tr_b16 a[18:19], v252 offset:21056
  v_mfma_f32_16x16x32_bf16 v[196:199], a[20:23], v[36:39], v[196:199]
  s_waitcnt lgkmcnt(8)
  buffer_store_dword v222, v238, s[12:15], s6 offen offset:0 sc1
  v_mfma_f32_16x16x32_bf16 v[200:203], a[0:3], v[32:35], v[200:203]
  ds_read_b64_tr_b16 a[20:21], v240 offset:19456
  ds_read_b64_tr_b16 a[22:23], v240 offset:20992
  v_mfma_f32_16x16x32_bf16 v[204:207], a[0:3], v[36:39], v[204:207]
  s_waitcnt lgkmcnt(8)
  buffer_store_dword v223, v238, s[12:15], s6 offen offset:64 sc1
  v_mfma_f32_16x16x32_bf16 a[48:51], a[4:7], v[244:247], a[48:51]
  ds_read_b64_tr_b16 a[0:1], v252 offset:35840
  ds_read_b64_tr_b16 a[2:3], v252 offset:37376
  s_waitcnt lgkmcnt(8)
  v_accvgpr_read_b32 v208, a104
  v_accvgpr_read_b32 v209, a105
  v_accvgpr_read_b32 v210, a106
  v_mfma_f32_16x16x32_bf16 v[184:187], a[8:11], v[40:43], v[184:187]
  ds_read_b64_tr_b16 a[4:5], v252 offset:35872
  ds_read_b64_tr_b16 a[6:7], v252 offset:37408
  v_mfma_f32_16x16x32_bf16 v[188:191], a[8:11], v[44:47], v[188:191]
  s_waitcnt lgkmcnt(8)
  v_accvgpr_read_b32 v211, a107
  v_accvgpr_read_b32 v212, a108
  v_mfma_f32_16x16x32_bf16 v[192:195], a[12:15], v[40:43], v[192:195]
  ds_read_b64_tr_b16 a[8:9], v252 offset:35904
  ds_read_b64_tr_b16 a[10:11], v252 offset:37440
  v_mfma_f32_16x16x32_bf16 v[196:199], a[12:15], v[44:47], v[196:199]
  s_waitcnt lgkmcnt(8)
  s_lshr_b32 s65, s2, 5
  s_mul_i32 s6, s65, 144
  v_mfma_f32_16x16x32_bf16 v[200:203], a[16:19], v[40:43], v[200:203]
  ds_read_b64_tr_b16 a[12:13], v240 offset:35840
  ds_read_b64_tr_b16 a[14:15], v240 offset:37376
  v_mfma_f32_16x16x32_bf16 v[204:207], a[16:19], v[44:47], v[204:207]
  s_waitcnt lgkmcnt(8)
  s_mul_i32 s70, s32, 36864
  s_add_u32 s70, s70, s6
  v_mfma_f32_16x16x32_bf16 a[48:51], a[20:23], v[244:247], a[48:51]
  ds_read_b64_tr_b16 a[16:17], v252 offset:52224
  ds_read_b64_tr_b16 a[18:19], v252 offset:53760
  s_waitcnt lgkmcnt(8)
  s_add_u32 m0, s47, 0
  s_add_u32 s71, s70, 0
  buffer_load_dwordx4 v208, s[24:27], s71 offen lds
  v_mfma_f32_16x16x32_bf16 v[184:187], a[0:3], v[48:51], v[184:187]
  ds_read_b64_tr_b16 a[20:21], v252 offset:52256
  ds_read_b64_tr_b16 a[22:23], v252 offset:53792
  v_mfma_f32_16x16x32_bf16 v[188:191], a[0:3], v[52:55], v[188:191]
  s_waitcnt lgkmcnt(8)
  s_add_u32 m0, s47, 1024
  s_nop 0
  buffer_load_dwordx4 v209, s[24:27], s71 offen lds
  v_mfma_f32_16x16x32_bf16 v[192:195], a[4:7], v[48:51], v[192:195]
  ds_read_b64_tr_b16 a[0:1], v252 offset:52288
  ds_read_b64_tr_b16 a[2:3], v252 offset:53824
  v_mfma_f32_16x16x32_bf16 v[196:199], a[4:7], v[52:55], v[196:199]
  s_waitcnt lgkmcnt(8)
  s_add_u32 m0, s47, 2048
  s_nop 0
  buffer_load_dwordx4 v210, s[24:27], s71 offen lds
  v_mfma_f32_16x16x32_bf16 v[200:203], a[8:11], v[48:51], v[200:203]
  ds_read_b64_tr_b16 a[4:5], v240 offset:52224
  ds_read_b64_tr_b16 a[6:7], v240 offset:53760
  v_mfma_f32_16x16x32_bf16 v[204:207], a[8:11], v[52:55], v[204:207]
  s_waitcnt lgkmcnt(8)
  s_add_u32 m0, s47, 3072
  s_nop 0
  buffer_load_dwordx4 v211, s[24:27], s71 offen lds
  v_mfma_f32_16x16x32_bf16 a[48:51], a[12:15], v[244:247], a[48:51]
  ds_read_b64_tr_b16 a[8:9], v252 offset:6144
  ds_read_b64_tr_b16 a[10:11], v252 offset:7680
  s_waitcnt lgkmcnt(8)
  s_add_u32 m0, s47, 4096
  s_nop 0
  buffer_load_dwordx4 v212, s[24:27], s71 offen lds
  v_mfma_f32_16x16x32_bf16 v[184:187], a[16:19], v[56:59], v[184:187]
  ds_read_b64_tr_b16 a[12:13], v252 offset:6176
  ds_read_b64_tr_b16 a[14:15], v252 offset:7712
  v_mfma_f32_16x16x32_bf16 v[188:191], a[16:19], v[60:63], v[188:191]
  s_waitcnt lgkmcnt(8)
  s_add_u32 m0, s47, 20480
  s_add_u32 s71, s70, 147456
  buffer_load_dwordx4 v208, s[24:27], s71 offen lds
  v_mfma_f32_16x16x32_bf16 v[192:195], a[20:23], v[56:59], v[192:195]
  ds_read_b64_tr_b16 a[16:17], v252 offset:6208
  ds_read_b64_tr_b16 a[18:19], v252 offset:7744
  v_mfma_f32_16x16x32_bf16 v[196:199], a[20:23], v[60:63], v[196:199]
  s_waitcnt lgkmcnt(8)
  s_add_u32 m0, s47, 21504
  s_nop 0
  buffer_load_dwordx4 v209, s[24:27], s71 offen lds
  v_mfma_f32_16x16x32_bf16 v[200:203], a[0:3], v[56:59], v[200:203]
  ds_read_b64_tr_b16 a[20:21], v240 offset:6144
  ds_read_b64_tr_b16 a[22:23], v240 offset:7680
  v_mfma_f32_16x16x32_bf16 v[204:207], a[0:3], v[60:63], v[204:207]
  s_waitcnt lgkmcnt(8)
  s_add_u32 m0, s47, 22528
  s_nop 0
  buffer_load_dwordx4 v210, s[24:27], s71 offen lds
  v_mfma_f32_16x16x32_bf16 a[48:51], a[4:7], v[244:247], a[48:51]
  ds_read_b64_tr_b16 a[0:1], v252 offset:22528
  ds_read_b64_tr_b16 a[2:3], v252 offset:24064
  s_waitcnt lgkmcnt(8)
  s_add_u32 m0, s47, 23552
  s_nop 0
  buffer_load_dwordx4 v211, s[24:27], s71 offen lds
  v_mfma_f32_16x16x32_bf16 v[184:187], a[8:11], v[64:67], v[184:187]
  ds_read_b64_tr_b16 a[4:5], v252 offset:22560
  ds_read_b64_tr_b16 a[6:7], v252 offset:24096
  v_mfma_f32_16x16x32_bf16 v[188:191], a[8:11], v[68:71], v[188:191]
  s_waitcnt lgkmcnt(8)
  s_add_u32 m0, s47, 24576
  s_nop 0
  buffer_load_dwordx4 v212, s[24:27], s71 offen lds
  v_mfma_f32_16x16x32_bf16 v[192:195], a[12:15], v[64:67], v[192:195]
  ds_read_b64_tr_b16 a[8:9], v252 offset:22592
  ds_read_b64_tr_b16 a[10:11], v252 offset:24128
  v_mfma_f32_16x16x32_bf16 v[196:199], a[12:15], v[68:71], v[196:199]
  s_waitcnt lgkmcnt(8)
  s_add_u32 m0, s47, 40960
  s_add_u32 s71, s70, 294912
  buffer_load_dwordx4 v208, s[24:27], s71 offen lds
  v_mfma_f32_16x16x32_bf16 v[200:203], a[16:19], v[64:67], v[200:203]
  ds_read_b64_tr_b16 a[12:13], v240 offset:22528
  ds_read_b64_tr_b16 a[14:15], v240 offset:24064
  v_mfma_f32_16x16x32_bf16 v[204:207], a[16:19], v[68:71], v[204:207]
  s_waitcnt lgkmcnt(8)
  s_add_u32 m0, s47, 41984
  s_nop 0
  buffer_load_dwordx4 v209, s[24:27], s71 offen lds
  v_mfma_f32_16x16x32_bf16 a[48:51], a[20:23], v[244:247], a[48:51]
  ds_read_b64_tr_b16 a[16:17], v252 offset:38912
  ds_read_b64_tr_b16 a[18:19], v252 offset:40448
  s_waitcnt lgkmcnt(8)
  s_add_u32 m0, s47, 43008
  s_nop 0
  buffer_load_dwordx4 v210, s[24:27], s71 offen lds
  v_mfma_f32_16x16x32_bf16 v[184:187], a[0:3], v[72:75], v[184:187]
  ds_read_b64_tr_b16 a[20:21], v252 offset:38944
  ds_read_b64_tr_b16 a[22:23], v252 offset:40480
  v_mfma_f32_16x16x32_bf16 v[188:191], a[0:3], v[76:79], v[188:191]
  s_waitcnt lgkmcnt(8)
  s_add_u32 m0, s47, 44032
  s_nop 0
  buffer_load_dwordx4 v211, s[24:27], s71 offen lds
  v_mfma_f32_16x16x32_bf16 v[192:195], a[4:7], v[72:75], v[192:195]
  ds_read_b64_tr_b16 a[0:1], v252 offset:38976
  ds_read_b64_tr_b16 a[2:3], v252 offset:40512
  v_mfma_f32_16x16x32_bf16 v[196:199], a[4:7], v[76:79], v[196:199]
  s_waitcnt lgkmcnt(8)
  s_add_u32 m0, s47, 45056
  s_nop 0
  buffer_load_dwordx4 v212, s[24:27], s71 offen lds
  v_mfma_f32_16x16x32_bf16 v[200:203], a[8:11], v[72:75], v[200:203]
  ds_read_b64_tr_b16 a[4:5], v240 offset:38912
  ds_read_b64_tr_b16 a[6:7], v240 offset:40448
  v_mfma_f32_16x16x32_bf16 v[204:207], a[8:11], v[76:79], v[204:207]
  s_waitcnt lgkmcnt(8)
  s_add_u32 m0, s47, 61440
  s_add_u32 s71, s70, 442368
  buffer_load_dwordx4 v208, s[24:27], s71 offen lds
  v_mfma_f32_16x16x32_bf16 a[48:51], a[12:15], v[244:247], a[48:51]
  ds_read_b64_tr_b16 a[8:9], v252 offset:55296
  ds_read_b64_tr_b16 a[10:11], v252 offset:56832
  s_waitcnt lgkmcnt(8)
  s_add_u32 m0, s47, 62464
  s_nop 0
  buffer_load_dwordx4 v209, s[24:27], s71 offen lds
  v_mfma_f32_16x16x32_bf16 v[184:187], a[16:19], v[80:83], v[184:187]
  ds_read_b64_tr_b16 a[12:13], v252 offset:55328
  ds_read_b64_tr_b16 a[14:15], v252 offset:56864
  v_mfma_f32_16x16x32_bf16 v[188:191], a[16:19], v[84:87], v[188:191]
  s_waitcnt lgkmcnt(8)
  s_add_u32 m0, s47, 63488
  s_nop 0
  buffer_load_dwordx4 v210, s[24:27], s71 offen lds
  v_mfma_f32_16x16x32_bf16 v[192:195], a[20:23], v[80:83], v[192:195]
  ds_read_b64_tr_b16 a[16:17], v252 offset:55360
  ds_read_b64_tr_b16 a[18:19], v252 offset:56896
  v_mfma_f32_16x16x32_bf16 v[196:199], a[20:23], v[84:87], v[196:199]
  s_waitcnt lgkmcnt(8)
  s_add_u32 m0, s47, 64512
  s_nop 0
  buffer_load_dwordx4 v211, s[24:27], s71 offen lds
  v_mfma_f32_16x16x32_bf16 v[200:203], a[0:3], v[80:83], v[200:203]
  ds_read_b64_tr_b16 a[20:21], v240 offset:55296
  ds_read_b64_tr_b16 a[22:23], v240 offset:56832
  v_mfma_f32_16x16x32_bf16 v[204:207], a[0:3], v[84:87], v[204:207]
  s_waitcnt lgkmcnt(8)
  s_add_u32 m0, s47, 65536
  s_nop 0
  buffer_load_dwordx4 v212, s[24:27], s71 offen lds
  v_mfma_f32_16x16x32_bf16 a[48:51], a[4:7], v[244:247], a[48:51]
  ds_read_b64_tr_b16 a[0:1], v252 offset:9216
  ds_read_b64_tr_b16 a[2:3], v252 offset:10752
  s_waitcnt lgkmcnt(8)
  s_cmp_lt_u32 s32, 2
  s_cbranch_scc0 K1_noo4
  s_add_u32 m0, s47, 81920
  s_add_u32 s71, s70, 589824
  buffer_load_dwordx4 v208, s[24:27], s71 offen lds
  s_add_u32 m0, s47, 82944
  s_nop 0
  buffer_load_dwordx4 v209, s[24:27], s71 offen lds
  s_add_u32 m0, s47, 83968
  s_nop 0
  buffer_load_dwordx4 v210, s[24:27], s71 offen lds
  s_add_u32 m0, s47, 84992
  s_nop 0
  buffer_load_dwordx4 v211, s[24:27], s71 offen lds
  s_add_u32 m0, s47, 86016
  s_nop 0
  buffer_load_dwordx4 v212, s[24:27], s71 offen lds
K1_noo4:
  v_mfma_f32_16x16x32_bf16 v[184:187], a[8:11], v[88:91], v[184:187]
  ds_read_b64_tr_b16 a[4:5], v252 offset:9248
  ds_read_b64_tr_b16 a[6:7], v252 offset:10784
  v_mfma_f32_16x16x32_bf16 v[188:191], a[8:11], v[92:95], v[188:191]
  s_waitcnt lgkmcnt(8)
  s_and_b32 s64, s2, 7
  s_lshl_b32 s64, s64, 2
  v_mfma_f32_16x16x32_bf16 v[192:195], a[12:15], v[88:91], v[192:195]
  ds_read_b64_tr_b16 a[8:9], v252 offset:9280
  ds_read_b64_tr_b16 a[10:11], v252 offset:10816
  v_mfma_f32_16x16x32_bf16 v[196:199], a[12:15], v[92:95], v[196:199]
  s_waitcnt lgkmcnt(8)
  s_bfe_u32 s71, s2, 0x20003
  s_add_u32 s64, s64, s71
  v_mfma_f32_16x16x32_bf16 v[200:203], a[16:19], v[88:91], v[200:203]
  ds_read_b64_tr_b16 a[12:13], v240 offset:9216
  ds_read_b64_tr_b16 a[14:15], v240 offset:10752
  v_mfma_f32_16x16x32_bf16 v[204:207], a[16:19], v[92:95], v[204:207]
  s_waitcnt lgkmcnt(8)
  s_lshl_b32 s66, s64, 2
  s_add_u32 s66, s66, s32
  v_mfma_f32_16x16x32_bf16 a[48:51], a[20:23], v[244:247], a[48:51]
  ds_read_b64_tr_b16 a[16:17], v252 offset:25600
  ds_read_b64_tr_b16 a[18:19], v252 offset:27136
  s_waitcnt lgkmcnt(8)
  s_mul_i32 s71, s66, 18432
  s_add_u32 s71, s71, s6
  v_mfma_f32_16x16x32_bf16 v[184:187], a[0:3], v[96:99], v[184:187]
  ds_read_b64_tr_b16 a[20:21], v252 offset:25632
  ds_read_b64_tr_b16 a[22:23], v252 offset:27168
  v_mfma_f32_16x16x32_bf16 v[188:191], a[0:3], v[100:103], v[188:191]
  s_waitcnt lgkmcnt(8)
  v_mul_u32_u24 v170, s3, v219
  v_lshl_add_u32 v170, v220, 3, v170
  v_mfma_f32_16x16x32_bf16 v[192:195], a[4:7], v[96:99], v[192:195]
  ds_read_b64_tr_b16 a[0:1], v252 offset:25664
  ds_read_b64_tr_b16 a[2:3], v252 offset:27200
  v_mfma_f32_16x16x32_bf16 v[196:199], a[4:7], v[100:103], v[196:199]
  s_waitcnt lgkmcnt(8)
  buffer_load_dwordx2 a[110:111], v170, s[16:19], s71 offen offset:0
  v_mfma_f32_16x16x32_bf16 v[200:203], a[8:11], v[96:99], v[200:203]
  ds_read_b64_tr_b16 a[4:5], v240 offset:25600
  ds_read_b64_tr_b16 a[6:7], v240 offset:27136
  v_mfma_f32_16x16x32_bf16 v[204:207], a[8:11], v[100:103], v[204:207]
  s_waitcnt lgkmcnt(8)
  buffer_load_dwordx2 a[112:113], v170, s[16:19], s71 offen offset:32
  v_mfma_f32_16x16x32_bf16 a[48:51], a[12:15], v[244:247], a[48:51]
  ds_read_b64_tr_b16 a[8:9], v252 offset:41984
  ds_read_b64_tr_b16 a[10:11], v252 offset:43520
  s_waitcnt lgkmcnt(8)
  buffer_load_dwordx2 a[114:115], v170, s[16:19], s71 offen offset:64
  v_mfma_f32_16x16x32_bf16 v[184:187], a[16:19], v[104:107], v[184:187]
  ds_read_b64_tr_b16 a[12:13], v252 offset:42016
  ds_read_b64_tr_b16 a[14:15], v252 offset:43552
  v_mfma_f32_16x16x32_bf16 v[188:191], a[16:19], v[108:111], v[188:191]
  s_waitcnt lgkmcnt(8)
  buffer_load_dwordx2 a[116:117], v170, s[16:19], s71 offen offset:96
  v_mfma_f32_16x16x32_bf16 v[192:195], a[20:23], v[104:107], v[192:195]
  ds_read_b64_tr_b16 a[16:17], v252 offset:42048
  ds_read_b64_tr_b16 a[18:19], v252 offset:43584
  v_mfma_f32_16x16x32_bf16 v[196:199], a[20:23], v[108:111], v[196:199]
  s_waitcnt lgkmcnt(8)
  buffer_load_dwordx2 a[118:119], v170, s[16:19], s71 offen offset:128
  v_mfma_f32_16x16x32_bf16 v[200:203], a[0:3], v[104:107], v[200:203]
  ds_read_b64_tr_b16 a[20:21], v240 offset:41984
  ds_read_b64_tr_b16 a[22:23], v240 offset:43520
  v_mfma_f32_16x16x32_bf16 v[204:207], a[0:3], v[108:111], v[204:207]
  s_waitcnt lgkmcnt(8)
  s_cmp_eq_u32 s32, 3
  s_cbranch_scc0 K1_nopfc
  s_mov_b32 s30, 5308416
  s_mov_b32 s31, 0x20000
  s_mov_b32 s28, s82
  s_mov_b32 s29, s83
  s_mul_i32 s72, s2, 20736
  v_lshlrev_b32 v171, 7, v218
  s_add_u32 s73, s72, 0
  buffer_load_dword a40, v171, s[28:31], s73 offen
  s_add_u32 s73, s72, 8192
  buffer_load_dword a40, v171, s[28:31], s73 offen
  s_add_u32 s73, s72, 12544
  buffer_load_dword a40, v171, s[28:31], s73 offen
K1_nopfc:
  v_mfma_f32_16x16x32_bf16 a[48:51], a[4:7], v[244:247], a[48:51]
  ds_read_b64_tr_b16 a[0:1], v252 offset:58368
  ds_read_b64_tr_b16 a[2:3], v252 offset:59904
  s_waitcnt lgkmcnt(8)
  v_mfma_f32_16x16x32_bf16 v[184:187], a[8:11], v[112:115], v[184:187]
  ds_read_b64_tr_b16 a[4:5], v252 offset:58400
  ds_read_b64_tr_b16 a[6:7], v252 offset:59936
  v_mfma_f32_16x16x32_bf16 v[188:191], a[8:11], v[116:119], v[188:191]
  s_waitcnt lgkmcnt(8)
  v_mfma_f32_16x16x32_bf16 v[192:195], a[12:15], v[112:115], v[192:195]
  ds_read_b64_tr_b16 a[8:9], v252 offset:58432
  ds_read_b64_tr_b16 a[10:11], v252 offset:59968
  v_mfma_f32_16x16x32_bf16 v[196:199], a[12:15], v[116:119], v[196:199]
  s_waitcnt lgkmcnt(8)
  v_mfma_f32_16x16x32_bf16 v[200:203], a[16:19], v[112:115], v[200:203]
  ds_read_b64_tr_b16 a[12:13], v240 offset:58368
  ds_read_b64_tr_b16 a[14:15], v240 offset:59904
  v_mfma_f32_16x16x32_bf16 v[204:207], a[16:19], v[116:119], v[204:207]
  s_waitcnt lgkmcnt(8)
  v_mfma_f32_16x16x32_bf16 a[48:51], a[20:23], v[244:247], a[48:51]
  ds_read_b64_tr_b16 a[16:17], v252 offset:12288
  ds_read_b64_tr_b16 a[18:19], v252 offset:13824
  s_waitcnt lgkmcnt(8)
  v_mfma_f32_16x16x32_bf16 v[184:187], a[0:3], v[120:123], v[184:187]
  ds_read_b64_tr_b16 a[20:21], v252 offset:12320
  ds_read_b64_tr_b16 a[22:23], v252 offset:13856
  v_mfma_f32_16x16x32_bf16 v[188:191], a[0:3], v[124:127], v[188:191]
  s_waitcnt lgkmcnt(8)
  v_mfma_f32_16x16x32_bf16 v[192:195], a[4:7], v[120:123], v[192:195]
  ds_read_b64_tr_b16 a[0:1], v252 offset:12352
  ds_read_b64_tr_b16 a[2:3], v252 offset:13888
  v_mfma_f32_16x16x32_bf16 v[196:199], a[4:7], v[124:127], v[196:199]
  s_waitcnt lgkmcnt(8)
  v_mfma_f32_16x16x32_bf16 v[200:203], a[8:11], v[120:123], v[200:203]
  ds_read_b64_tr_b16 a[4:5], v240 offset:12288
  ds_read_b64_tr_b16 a[6:7], v240 offset:13824
  v_mfma_f32_16x16x32_bf16 v[204:207], a[8:11], v[124:127], v[204:207]
  s_waitcnt lgkmcnt(8)
  v_mfma_f32_16x16x32_bf16 a[48:51], a[12:15], v[244:247], a[48:51]
  ds_read_b64_tr_b16 a[8:9], v252 offset:28672
  ds_read_b64_tr_b16 a[10:11], v252 offset:30208
  s_waitcnt lgkmcnt(8)
  v_mfma_f32_16x16x32_bf16 v[184:187], a[16:19], v[128:131], v[184:187]
  ds_read_b64_tr_b16 a[12:13], v252 offset:28704
  ds_read_b64_tr_b16 a[14:15], v252 offset:30240
  v_mfma_f32_16x16x32_bf16 v[188:191], a[16:19], v[132:135], v[188:191]
  s_waitcnt lgkmcnt(8)
  v_mfma_f32_16x16x32_bf16 v[192:195], a[20:23], v[128:131], v[192:195]
  ds_read_b64_tr_b16 a[16:17], v252 offset:28736
  ds_read_b64_tr_b16 a[18:19], v252 offset:30272
  v_mfma_f32_16x16x32_bf16 v[196:199], a[20:23], v[132:135], v[196:199]
  s_waitcnt lgkmcnt(8)
  v_mfma_f32_16x16x32_bf16 v[200:203], a[0:3], v[128:131], v[200:203]
  ds_read_b64_tr_b16 a[20:21], v240 offset:28672
  ds_read_b64_tr_b16 a[22:23], v240 offset:30208
  v_mfma_f32_16x16x32_bf16 v[204:207], a[0:3], v[132:135], v[204:207]
  s_waitcnt lgkmcnt(8)
  v_mfma_f32_16x16x32_bf16 a[48:51], a[4:7], v[244:247], a[48:51]
  s_waitcnt lgkmcnt(6)
  v_mfma_f32_16x16x32_bf16 v[184:187], a[8:11], v[136:139], v[184:187]
  v_mfma_f32_16x16x32_bf16 v[188:191], a[8:11], v[140:143], v[188:191]
  s_waitcnt lgkmcnt(4)
  v_mfma_f32_16x16x32_bf16 v[192:195], a[12:15], v[136:139], v[192:195]
  v_mfma_f32_16x16x32_bf16 v[196:199], a[12:15], v[140:143], v[196:199]
  s_waitcnt lgkmcnt(2)
  v_mfma_f32_16x16x32_bf16 v[200:203], a[16:19], v[136:139], v[200:203]
  v_mfma_f32_16x16x32_bf16 v[204:207], a[16:19], v[140:143], v[204:207]
  s_waitcnt lgkmcnt(0)
  v_mfma_f32_16x16x32_bf16 a[48:51], a[20:23], v[244:247], a[48:51]
  v_lshlrev_b32 v160, 4, v220
  v_add_u32 v160, 158976, v160
  v_mul_f32 v208, 0x3fb8aa3b, v224
  v_mul_f32 v209, 0x3fb8aa3b, v225
  s_nop 3
  ds_write_b128 v253, a[48:51] offset:256
  s_waitcnt lgkmcnt(0)
  s_barrier
  ds_read_b128 v[172:175], v160 offset:0
  ds_read_b128 v[176:179], v160 offset:64
  ds_read_b128 v[180:183], v160 offset:128
  v_add_u32 v165, 147456, v221
  ds_write_b128 v165, a[44:47] offset:0
  ds_write_b128 v165, a[44:47] offset:3072
  v_lshlrev_b32 v161, 3, v220
  v_add_u32 v235, 153600, v161
  v_lshl_add_u32 v234, v219, 7, v161
  v_add_u32 v234, 147456, v234
  v_lshlrev_b32 v161, 3, v230
  v_lshl_add_u32 v227, v227, 7, v161
  v_add_u32 v227, 147456, v227
  v_cmp_eq_u32 vcc, 4, v230
  v_subrev_u32 v161, 1, v228
  v_sub_u32 v162, 0, v228
  v_cndmask_b32 v228, -1, v161, vcc
  v_cndmask_b32 v229, -1, v162, vcc
  s_mul_i32 s43, s33, 36
  v_lshl_add_u32 v161, v220, 2, s43
  v_lshrrev_b32 v162, 5, v161
  v_lshlrev_b32 v162, 10, v162
  v_bfe_u32 v163, v161, 2, 2
  v_lshl_add_u32 v162, v163, 8, v162
  v_bfe_u32 v163, v161, 4, 1
  v_lshl_add_u32 v162, v163, 3, v162
  v_lshl_add_u32 v230, v219, 4, v162
  v_add_u32 v161, 16, v161
  v_lshrrev_b32 v162, 5, v161
  v_lshlrev_b32 v162, 10, v162
  v_bfe_u32 v163, v161, 2, 2
  v_lshl_add_u32 v162, v163, 8, v162
  v_bfe_u32 v163, v161, 4, 1
  v_lshl_add_u32 v162, v163, 3, v162
  v_lshl_add_u32 v231, v219, 4, v162
  v_add_u32 v161, 16, v161
  v_lshrrev_b32 v162, 5, v161
  v_lshlrev_b32 v162, 10, v162
  v_bfe_u32 v163, v161, 2, 2
  v_lshl_add_u32 v162, v163, 8, v162
  v_bfe_u32 v163, v161, 4, 1
  v_lshl_add_u32 v162, v163, 3, v162
  v_lshl_add_u32 v232, v219, 4, v162
  v_and_b32 v161, 268435456, v238
  v_add_u32 v232, v232, v161
  s_waitcnt lgkmcnt(0)
  v_fma_f32 v184, -v222, v172, v184
  v_mul_f32 v248, v184, v208
  v_exp_f32 v248, v248
  v_fma_f32 v249, v184, v224, 1.0
  v_med3_f32 v248, v248, v249, 1.0
  v_add_f32 v248, 0x358637bd, v248
  v_fma_f32 v185, -v222, v173, v185
  v_mul_f32 v250, v185, v208
  v_exp_f32 v250, v250
  v_fma_f32 v251, v185, v224, 1.0
  v_med3_f32 v250, v250, v251, 1.0
  v_add_f32 v250, 0x358637bd, v250
  v_cvt_pk_bf16_f32 v144, v248, v250
  v_fma_f32 v186, -v222, v174, v186
  v_mul_f32 v240, v186, v208
  v_exp_f32 v240, v240
  v_fma_f32 v241, v186, v224, 1.0
  v_med3_f32 v240, v240, v241, 1.0
  v_add_f32 v240, 0x358637bd, v240
  v_fma_f32 v187, -v222, v175, v187
  v_mul_f32 v254, v187, v208
  v_exp_f32 v254, v254
  v_fma_f32 v255, v187, v224, 1.0
  v_med3_f32 v254, v254, v255, 1.0
  v_add_f32 v254, 0x358637bd, v254
  v_cvt_pk_bf16_f32 v145, v240, v254
  v_fma_f32 v192, -v222, v176, v192
  v_mul_f32 v248, v192, v208
  v_exp_f32 v248, v248
  v_fma_f32 v249, v192, v224, 1.0
  v_med3_f32 v248, v248, v249, 1.0
  v_add_f32 v248, 0x358637bd, v248
  v_fma_f32 v193, -v222, v177, v193
  v_mul_f32 v250, v193, v208
  v_exp_f32 v250, v250
  v_fma_f32 v251, v193, v224, 1.0
  v_med3_f32 v250, v250, v251, 1.0
  v_add_f32 v250, 0x358637bd, v250
  v_cvt_pk_bf16_f32 v146, v248, v250
  v_fma_f32 v194, -v222, v178, v194
  v_mul_f32 v240, v194, v208
  v_exp_f32 v240, v240
  v_fma_f32 v241, v194, v224, 1.0
  v_med3_f32 v240, v240, v241, 1.0
  v_add_f32 v240, 0x358637bd, v240
  v_fma_f32 v195, -v222, v179, v195
  v_mul_f32 v254, v195, v208
  v_exp_f32 v254, v254
  v_fma_f32 v255, v195, v224, 1.0
  v_med3_f32 v254, v254, v255, 1.0
  v_add_f32 v254, 0x358637bd, v254
  v_cvt_pk_bf16_f32 v147, v240, v254
  v_fma_f32 v200, -v222, v180, v200
  v_mul_f32 v248, v200, v208
  v_exp_f32 v248, v248
  v_fma_f32 v249, v200, v224, 1.0
  v_med3_f32 v248, v248, v249, 1.0
  v_add_f32 v248, 0x358637bd, v248
  v_fma_f32 v201, -v222, v181, v201
  v_mul_f32 v250, v201, v208
  v_exp_f32 v250, v250
  v_fma_f32 v251, v201, v224, 1.0
  v_med3_f32 v250, v250, v251, 1.0
  v_add_f32 v250, 0x358637bd, v250
  v_cvt_pk_bf16_f32 v148, v248, v250
  v_fma_f32 v202, -v222, v182, v202
  v_mul_f32 v240, v202, v208
  v_exp_f32 v240, v240
  v_fma_f32 v241, v202, v224, 1.0
  v_med3_f32 v240, v240, v241, 1.0
  v_add_f32 v240, 0x358637bd, v240
  v_fma_f32 v203, -v222, v183, v203
  v_mul_f32 v254, v203, v208
  v_exp_f32 v254, v254
  v_fma_f32 v255, v203, v224, 1.0
  v_med3_f32 v254, v254, v255, 1.0
  v_add_f32 v254, 0x358637bd, v254
  v_cvt_pk_bf16_f32 v149, v240, v254
  v_mov_b32 v150, 0
  v_mov_b32 v151, 0
  v_fma_f32 v188, -v223, v172, v188
  v_mul_f32 v248, v188, v209
  v_exp_f32 v248, v248
  v_fma_f32 v249, v188, v225, 1.0
  v_med3_f32 v248, v248, v249, 1.0
  v_add_f32 v248, 0x358637bd, v248
  v_fma_f32 v189, -v223, v173, v189
  v_mul_f32 v250, v189, v209
  v_exp_f32 v250, v250
  v_fma_f32 v251, v189, v225, 1.0
  v_med3_f32 v250, v250, v251, 1.0
  v_add_f32 v250, 0x358637bd, v250
  v_cvt_pk_bf16_f32 v152, v248, v250
  v_fma_f32 v190, -v223, v174, v190
  v_mul_f32 v240, v190, v209
  v_exp_f32 v240, v240
  v_fma_f32 v241, v190, v225, 1.0
  v_med3_f32 v240, v240, v241, 1.0
  v_add_f32 v240, 0x358637bd, v240
  v_fma_f32 v191, -v223, v175, v191
  v_mul_f32 v254, v191, v209
  v_exp_f32 v254, v254
  v_fma_f32 v255, v191, v225, 1.0
  v_med3_f32 v254, v254, v255, 1.0
  v_add_f32 v254, 0x358637bd, v254
  v_cvt_pk_bf16_f32 v153, v240, v254
  v_fma_f32 v196, -v223, v176, v196
  v_mul_f32 v248, v196, v209
  v_exp_f32 v248, v248
  v_fma_f32 v249, v196, v225, 1.0
  v_med3_f32 v248, v248, v249, 1.0
  v_add_f32 v248, 0x358637bd, v248
  v_fma_f32 v197, -v223, v177, v197
  v_mul_f32 v250, v197, v209
  v_exp_f32 v250, v250
  v_fma_f32 v251, v197, v225, 1.0
  v_med3_f32 v250, v250, v251, 1.0
  v_add_f32 v250, 0x358637bd, v250
  v_cvt_pk_bf16_f32 v154, v248, v250
  v_fma_f32 v198, -v223, v178, v198
  v_mul_f32 v240, v198, v209
  v_exp_f32 v240, v240
  v_fma_f32 v241, v198, v225, 1.0
  v_med3_f32 v240, v240, v241, 1.0
  v_add_f32 v240, 0x358637bd, v240
  v_fma_f32 v199, -v223, v179, v199
  v_mul_f32 v254, v199, v209
  v_exp_f32 v254, v254
  v_fma_f32 v255, v199, v225, 1.0
  v_med3_f32 v254, v254, v255, 1.0
  v_add_f32 v254, 0x358637bd, v254
  v_cvt_pk_bf16_f32 v155, v240, v254
  v_fma_f32 v204, -v223, v180, v204
  v_mul_f32 v248, v204, v209
  v_exp_f32 v248, v248
  v_fma_f32 v249, v204, v225, 1.0
  v_med3_f32 v248, v248, v249, 1.0
  v_add_f32 v248, 0x358637bd, v248
  v_fma_f32 v205, -v223, v181, v205
  v_mul_f32 v250, v205, v209
  v_exp_f32 v250, v250
  v_fma_f32 v251, v205, v225, 1.0
  v_med3_f32 v250, v250, v251, 1.0
  v_add_f32 v250, 0x358637bd, v250
  v_cvt_pk_bf16_f32 v156, v248, v250
  v_fma_f32 v206, -v223, v182, v206
  v_mul_f32 v240, v206, v209
  v_exp_f32 v240, v240
  v_fma_f32 v241, v206, v225, 1.0
  v_med3_f32 v240, v240, v241, 1.0
  v_add_f32 v240, 0x358637bd, v240
  v_fma_f32 v207, -v223, v183, v207
  v_mul_f32 v254, v207, v209
  v_exp_f32 v254, v254
  v_fma_f32 v255, v207, v225, 1.0
  v_med3_f32 v254, v254, v255, 1.0
  v_add_f32 v254, 0x358637bd, v254
  v_cvt_pk_bf16_f32 v157, v240, v254
  v_mov_b32 v158, 0
  v_mov_b32 v159, 0
  s_cmp_eq_u32 s32, 0
  s_cbranch_scc0 K1_polled
  v_lshlrev_b32 v169, 2, v219
  s_branch K1_poll0
K1_poll:
  s_sleep 2
K1_poll0:
  buffer_load_dword v168, v169, s[12:15], s5 offen sc1
  s_waitcnt vmcnt(0)
  v_cmp_ne_u32 vcc, s100, v168
  s_cmp_eq_u64 vcc, 0
  s_cbranch_scc0 K1_poll
K1_polled:
  s_barrier
  s_cmp_eq_u32 s32, 3
  s_cbranch_scc1 K1_now
  buffer_load_dwordx4 v[0:3], v237, s[12:15], s39 offen sc1
  s_add_u32 s39, s39, 3072
  buffer_load_dwordx4 v[4:7], v237, s[12:15], s39 offen sc1
  s_add_u32 s39, s39, 3072
  buffer_load_dwordx4 v[8:11], v237, s[12:15], s39 offen sc1
  s_add_u32 s39, s39, 3072
  buffer_load_dwordx4 v[12:15], v237, s[12:15], s39 offen sc1
  s_add_u32 s39, s39, 3072
  buffer_load_dwordx4 v[16:19], v237, s[12:15], s39 offen sc1
  s_add_u32 s39, s39, 3072
  buffer_load_dwordx4 v[20:23], v237, s[12:15], s39 offen sc1
  s_add_u32 s39, s39, 3072
  buffer_load_dwordx4 v[24:27], v237, s[12:15], s39 offen sc1
  s_add_u32 s39, s39, 3072
  buffer_load_dwordx4 v[28:31], v237, s[12:15], s39 offen sc1
  s_add_u32 s39, s39, 3072
  buffer_load_dwordx4 v[32:35], v237, s[12:15], s39 offen sc1
  s_add_u32 s39, s39, 3072
  buffer_load_dwordx4 v[36:39], v237, s[12:15], s39 offen sc1
  s_add_u32 s39, s39, 3072
  buffer_load_dwordx4 v[40:43], v237, s[12:15], s39 offen sc1
  s_add_u32 s39, s39, 3072
  buffer_load_dwordx4 v[44:47], v237, s[12:15], s39 offen sc1
  s_add_u32 s39, s39, 3072
  buffer_load_dwordx4 v[48:51], v237, s[12:15], s39 offen sc1
  s_add_u32 s39, s39, 3072
  buffer_load_dwordx4 v[52:55], v237, s[12:15], s39 offen sc1
  s_add_u32 s39, s39, 3072
  buffer_load_dwordx4 v[56:59], v237, s[12:15], s39 offen sc1
  s_add_u32 s39, s39, 3072
  buffer_load_dwordx4 v[60:63], v237, s[12:15], s39 offen sc1
  s_waitcnt vmcnt(13)
  v_add_f32 v0, v0, v4
  v_add_f32 v1, v1, v5
  v_add_f32 v2, v2, v6
  v_add_f32 v3, v3, v7
  v_add_f32 v0, v0, v8
  v_add_f32 v1, v1, v9
  v_add_f32 v2, v2, v10
  v_add_f32 v3, v3, v11
  s_waitcnt vmcnt(11)
  v_add_f32 v0, v0, v12
  v_add_f32 v1, v1, v13
  v_add_f32 v2, v2, v14
  v_add_f32 v3, v3, v15
  v_add_f32 v0, v0, v16
  v_add_f32 v1, v1, v17
  v_add_f32 v2, v2, v18
  v_add_f32 v3, v3, v19
  s_waitcnt vmcnt(9)
  v_add_f32 v0, v0, v20
  v_add_f32 v1, v1, v21
  v_add_f32 v2, v2, v22
  v_add_f32 v3, v3, v23
  v_add_f32 v0, v0, v24
  v_add_f32 v1, v1, v25
  v_add_f32 v2, v2, v26
  v_add_f32 v3, v3, v27
  s_waitcnt vmcnt(7)
  v_add_f32 v0, v0, v28
  v_add_f32 v1, v1, v29
  v_add_f32 v2, v2, v30
  v_add_f32 v3, v3, v31
  v_add_f32 v0, v0, v32
  v_add_f32 v1, v1, v33
  v_add_f32 v2, v2, v34
  v_add_f32 v3, v3, v35
  s_waitcnt vmcnt(5)
  v_add_f32 v0, v0, v36
  v_add_f32 v1, v1, v37
  v_add_f32 v2, v2, v38
  v_add_f32 v3, v3, v39
  v_add_f32 v0, v0, v40
  v_add_f32 v1, v1, v41
  v_add_f32 v2, v2, v42
  v_add_f32 v3, v3, v43
  s_waitcnt vmcnt(3)
  v_add_f32 v0, v0, v44
  v_add_f32 v1, v1, v45
  v_add_f32 v2, v2, v46
  v_add_f32 v3, v3, v47
  v_add_f32 v0, v0, v48
  v_add_f32 v1, v1, v49
  v_add_f32 v2, v2, v50
  v_add_f32 v3, v3, v51
  s_waitcnt vmcnt(1)
  v_add_f32 v0, v0, v52
  v_add_f32 v1, v1, v53
  v_add_f32 v2, v2, v54
  v_add_f32 v3, v3, v55
  v_add_f32 v0, v0, v56
  v_add_f32 v1, v1, v57
  v_add_f32 v2, v2, v58
  v_add_f32 v3, v3, v59
  s_waitcnt vmcnt(0)
  v_add_f32 v0, v0, v60
  v_add_f32 v1, v1, v61
  v_add_f32 v2, v2, v62
  v_add_f32 v3, v3, v63
  v_cvt_pk_bf16_f32 v4, v0, v1
  v_cvt_pk_bf16_f32 v5, v2, v3
  v_cmp_gt_u32 vcc, 3040, v221
  v_and_b32 v4, v4, v228
  v_and_b32 v5, v5, v229
  s_and_saveexec_b64 s[6:7], vcc
  ds_write_b64 v227, v[4:5]
  s_mov_b64 exec, s[6:7]
K1_now:
  s_waitcnt lgkmcnt(0)
  s_barrier
  ds_read_b64 v[88:89], v235 offset:0
  ds_read_b64 v[90:91], v235 offset:32
  ds_read_b64 v[96:97], v235 offset:128
  ds_read_b64 v[98:99], v235 offset:160
  ds_read_b64 v[64:65], v234 offset:0
  ds_read_b64 v[66:67], v234 offset:32
  ds_read_b64 v[72:73], v234 offset:2048
  ds_read_b64 v[74:75], v234 offset:2080
  ds_read_b64 v[80:81], v234 offset:4096
  ds_read_b64 v[82:83], v234 offset:4128
  ds_read_b64 v[92:93], v235 offset:64
  ds_read_b64 v[94:95], v235 offset:96
  ds_read_b64 v[100:101], v235 offset:192
  ds_read_b64 v[102:103], v235 offset:224
  ds_read_b64 v[68:69], v234 offset:64
  ds_read_b64 v[70:71], v234 offset:96
  ds_read_b64 v[76:77], v234 offset:2112
  ds_read_b64 v[78:79], v234 offset:2144
  ds_read_b64 v[84:85], v234 offset:4160
  ds_read_b64 v[86:87], v234 offset:4192
  s_lshl_b32 s5, s37, 1
  s_mul_i32 s5, s5, 18432
  s_add_u32 s5, s5, 3145728
  s_add_u32 s6, s5, 18432
  v_cmp_eq_u32 vcc, 0, v220
  s_waitcnt lgkmcnt(10)
  v_mfma_f32_16x16x32_bf16 v[128:131], v[88:91], v[144:147], 0
  v_mfma_f32_16x16x32_bf16 v[132:135], v[88:91], v[152:155], 0
  v_mfma_f32_16x16x32_bf16 v[136:139], v[96:99], v[144:147], 0
  v_mfma_f32_16x16x32_bf16 v[140:143], v[96:99], v[152:155], 0
  v_mfma_f32_16x16x32_bf16 v[104:107], v[64:67], v[144:147], 0
  v_mfma_f32_16x16x32_bf16 v[108:111], v[64:67], v[152:155], 0
  v_mfma_f32_16x16x32_bf16 v[112:115], v[72:75], v[144:147], 0
  v_mfma_f32_16x16x32_bf16 v[116:119], v[72:75], v[152:155], 0
  v_mfma_f32_16x16x32_bf16 v[120:123], v[80:83], v[144:147], 0
  v_mfma_f32_16x16x32_bf16 v[124:127], v[80:83], v[152:155], 0
  s_waitcnt lgkmcnt(0)
  v_mfma_f32_16x16x32_bf16 v[128:131], v[92:95], v[148:151], v[128:131]
  v_mfma_f32_16x16x32_bf16 v[132:135], v[92:95], v[156:159], v[132:135]
  v_mfma_f32_16x16x32_bf16 v[136:139], v[100:103], v[148:151], v[136:139]
  v_mfma_f32_16x16x32_bf16 v[140:143], v[100:103], v[156:159], v[140:143]
  v_mfma_f32_16x16x32_bf16 v[104:107], v[68:71], v[148:151], v[104:107]
  v_mfma_f32_16x16x32_bf16 v[108:111], v[68:71], v[156:159], v[108:111]
  v_mfma_f32_16x16x32_bf16 v[112:115], v[76:79], v[148:151], v[112:115]
  v_mfma_f32_16x16x32_bf16 v[116:119], v[76:79], v[156:159], v[116:119]
  v_mfma_f32_16x16x32_bf16 v[120:123], v[84:87], v[148:151], v[120:123]
  v_mfma_f32_16x16x32_bf16 v[124:127], v[84:87], v[156:159], v[124:127]
  s_nop 1
  v_add_f32 v128, 0x358637bd, v128
  v_rcp_f32 v160, v128
  v_add_f32 v136, 0x358637bd, v136
  v_rcp_f32 v161, v136
  v_add_f32 v132, 0x358637bd, v132
  v_rcp_f32 v163, v132
  v_add_f32 v140, 0x358637bd, v140
  v_rcp_f32 v164, v140
  s_nop 0
  v_cndmask_b32 v162, v161, v160, vcc
  v_cndmask_b32 v165, v164, v163, vcc
  v_mul_f32 v104, v104, v160
  v_mul_f32 v105, v105, v160
  v_mul_f32 v106, v106, v160
  v_mul_f32 v107, v107, v160
  v_cvt_pk_bf16_f32 v104, v104, v105
  v_cvt_pk_bf16_f32 v105, v106, v107
  buffer_store_dwordx2 v[104:105], v230, s[12:15], s5 offen sc1
  v_mul_f32 v112, v112, v162
  v_mul_f32 v113, v113, v162
  v_mul_f32 v114, v114, v161
  v_mul_f32 v115, v115, v161
  v_cvt_pk_bf16_f32 v112, v112, v113
  v_cvt_pk_bf16_f32 v113, v114, v115
  buffer_store_dwordx2 v[112:113], v231, s[12:15], s5 offen sc1
  v_mul_f32 v120, v120, v161
  v_mul_f32 v121, v121, v161
  v_mul_f32 v122, v122, v161
  v_mul_f32 v123, v123, v161
  v_cvt_pk_bf16_f32 v120, v120, v121
  v_cvt_pk_bf16_f32 v121, v122, v123
  buffer_store_dwordx2 v[120:121], v232, s[12:15], s5 offen sc1
  v_mul_f32 v108, v108, v163
  v_mul_f32 v109, v109, v163
  v_mul_f32 v110, v110, v163
  v_mul_f32 v111, v111, v163
  v_cvt_pk_bf16_f32 v108, v108, v109
  v_cvt_pk_bf16_f32 v109, v110, v111
  buffer_store_dwordx2 v[108:109], v230, s[12:15], s6 offen sc1
  v_mul_f32 v116, v116, v165
  v_mul_f32 v117, v117, v165
  v_mul_f32 v118, v118, v164
  v_mul_f32 v119, v119, v164
  v_cvt_pk_bf16_f32 v116, v116, v117
  v_cvt_pk_bf16_f32 v117, v118, v119
  buffer_store_dwordx2 v[116:117], v231, s[12:15], s6 offen sc1
  v_mul_f32 v124, v124, v164
  v_mul_f32 v125, v125, v164
  v_mul_f32 v126, v126, v164
  v_mul_f32 v127, v127, v164
  v_cvt_pk_bf16_f32 v124, v124, v125
  v_cvt_pk_bf16_f32 v125, v126, v127
  buffer_store_dwordx2 v[124:125], v232, s[12:15], s6 offen sc1
  s_lshl_b32 s67, s34, 7
  s_lshl_b32 s68, s33, 2
  s_add_u32 s67, s67, s68
  s_add_u32 s67, s67, 6440960
  s_cmp_eq_u32 s32, 0
  s_cselect_b32 s67, s67, 268435456
  s_load_dwordx4 s[48:51], s[0:1], 32
  s_load_dwordx4 s[52:55], s[0:1], 48
  v_accvgpr_read_b32 v0, a174
  v_lshrrev_b32 v177, 6, v0
  v_and_b32 v176, 63, v0
  s_and_b32 s30, s2, 3
  v_readfirstlane_b32 s25, v177
  s_bfe_u32 s31, s2, 0x10002
  s_lshr_b32 s3, s2, 5
  s_lshl_b32 s31, s31, 3
  s_add_u32 s31, s31, s3
  s_bfe_u32 s32, s2, 0x20003
  v_lshlrev_b32 v164, 4, v176
  v_lshrrev_b32 v179, 1, v176
  v_lshrrev_b32 v180, 4, v176
  v_xor_b32 v179, v179, v180
  v_and_b32 v179, 3, v179
  v_lshlrev_b32 v179, 5, v179
  v_and_b32 v180, 1, v176
  v_lshl_add_u32 v179, v180, 4, v179
  v_lshrrev_b32 v178, 3, v176
  s_movk_i32 s3, 9216
  v_mad_u32_u24 v144, v178, s3, v179
  s_movk_i32 s3, 1152
  v_mad_u32_u24 v148, v178, s3, v179
  v_add_u32 v145, 72704, v144
  v_add_u32 v146, 145408, v144
  v_add_u32 v147, 218112, v144
  s_lshl_b32 s4, s31, 2
  s_add_u32 s4, s4, s25
  s_mul_i32 s5, s4, 36864
  s_lshr_b32 s6, s25, 1
  s_mul_i32 s6, s6, 294912
  s_mul_i32 s7, s30, 2304
  s_add_u32 s6, s6, s7
  s_lshl_b32 s7, s32, 7
  s_add_u32 s20, s6, s7
  s_add_u32 s24, s20, 512
  s_lshl_b32 s21, s25, 12
  s_mov_b32 s27, 589824
  s_mov_b32 s28, 589824
  s_mov_b32 s29, 589824
  s_mov_b32 s10, 5308416
  s_mov_b32 s11, 0x20000
  s_bitcmp0_b32 s25, 0
  s_waitcnt lgkmcnt(0)
  s_cselect_b32 s8, s48, s50
  s_cselect_b32 s9, s49, s51
  s_mov_b32 s88, s5
  s_mov_b32 s89, s4
  v_add_u32 v149, 8192, v148
  v_add_u32 v150, 16384, v148
  v_add_u32 v151, 24576, v148
  s_mov_b32 s16, s52
  s_mov_b32 s17, s53
  s_mov_b32 s18, 5308416
  s_mov_b32 s19, 0x20000
  s_mov_b32 s56, s54
  s_mov_b32 s57, s55
  s_mov_b32 s58, 2359296
  s_mov_b32 s59, 0x20000
  v_lshrrev_b32 v180, 2, v176
  v_lshlrev_b32 v179, 7, v180
  v_bfe_u32 v180, v176, 3, 2
  v_lshl_add_u32 v179, v180, 5, v179
  v_and_b32 v180, 3, v176
  v_lshl_add_u32 v179, v180, 3, v179
  s_and_b32 s5, s30, 1
  s_lshl_b32 s5, s5, 6
  v_xor_b32 v152, s5, v179
  v_xor_b32 v155, 32, v152
  v_xor_b32 v158, 64, v152
  v_xor_b32 v161, 96, v152
  v_add_u32 v153, 49152, v152
  v_add_u32 v154, 98304, v152
  v_add_u32 v156, 49152, v155
  v_add_u32 v157, 98304, v155
  v_add_u32 v159, 49152, v158
  v_add_u32 v160, 98304, v158
  v_add_u32 v162, 49152, v161
  v_add_u32 v163, 98304, v161
  v_min_u32 v165, 1, v176
  v_lshlrev_b32 v165, 28, v165
  s_lshr_b32 s5, s2, 5
  s_lshr_b32 s3, s25, 1
  s_lshl_b32 s6, s5, 1
  s_add_u32 s3, s3, s6
  s_mul_i32 s3, s3, 36
  v_cmp_gt_u32 vcc, 36, v176
  v_add_u32 v179, s3, v176
  s_movk_i32 s3, 9216
  v_mul_lo_u32 v179, v179, s3
  v_mov_b32 v180, 268435456
  v_cndmask_b32 v188, v180, v179, vcc
  s_cmp_eq_u32 s32, 3
  s_cselect_b32 s6, 48, 32
  v_cmp_gt_u32 vcc, s6, v176
  v_and_b32 v179, 15, v176
  v_min_u32 v179, 11, v179
  s_movk_i32 s3, 1152
  v_mul_u32_u24 v179, s3, v179
  v_lshrrev_b32 v181, 4, v176
  v_lshl_add_u32 v179, v181, 7, v179
  v_cndmask_b32 v189, v180, v179, vcc
  s_mov_b32 s96, s8
  s_mov_b32 s97, s9
  s_mov_b32 s98, s10
  s_mov_b32 s99, s11
  s_mul_i32 s3, s30, 2304
  s_lshl_b32 s6, s32, 7
  s_add_u32 s3, s3, s6
  s_add_u32 s61, s3, 1024
  s_mul_i32 s5, s5, 12
  s_add_u32 s5, s5, s25
  s_mul_i32 s5, s5, 13824
  s_mul_i32 s3, s30, 1327104
  s_add_u32 s5, s5, s3
  s_lshl_b32 s6, s32, 8
  s_add_u32 s62, s5, s6
  s_lshl_b32 s3, s31, 2
  s_add_u32 s3, s3, s30
  s_lshl_b32 s5, s3, 7
  s_add_u32 s33, s5, 6422528
  s_lshl_b32 s5, s32, 2
  s_add_u32 s34, s33, s5
  s_cmp_eq_u32 s25, 0
  s_cselect_b32 s34, s34, 268435456
  s_mul_i32 s3, s3, 294912
  s_add_u32 s3, s3, 8388608
  s_add_u32 s92, s12, s3
  s_addc_u32 s93, s13, 0
  s_mov_b32 s94, 294912
  s_mov_b32 s95, 0x20000
  s_lshl_b32 s38, s25, 12
  s_mov_b32 s37, 0
  s_mov_b32 s43, 268435456
  s_lshl_b32 s5, s32, 14
  s_add_u32 s26, s38, s5
  s_mov_b32 s23, 268435456
  s_mov_b32 s35, 0
  s_xor_b32 s6, s25, s30
  s_lshr_b32 s5, s25, 1
  s_xor_b32 s5, s5, s30
  s_and_b32 s5, s5, 1
  s_lshr_b32 s7, s30, 1
  s_xor_b32 s7, s7, s25
  s_and_b32 s7, s7, 1
  s_mul_i32 s5, s5, 36864
  s_lshl_b32 s7, s7, 7
  s_add_u32 s5, s5, s7
  s_mul_i32 s3, s30, 1327104
  s_lshl_b32 s7, s32, 8
  s_add_u32 s3, s3, s7
  s_add_u32 s39, s3, s5
  s_and_b32 s7, s30, 1
  s_xor_b32 s7, s7, s25
  s_mul_i32 s7, s7, 36864
  s_add_u32 s7, s7, 256
  s_sub_u32 s5, s7, s5
  s_sub_u32 s6, s5, 73728
  s_sub_u32 s7, 147456, s5
  s_mov_b32 s40, 73728
  s_cmp_eq_u32 s32, 3
  s_cselect_b32 s41, s6, s40
  s_cselect_b32 s42, s7, s40
  s_cselect_b32 s60, 3, 2
  s_cmp_lt_u32 s32, 2
  s_cselect_b32 s22, 5, 4
  v_mov_b32 v178, s100
  s_waitcnt vmcnt(0)
  s_barrier
  buffer_store_dword v178, v165, s[12:15], s67 offen sc1
  s_add_u32 m0, s21, 98304
  s_nop 0
  buffer_load_dwordx4 v144, s[8:11], s20 offen offset:0 lds
  buffer_load_dwordx4 v145, s[8:11], s20 offen offset:1024 lds
  buffer_load_dwordx4 v146, s[8:11], s20 offen offset:2048 lds
  buffer_load_dwordx4 v147, s[8:11], s20 offen offset:3072 lds
  s_add_u32 s20, s20, s27
  s_add_u32 m0, s21, 114688
  s_nop 0
  buffer_load_dwordx4 v144, s[8:11], s20 offen offset:0 lds
  buffer_load_dwordx4 v145, s[8:11], s20 offen offset:1024 lds
  buffer_load_dwordx4 v146, s[8:11], s20 offen offset:2048 lds
  buffer_load_dwordx4 v147, s[8:11], s20 offen offset:3072 lds
  s_add_u32 s20, s20, s27
  s_add_u32 m0, s21, 131072
  s_nop 0
  buffer_load_dwordx4 v144, s[8:11], s20 offen offset:0 lds
  buffer_load_dwordx4 v145, s[8:11], s20 offen offset:1024 lds
  buffer_load_dwordx4 v146, s[8:11], s20 offen offset:2048 lds
  buffer_load_dwordx4 v147, s[8:11], s20 offen offset:3072 lds
  s_add_u32 s20, s20, s27
  v_lshrrev_b32 v116, 4, v164
  v_and_b32 v117, 15, v116
  v_lshrrev_b32 v118, 4, v116
  v_lshrrev_b32 v119, 2, v116
  v_mul_u32_u24 v96, 160, v119
  v_and_b32 v119, 3, v116
  v_lshl_add_u32 v96, v119, 3, v96
  v_add_u32 v97, 46080, v96
  v_lshlrev_b32 v98, 4, v118
  v_add_u32 v98, 92160, v98
  v_min_u32 v119, 1, v118
  v_lshlrev_b32 v119, 28, v119
  v_lshlrev_b32 v120, 2, v117
  v_add_u32 v99, v119, v120
  s_mul_i32 s3, s65, 72
  v_lshl_add_u32 v121, v118, 2, s3
  v_lshrrev_b32 v122, 5, v121
  v_lshlrev_b32 v122, 11, v122
  v_bfe_u32 v123, v121, 2, 2
  v_lshl_add_u32 v122, v123, 8, v122
  v_bfe_u32 v123, v121, 4, 1
  v_lshl_add_u32 v122, v123, 3, v122
  v_lshl_add_u32 v100, v117, 4, v122
  v_add_u32 v121, 16, v121
  v_lshrrev_b32 v122, 5, v121
  v_lshlrev_b32 v122, 11, v122
  v_bfe_u32 v123, v121, 2, 2
  v_lshl_add_u32 v122, v123, 8, v122
  v_bfe_u32 v123, v121, 4, 1
  v_lshl_add_u32 v122, v123, 3, v122
  v_lshl_add_u32 v101, v117, 4, v122
  v_add_u32 v121, 16, v121
  v_lshrrev_b32 v122, 5, v121
  v_lshlrev_b32 v122, 11, v122
  v_bfe_u32 v123, v121, 2, 2
  v_lshl_add_u32 v122, v123, 8, v122
  v_bfe_u32 v123, v121, 4, 1
  v_lshl_add_u32 v122, v123, 3, v122
  v_lshl_add_u32 v102, v117, 4, v122
  v_add_u32 v121, 16, v121
  v_lshrrev_b32 v122, 5, v121
  v_lshlrev_b32 v122, 11, v122
  v_bfe_u32 v123, v121, 2, 2
  v_lshl_add_u32 v122, v123, 8, v122
  v_bfe_u32 v123, v121, 4, 1
  v_lshl_add_u32 v122, v123, 3, v122
  v_lshl_add_u32 v103, v117, 4, v122
  v_add_u32 v121, 16, v121
  v_lshrrev_b32 v122, 5, v121
  v_lshlrev_b32 v122, 11, v122
  v_bfe_u32 v123, v121, 2, 2
  v_lshl_add_u32 v122, v123, 8, v122
  v_bfe_u32 v123, v121, 4, 1
  v_lshl_add_u32 v122, v123, 3, v122
  v_lshl_add_u32 v104, v117, 4, v122
  v_lshrrev_b32 v122, 1, v118
  v_lshlrev_b32 v122, 28, v122
  v_add_u32 v104, v104, v122
  v_cmp_gt_u32 s[70:71], 2, v118
  v_accvgpr_read_b32 v106, a110
  v_accvgpr_read_b32 v107, a111
  v_accvgpr_read_b32 v108, a112
  v_accvgpr_read_b32 v109, a113
  v_accvgpr_read_b32 v110, a114
  v_accvgpr_read_b32 v111, a115
  v_accvgpr_read_b32 v112, a116
  v_accvgpr_read_b32 v113, a117
  v_accvgpr_read_b32 v114, a118
  v_accvgpr_read_b32 v115, a119
  s_lshl_b32 s3, s25, 10
  v_add_u32 v124, s3, v164
  v_add_u32 v124, 92160, v124
  s_add_u32 s72, s3, 6389760
  s_mul_i32 s73, s66, 18432
  s_add_u32 s73, s73, 3145728
  s_lshl_b32 s74, s66, 6
  s_add_u32 s75, s74, 6299648
  s_lshr_b32 s76, s64, 1
  s_lshl_b32 s76, s76, 7
  s_add_u32 s5, s76, 6440960
  s_cmp_eq_u32 s25, 0
  s_cbranch_scc0 KB_of_done
  v_bfe_u32 v126, v164, 4, 4
  v_lshlrev_b32 v126, 2, v126
  s_branch KB_of_0
KB_of_again:
  s_sleep 2
KB_of_0:
  buffer_load_dword v125, v126, s[12:15], s5 offen sc1
  s_waitcnt vmcnt(0)
  v_cmp_ne_u32 vcc, s100, v125
  s_cmp_eq_u64 vcc, 0
  s_cbranch_scc0 KB_of_again
KB_of_done:
  s_barrier
  buffer_load_dwordx4 v[128:131], v164, s[12:15], s72 offen sc1
  buffer_load_dwordx4 v[0:3], v164, s[12:15], s73 offen offset:0 sc1
  buffer_load_dwordx4 v[4:7], v164, s[12:15], s73 offen offset:1024 sc1
  buffer_load_dwordx4 v[8:11], v164, s[12:15], s73 offen offset:2048 sc1
  buffer_load_dwordx4 v[12:15], v164, s[12:15], s73 offen offset:3072 sc1
  s_add_u32 s73, s73, 4096
  buffer_load_dwordx4 v[16:19], v164, s[12:15], s73 offen offset:0 sc1
  buffer_load_dwordx4 v[20:23], v164, s[12:15], s73 offen offset:1024 sc1
  buffer_load_dwordx4 v[24:27], v164, s[12:15], s73 offen offset:2048 sc1
  buffer_load_dwordx4 v[28:31], v164, s[12:15], s73 offen offset:3072 sc1
  s_add_u32 s73, s73, 4096
  buffer_load_dwordx4 v[32:35], v164, s[12:15], s73 offen offset:0 sc1
  buffer_load_dwordx4 v[36:39], v164, s[12:15], s73 offen offset:1024 sc1
  buffer_load_dwordx4 v[40:43], v164, s[12:15], s73 offen offset:2048 sc1
  buffer_load_dwordx4 v[44:47], v164, s[12:15], s73 offen offset:3072 sc1
  s_add_u32 s73, s73, 4096
  buffer_load_dwordx4 v[48:51], v164, s[12:15], s73 offen offset:0 sc1
  buffer_load_dwordx4 v[52:55], v164, s[12:15], s73 offen offset:1024 sc1
  buffer_load_dwordx4 v[56:59], v164, s[12:15], s73 offen offset:2048 sc1
  buffer_load_dwordx4 v[60:63], v164, s[12:15], s73 offen offset:3072 sc1
  s_add_u32 s73, s73, 4096
  buffer_load_dwordx4 v[64:67], v164, s[12:15], s73 offen offset:0 sc1
  buffer_load_dwordx4 v[68:71], v164, s[12:15], s73 offen offset:1024 sc1
  buffer_load_dword v105, v120, s[12:15], s75 offen sc1
  s_waitcnt vmcnt(19)
  ds_write_b128 v124, v[128:131]
  s_waitcnt lgkmcnt(0)
  s_barrier
  ds_read_b64_tr_b16 a[144:145], v96 offset:0
  ds_read_b64_tr_b16 a[146:147], v96 offset:2560
  ds_read_b64_tr_b16 a[148:149], v96 offset:32
  ds_read_b64_tr_b16 a[150:151], v96 offset:2592
  ds_read_b64_tr_b16 a[152:153], v96 offset:64
  ds_read_b64_tr_b16 a[154:155], v96 offset:2624
  ds_read_b64_tr_b16 a[156:157], v96 offset:96
  ds_read_b64_tr_b16 a[158:159], v96 offset:2656
  ds_read_b64_tr_b16 a[160:161], v96 offset:128
  ds_read_b64_tr_b16 a[162:163], v96 offset:2688
  s_waitcnt vmcnt(17) lgkmcnt(8)
  v_mfma_f32_16x16x32_bf16 v[72:75], a[144:147], v[0:3], 0
  ds_read_b128 a[164:167], v98 offset:0
  s_waitcnt lgkmcnt(7)
  v_mfma_f32_16x16x32_bf16 v[76:79], a[148:151], v[0:3], 0
  ds_read_b64_tr_b16 a[144:145], v96 offset:5120
  ds_read_b64_tr_b16 a[146:147], v96 offset:7680
  s_waitcnt lgkmcnt(7)
  v_mfma_f32_16x16x32_bf16 v[80:83], a[152:155], v[0:3], 0
  ds_read_b64_tr_b16 a[148:149], v96 offset:5152
  ds_read_b64_tr_b16 a[150:151], v96 offset:7712
  s_waitcnt lgkmcnt(7)
  v_mfma_f32_16x16x32_bf16 v[84:87], a[156:159], v[0:3], 0
  ds_read_b64_tr_b16 a[152:153], v96 offset:5184
  ds_read_b64_tr_b16 a[154:155], v96 offset:7744
  s_waitcnt lgkmcnt(7)
  v_mfma_f32_16x16x32_bf16 v[88:91], a[160:163], v[0:3], 0
  ds_read_b64_tr_b16 a[156:157], v96 offset:5216
  ds_read_b64_tr_b16 a[158:159], v96 offset:7776
  s_waitcnt lgkmcnt(8)
  v_mfma_f32_16x16x32_bf16 v[92:95], a[164:167], v[0:3], 0
  ds_read_b64_tr_b16 a[160:161], v96 offset:5248
  ds_read_b64_tr_b16 a[162:163], v96 offset:7808
  s_waitcnt lgkmcnt(8)
  v_mfma_f32_16x16x32_bf16 v[72:75], a[144:147], v[4:7], v[72:75]
  ds_read_b128 a[164:167], v98 offset:64
  s_waitcnt lgkmcnt(7)
  v_mfma_f32_16x16x32_bf16 v[76:79], a[148:151], v[4:7], v[76:79]
  ds_read_b64_tr_b16 a[144:145], v96 offset:10240
  ds_read_b64_tr_b16 a[146:147], v96 offset:12800
  s_waitcnt lgkmcnt(7)
  v_mfma_f32_16x16x32_bf16 v[80:83], a[152:155], v[4:7], v[80:83]
  ds_read_b64_tr_b16 a[148:149], v96 offset:10272
  ds_read_b64_tr_b16 a[150:151], v96 offset:12832
  s_waitcnt lgkmcnt(7)
  v_mfma_f32_16x16x32_bf16 v[84:87], a[156:159], v[4:7], v[84:87]
  ds_read_b64_tr_b16 a[152:153], v96 offset:10304
  ds_read_b64_tr_b16 a[154:155], v96 offset:12864
  s_waitcnt lgkmcnt(7)
  v_mfma_f32_16x16x32_bf16 v[88:91], a[160:163], v[4:7], v[88:91]
  ds_read_b64_tr_b16 a[156:157], v96 offset:10336
  ds_read_b64_tr_b16 a[158:159], v96 offset:12896
  s_waitcnt lgkmcnt(8)
  v_mfma_f32_16x16x32_bf16 v[92:95], a[164:167], v[4:7], v[92:95]
  ds_read_b64_tr_b16 a[160:161], v96 offset:10368
  ds_read_b64_tr_b16 a[162:163], v96 offset:12928
  s_waitcnt vmcnt(15) lgkmcnt(8)
  v_mfma_f32_16x16x32_bf16 v[72:75], a[144:147], v[8:11], v[72:75]
  ds_read_b128 a[164:167], v98 offset:128
  s_waitcnt lgkmcnt(7)
  v_mfma_f32_16x16x32_bf16 v[76:79], a[148:151], v[8:11], v[76:79]
  ds_read_b64_tr_b16 a[144:145], v96 offset:15360
  ds_read_b64_tr_b16 a[146:147], v96 offset:17920
  s_waitcnt lgkmcnt(7)
  v_mfma_f32_16x16x32_bf16 v[80:83], a[152:155], v[8:11], v[80:83]
  ds_read_b64_tr_b16 a[148:149], v96 offset:15392
  ds_read_b64_tr_b16 a[150:151], v96 offset:17952
  s_waitcnt lgkmcnt(7)
  v_mfma_f32_16x16x32_bf16 v[84:87], a[156:159], v[8:11], v[84:87]
  ds_read_b64_tr_b16 a[152:153], v96 offset:15424
  ds_read_b64_tr_b16 a[154:155], v96 offset:17984
  s_waitcnt lgkmcnt(7)
  v_mfma_f32_16x16x32_bf16 v[88:91], a[160:163], v[8:11], v[88:91]
  ds_read_b64_tr_b16 a[156:157], v96 offset:15456
  ds_read_b64_tr_b16 a[158:159], v96 offset:18016
  s_waitcnt lgkmcnt(8)
  v_mfma_f32_16x16x32_bf16 v[92:95], a[164:167], v[8:11], v[92:95]
  ds_read_b64_tr_b16 a[160:161], v96 offset:15488
  ds_read_b64_tr_b16 a[162:163], v96 offset:18048
  s_waitcnt lgkmcnt(8)
  v_mfma_f32_16x16x32_bf16 v[72:75], a[144:147], v[12:15], v[72:75]
  ds_read_b128 a[164:167], v98 offset:192
  s_waitcnt lgkmcnt(7)
  v_mfma_f32_16x16x32_bf16 v[76:79], a[148:151], v[12:15], v[76:79]
  ds_read_b64_tr_b16 a[144:145], v96 offset:20480
  ds_read_b64_tr_b16 a[146:147], v96 offset:23040
  s_waitcnt lgkmcnt(7)
  v_mfma_f32_16x16x32_bf16 v[80:83], a[152:155], v[12:15], v[80:83]
  ds_read_b64_tr_b16 a[148:149], v96 offset:20512
  ds_read_b64_tr_b16 a[150:151], v96 offset:23072
  s_waitcnt lgkmcnt(7)
  v_mfma_f32_16x16x32_bf16 v[84:87], a[156:159], v[12:15], v[84:87]
  ds_read_b64_tr_b16 a[152:153], v96 offset:20544
  ds_read_b64_tr_b16 a[154:155], v96 offset:23104
  s_waitcnt lgkmcnt(7)
  v_mfma_f32_16x16x32_bf16 v[88:91], a[160:163], v[12:15], v[88:91]
  ds_read_b64_tr_b16 a[156:157], v96 offset:20576
  ds_read_b64_tr_b16 a[158:159], v96 offset:23136
  s_waitcnt lgkmcnt(8)
  v_mfma_f32_16x16x32_bf16 v[92:95], a[164:167], v[12:15], v[92:95]
  ds_read_b64_tr_b16 a[160:161], v96 offset:20608
  ds_read_b64_tr_b16 a[162:163], v96 offset:23168
  s_waitcnt vmcnt(13) lgkmcnt(8)
  v_mfma_f32_16x16x32_bf16 v[72:75], a[144:147], v[16:19], v[72:75]
  ds_read_b128 a[164:167], v98 offset:256
  s_waitcnt lgkmcnt(7)
  v_mfma_f32_16x16x32_bf16 v[76:79], a[148:151], v[16:19], v[76:79]
  ds_read_b64_tr_b16 a[144:145], v96 offset:25600
  ds_read_b64_tr_b16 a[146:147], v96 offset:28160
  s_waitcnt lgkmcnt(7)
  v_mfma_f32_16x16x32_bf16 v[80:83], a[152:155], v[16:19], v[80:83]
  ds_read_b64_tr_b16 a[148:149], v96 offset:25632
  ds_read_b64_tr_b16 a[150:151], v96 offset:28192
  s_waitcnt lgkmcnt(7)
  v_mfma_f32_16x16x32_bf16 v[84:87], a[156:159], v[16:19], v[84:87]
  ds_read_b64_tr_b16 a[152:153], v96 offset:25664
  ds_read_b64_tr_b16 a[154:155], v96 offset:28224
  s_waitcnt lgkmcnt(7)
  v_mfma_f32_16x16x32_bf16 v[88:91], a[160:163], v[16:19], v[88:91]
  ds_read_b64_tr_b16 a[156:157], v96 offset:25696
  ds_read_b64_tr_b16 a[158:159], v96 offset:28256
  s_waitcnt lgkmcnt(8)
  v_mfma_f32_16x16x32_bf16 v[92:95], a[164:167], v[16:19], v[92:95]
  ds_read_b64_tr_b16 a[160:161], v96 offset:25728
  ds_read_b64_tr_b16 a[162:163], v96 offset:28288
  s_waitcnt lgkmcnt(8)
  v_mfma_f32_16x16x32_bf16 v[72:75], a[144:147], v[20:23], v[72:75]
  ds_read_b128 a[164:167], v98 offset:320
  s_waitcnt lgkmcnt(7)
  v_mfma_f32_16x16x32_bf16 v[76:79], a[148:151], v[20:23], v[76:79]
  ds_read_b64_tr_b16 a[144:145], v96 offset:30720
  ds_read_b64_tr_b16 a[146:147], v96 offset:33280
  s_waitcnt lgkmcnt(7)
  v_mfma_f32_16x16x32_bf16 v[80:83], a[152:155], v[20:23], v[80:83]
  ds_read_b64_tr_b16 a[148:149], v96 offset:30752
  ds_read_b64_tr_b16 a[150:151], v96 offset:33312
  s_waitcnt lgkmcnt(7)
  v_mfma_f32_16x16x32_bf16 v[84:87], a[156:159], v[20:23], v[84:87]
  ds_read_b64_tr_b16 a[152:153], v96 offset:30784
  ds_read_b64_tr_b16 a[154:155], v96 offset:33344
  s_waitcnt lgkmcnt(7)
  v_mfma_f32_16x16x32_bf16 v[88:91], a[160:163], v[20:23], v[88:91]
  ds_read_b64_tr_b16 a[156:157], v96 offset:30816
  ds_read_b64_tr_b16 a[158:159], v96 offset:33376
  s_waitcnt lgkmcnt(8)
  v_mfma_f32_16x16x32_bf16 v[92:95], a[164:167], v[20:23], v[92:95]
  ds_read_b64_tr_b16 a[160:161], v96 offset:30848
  ds_read_b64_tr_b16 a[162:163], v96 offset:33408
  s_waitcnt vmcnt(11) lgkmcnt(8)
  v_mfma_f32_16x16x32_bf16 v[72:75], a[144:147], v[24:27], v[72:75]
  ds_read_b128 a[164:167], v98 offset:384
  s_waitcnt lgkmcnt(7)
  v_mfma_f32_16x16x32_bf16 v[76:79], a[148:151], v[24:27], v[76:79]
  ds_read_b64_tr_b16 a[144:145], v96 offset:35840
  ds_read_b64_tr_b16 a[146:147], v96 offset:38400
  s_waitcnt lgkmcnt(7)
  v_mfma_f32_16x16x32_bf16 v[80:83], a[152:155], v[24:27], v[80:83]
  ds_read_b64_tr_b16 a[148:149], v96 offset:35872
  ds_read_b64_tr_b16 a[150:151], v96 offset:38432
  s_waitcnt lgkmcnt(7)
  v_mfma_f32_16x16x32_bf16 v[84:87], a[156:159], v[24:27], v[84:87]
  ds_read_b64_tr_b16 a[152:153], v96 offset:35904
  ds_read_b64_tr_b16 a[154:155], v96 offset:38464
  s_waitcnt lgkmcnt(7)
  v_mfma_f32_16x16x32_bf16 v[88:91], a[160:163], v[24:27], v[88:91]
  ds_read_b64_tr_b16 a[156:157], v96 offset:35936
  ds_read_b64_tr_b16 a[158:159], v96 offset:38496
  s_waitcnt lgkmcnt(8)
  v_mfma_f32_16x16x32_bf16 v[92:95], a[164:167], v[24:27], v[92:95]
  ds_read_b64_tr_b16 a[160:161], v96 offset:35968
  ds_read_b64_tr_b16 a[162:163], v96 offset:38528
  s_waitcnt lgkmcnt(8)
  v_mfma_f32_16x16x32_bf16 v[72:75], a[144:147], v[28:31], v[72:75]
  ds_read_b128 a[164:167], v98 offset:448
  s_waitcnt lgkmcnt(7)
  v_mfma_f32_16x16x32_bf16 v[76:79], a[148:151], v[28:31], v[76:79]
  ds_read_b64_tr_b16 a[144:145], v96 offset:40960
  ds_read_b64_tr_b16 a[146:147], v96 offset:43520
  s_waitcnt lgkmcnt(7)
  v_mfma_f32_16x16x32_bf16 v[80:83], a[152:155], v[28:31], v[80:83]
  ds_read_b64_tr_b16 a[148:149], v96 offset:40992
  ds_read_b64_tr_b16 a[150:151], v96 offset:43552
  s_waitcnt lgkmcnt(7)
  v_mfma_f32_16x16x32_bf16 v[84:87], a[156:159], v[28:31], v[84:87]
  ds_read_b64_tr_b16 a[152:153], v96 offset:41024
  ds_read_b64_tr_b16 a[154:155], v96 offset:43584
  s_waitcnt lgkmcnt(7)
  v_mfma_f32_16x16x32_bf16 v[88:91], a[160:163], v[28:31], v[88:91]
  ds_read_b64_tr_b16 a[156:157], v96 offset:41056
  ds_read_b64_tr_b16 a[158:159], v96 offset:43616
  s_waitcnt lgkmcnt(8)
  v_mfma_f32_16x16x32_bf16 v[92:95], a[164:167], v[28:31], v[92:95]
  ds_read_b64_tr_b16 a[160:161], v96 offset:41088
  ds_read_b64_tr_b16 a[162:163], v96 offset:43648
  s_waitcnt vmcnt(9) lgkmcnt(8)
  v_mfma_f32_16x16x32_bf16 v[72:75], a[144:147], v[32:35], v[72:75]
  ds_read_b128 a[164:167], v98 offset:512
  s_waitcnt lgkmcnt(7)
  v_mfma_f32_16x16x32_bf16 v[76:79], a[148:151], v[32:35], v[76:79]
  ds_read_b64_tr_b16 a[144:145], v97 offset:0
  ds_read_b64_tr_b16 a[146:147], v97 offset:2560
  s_waitcnt lgkmcnt(7)
  v_mfma_f32_16x16x32_bf16 v[80:83], a[152:155], v[32:35], v[80:83]
  ds_read_b64_tr_b16 a[148:149], v97 offset:32
  ds_read_b64_tr_b16 a[150:151], v97 offset:2592
  s_waitcnt lgkmcnt(7)
  v_mfma_f32_16x16x32_bf16 v[84:87], a[156:159], v[32:35], v[84:87]
  ds_read_b64_tr_b16 a[152:153], v97 offset:64
  ds_read_b64_tr_b16 a[154:155], v97 offset:2624
  s_waitcnt lgkmcnt(7)
  v_mfma_f32_16x16x32_bf16 v[88:91], a[160:163], v[32:35], v[88:91]
  ds_read_b64_tr_b16 a[156:157], v97 offset:96
  ds_read_b64_tr_b16 a[158:159], v97 offset:2656
  s_waitcnt lgkmcnt(8)
  v_mfma_f32_16x16x32_bf16 v[92:95], a[164:167], v[32:35], v[92:95]
  ds_read_b64_tr_b16 a[160:161], v97 offset:128
  ds_read_b64_tr_b16 a[162:163], v97 offset:2688
  s_waitcnt lgkmcnt(8)
  v_mfma_f32_16x16x32_bf16 v[72:75], a[144:147], v[36:39], v[72:75]
  ds_read_b128 a[164:167], v98 offset:576
  s_waitcnt lgkmcnt(7)
  v_mfma_f32_16x16x32_bf16 v[76:79], a[148:151], v[36:39], v[76:79]
  ds_read_b64_tr_b16 a[144:145], v97 offset:5120
  ds_read_b64_tr_b16 a[146:147], v97 offset:7680
  s_waitcnt lgkmcnt(7)
  v_mfma_f32_16x16x32_bf16 v[80:83], a[152:155], v[36:39], v[80:83]
  ds_read_b64_tr_b16 a[148:149], v97 offset:5152
  ds_read_b64_tr_b16 a[150:151], v97 offset:7712
  s_waitcnt lgkmcnt(7)
  v_mfma_f32_16x16x32_bf16 v[84:87], a[156:159], v[36:39], v[84:87]
  ds_read_b64_tr_b16 a[152:153], v97 offset:5184
  ds_read_b64_tr_b16 a[154:155], v97 offset:7744
  s_waitcnt lgkmcnt(7)
  v_mfma_f32_16x16x32_bf16 v[88:91], a[160:163], v[36:39], v[88:91]
  ds_read_b64_tr_b16 a[156:157], v97 offset:5216
  ds_read_b64_tr_b16 a[158:159], v97 offset:7776
  s_waitcnt lgkmcnt(8)
  v_mfma_f32_16x16x32_bf16 v[92:95], a[164:167], v[36:39], v[92:95]
  ds_read_b64_tr_b16 a[160:161], v97 offset:5248
  ds_read_b64_tr_b16 a[162:163], v97 offset:7808
  s_waitcnt vmcnt(7) lgkmcnt(8)
  v_mfma_f32_16x16x32_bf16 v[72:75], a[144:147], v[40:43], v[72:75]
  ds_read_b128 a[164:167], v98 offset:640
  s_waitcnt lgkmcnt(7)
  v_mfma_f32_16x16x32_bf16 v[76:79], a[148:151], v[40:43], v[76:79]
  ds_read_b64_tr_b16 a[144:145], v97 offset:10240
  ds_read_b64_tr_b16 a[146:147], v97 offset:12800
  s_waitcnt lgkmcnt(7)
  v_mfma_f32_16x16x32_bf16 v[80:83], a[152:155], v[40:43], v[80:83]
  ds_read_b64_tr_b16 a[148:149], v97 offset:10272
  ds_read_b64_tr_b16 a[150:151], v97 offset:12832
  s_waitcnt lgkmcnt(7)
  v_mfma_f32_16x16x32_bf16 v[84:87], a[156:159], v[40:43], v[84:87]
  ds_read_b64_tr_b16 a[152:153], v97 offset:10304
  ds_read_b64_tr_b16 a[154:155], v97 offset:12864
  s_waitcnt lgkmcnt(7)
  v_mfma_f32_16x16x32_bf16 v[88:91], a[160:163], v[40:43], v[88:91]
  ds_read_b64_tr_b16 a[156:157], v97 offset:10336
  ds_read_b64_tr_b16 a[158:159], v97 offset:12896
  s_waitcnt lgkmcnt(8)
  v_mfma_f32_16x16x32_bf16 v[92:95], a[164:167], v[40:43], v[92:95]
  ds_read_b64_tr_b16 a[160:161], v97 offset:10368
  ds_read_b64_tr_b16 a[162:163], v97 offset:12928
  s_waitcnt lgkmcnt(8)
  v_mfma_f32_16x16x32_bf16 v[72:75], a[144:147], v[44:47], v[72:75]
  ds_read_b128 a[164:167], v98 offset:704
  s_waitcnt lgkmcnt(7)
  v_mfma_f32_16x16x32_bf16 v[76:79], a[148:151], v[44:47], v[76:79]
  ds_read_b64_tr_b16 a[144:145], v97 offset:15360
  ds_read_b64_tr_b16 a[146:147], v97 offset:17920
  s_waitcnt lgkmcnt(7)
  v_mfma_f32_16x16x32_bf16 v[80:83], a[152:155], v[44:47], v[80:83]
  ds_read_b64_tr_b16 a[148:149], v97 offset:15392
  ds_read_b64_tr_b16 a[150:151], v97 offset:17952
  s_waitcnt lgkmcnt(7)
  v_mfma_f32_16x16x32_bf16 v[84:87], a[156:159], v[44:47], v[84:87]
  ds_read_b64_tr_b16 a[152:153], v97 offset:15424
  ds_read_b64_tr_b16 a[154:155], v97 offset:17984
  s_waitcnt lgkmcnt(7)
  v_mfma_f32_16x16x32_bf16 v[88:91], a[160:163], v[44:47], v[88:91]
  ds_read_b64_tr_b16 a[156:157], v97 offset:15456
  ds_read_b64_tr_b16 a[158:159], v97 offset:18016
  s_waitcnt lgkmcnt(8)
  v_mfma_f32_16x16x32_bf16 v[92:95], a[164:167], v[44:47], v[92:95]
  ds_read_b64_tr_b16 a[160:161], v97 offset:15488
  ds_read_b64_tr_b16 a[162:163], v97 offset:18048
  s_waitcnt vmcnt(5) lgkmcnt(8)
  v_mfma_f32_16x16x32_bf16 v[72:75], a[144:147], v[48:51], v[72:75]
  ds_read_b128 a[164:167], v98 offset:768
  s_waitcnt lgkmcnt(7)
  v_mfma_f32_16x16x32_bf16 v[76:79], a[148:151], v[48:51], v[76:79]
  ds_read_b64_tr_b16 a[144:145], v97 offset:20480
  ds_read_b64_tr_b16 a[146:147], v97 offset:23040
  s_waitcnt lgkmcnt(7)
  v_mfma_f32_16x16x32_bf16 v[80:83], a[152:155], v[48:51], v[80:83]
  ds_read_b64_tr_b16 a[148:149], v97 offset:20512
  ds_read_b64_tr_b16 a[150:151], v97 offset:23072
  s_waitcnt lgkmcnt(7)
  v_mfma_f32_16x16x32_bf16 v[84:87], a[156:159], v[48:51], v[84:87]
  ds_read_b64_tr_b16 a[152:153], v97 offset:20544
  ds_read_b64_tr_b16 a[154:155], v97 offset:23104
  s_waitcnt lgkmcnt(7)
  v_mfma_f32_16x16x32_bf16 v[88:91], a[160:163], v[48:51], v[88:91]
  ds_read_b64_tr_b16 a[156:157], v97 offset:20576
  ds_read_b64_tr_b16 a[158:159], v97 offset:23136
  s_waitcnt lgkmcnt(8)
  v_mfma_f32_16x16x32_bf16 v[92:95], a[164:167], v[48:51], v[92:95]
  ds_read_b64_tr_b16 a[160:161], v97 offset:20608
  ds_read_b64_tr_b16 a[162:163], v97 offset:23168
  s_waitcnt lgkmcnt(8)
  v_mfma_f32_16x16x32_bf16 v[72:75], a[144:147], v[52:55], v[72:75]
  ds_read_b128 a[164:167], v98 offset:832
  s_waitcnt lgkmcnt(7)
  v_mfma_f32_16x16x32_bf16 v[76:79], a[148:151], v[52:55], v[76:79]
  ds_read_b64_tr_b16 a[144:145], v97 offset:25600
  ds_read_b64_tr_b16 a[146:147], v97 offset:28160
  s_waitcnt lgkmcnt(7)
  v_mfma_f32_16x16x32_bf16 v[80:83], a[152:155], v[52:55], v[80:83]
  ds_read_b64_tr_b16 a[148:149], v97 offset:25632
  ds_read_b64_tr_b16 a[150:151], v97 offset:28192
  s_waitcnt lgkmcnt(7)
  v_mfma_f32_16x16x32_bf16 v[84:87], a[156:159], v[52:55], v[84:87]
  ds_read_b64_tr_b16 a[152:153], v97 offset:25664
  ds_read_b64_tr_b16 a[154:155], v97 offset:28224
  s_waitcnt lgkmcnt(7)
  v_mfma_f32_16x16x32_bf16 v[88:91], a[160:163], v[52:55], v[88:91]
  ds_read_b64_tr_b16 a[156:157], v97 offset:25696
  ds_read_b64_tr_b16 a[158:159], v97 offset:28256
  s_waitcnt lgkmcnt(8)
  v_mfma_f32_16x16x32_bf16 v[92:95], a[164:167], v[52:55], v[92:95]
  ds_read_b64_tr_b16 a[160:161], v97 offset:25728
  ds_read_b64_tr_b16 a[162:163], v97 offset:28288
  s_waitcnt vmcnt(3) lgkmcnt(8)
  v_mfma_f32_16x16x32_bf16 v[72:75], a[144:147], v[56:59], v[72:75]
  ds_read_b128 a[164:167], v98 offset:896
  s_waitcnt lgkmcnt(7)
  v_mfma_f32_16x16x32_bf16 v[76:79], a[148:151], v[56:59], v[76:79]
  ds_read_b64_tr_b16 a[144:145], v97 offset:30720
  ds_read_b64_tr_b16 a[146:147], v97 offset:33280
  s_waitcnt lgkmcnt(7)
  v_mfma_f32_16x16x32_bf16 v[80:83], a[152:155], v[56:59], v[80:83]
  ds_read_b64_tr_b16 a[148:149], v97 offset:30752
  ds_read_b64_tr_b16 a[150:151], v97 offset:33312
  s_waitcnt lgkmcnt(7)
  v_mfma_f32_16x16x32_bf16 v[84:87], a[156:159], v[56:59], v[84:87]
  ds_read_b64_tr_b16 a[152:153], v97 offset:30784
  ds_read_b64_tr_b16 a[154:155], v97 offset:33344
  s_waitcnt lgkmcnt(7)
  v_mfma_f32_16x16x32_bf16 v[88:91], a[160:163], v[56:59], v[88:91]
  ds_read_b64_tr_b16 a[156:157], v97 offset:30816
  ds_read_b64_tr_b16 a[158:159], v97 offset:33376
  s_waitcnt lgkmcnt(8)
  v_mfma_f32_16x16x32_bf16 v[92:95], a[164:167], v[56:59], v[92:95]
  ds_read_b64_tr_b16 a[160:161], v97 offset:30848
  ds_read_b64_tr_b16 a[162:163], v97 offset:33408
  s_waitcnt lgkmcnt(8)
  v_mfma_f32_16x16x32_bf16 v[72:75], a[144:147], v[60:63], v[72:75]
  ds_read_b128 a[164:167], v98 offset:960
  s_waitcnt lgkmcnt(7)
  v_mfma_f32_16x16x32_bf16 v[76:79], a[148:151], v[60:63], v[76:79]
  ds_read_b64_tr_b16 a[144:145], v97 offset:35840
  ds_read_b64_tr_b16 a[146:147], v97 offset:38400
  s_waitcnt lgkmcnt(7)
  v_mfma_f32_16x16x32_bf16 v[80:83], a[152:155], v[60:63], v[80:83]
  ds_read_b64_tr_b16 a[148:149], v97 offset:35872
  ds_read_b64_tr_b16 a[150:151], v97 offset:38432
  s_waitcnt lgkmcnt(7)
  v_mfma_f32_16x16x32_bf16 v[84:87], a[156:159], v[60:63], v[84:87]
  ds_read_b64_tr_b16 a[152:153], v97 offset:35904
  ds_read_b64_tr_b16 a[154:155], v97 offset:38464
  s_waitcnt lgkmcnt(7)
  v_mfma_f32_16x16x32_bf16 v[88:91], a[160:163], v[60:63], v[88:91]
  ds_read_b64_tr_b16 a[156:157], v97 offset:35936
  ds_read_b64_tr_b16 a[158:159], v97 offset:38496
  s_waitcnt lgkmcnt(8)
  v_mfma_f32_16x16x32_bf16 v[92:95], a[164:167], v[60:63], v[92:95]
  ds_read_b64_tr_b16 a[160:161], v97 offset:35968
  ds_read_b64_tr_b16 a[162:163], v97 offset:38528
  s_waitcnt vmcnt(1) lgkmcnt(8)
  v_mfma_f32_16x16x32_bf16 v[72:75], a[144:147], v[64:67], v[72:75]
  ds_read_b128 a[164:167], v98 offset:1024
  s_waitcnt lgkmcnt(7)
  v_mfma_f32_16x16x32_bf16 v[76:79], a[148:151], v[64:67], v[76:79]
  ds_read_b64_tr_b16 a[144:145], v97 offset:40960
  ds_read_b64_tr_b16 a[146:147], v97 offset:43520
  s_waitcnt lgkmcnt(7)
  v_mfma_f32_16x16x32_bf16 v[80:83], a[152:155], v[64:67], v[80:83]
  ds_read_b64_tr_b16 a[148:149], v97 offset:40992
  ds_read_b64_tr_b16 a[150:151], v97 offset:43552
  s_waitcnt lgkmcnt(7)
  v_mfma_f32_16x16x32_bf16 v[84:87], a[156:159], v[64:67], v[84:87]
  ds_read_b64_tr_b16 a[152:153], v97 offset:41024
  ds_read_b64_tr_b16 a[154:155], v97 offset:43584
  s_waitcnt lgkmcnt(7)
  v_mfma_f32_16x16x32_bf16 v[88:91], a[160:163], v[64:67], v[88:91]
  ds_read_b64_tr_b16 a[156:157], v97 offset:41056
  ds_read_b64_tr_b16 a[158:159], v97 offset:43616
  s_waitcnt lgkmcnt(8)
  v_mfma_f32_16x16x32_bf16 v[92:95], a[164:167], v[64:67], v[92:95]
  ds_read_b64_tr_b16 a[160:161], v97 offset:41088
  ds_read_b64_tr_b16 a[162:163], v97 offset:43648
  s_waitcnt lgkmcnt(8)
  v_mfma_f32_16x16x32_bf16 v[72:75], a[144:147], v[68:71], v[72:75]
  ds_read_b128 a[164:167], v98 offset:1088
  s_waitcnt lgkmcnt(7)
  v_mfma_f32_16x16x32_bf16 v[76:79], a[148:151], v[68:71], v[76:79]
  s_waitcnt lgkmcnt(5)
  v_mfma_f32_16x16x32_bf16 v[80:83], a[152:155], v[68:71], v[80:83]
  s_waitcnt lgkmcnt(3)
  v_mfma_f32_16x16x32_bf16 v[84:87], a[156:159], v[68:71], v[84:87]
  s_waitcnt lgkmcnt(1)
  v_mfma_f32_16x16x32_bf16 v[88:91], a[160:163], v[68:71], v[88:91]
  s_waitcnt lgkmcnt(0)
  v_mfma_f32_16x16x32_bf16 v[92:95], a[164:167], v[68:71], v[92:95]
  s_lshr_b32 s4, s66, 1
  s_mul_i32 s4, s4, 36
  s_and_b32 s5, s66, 1
  s_add_u32 s4, s4, s5
  s_lshl_b32 s4, s4, 10
  s_lshl_b32 s5, s65, 13
  s_add_u32 s5, s5, s74
  s_add_u32 s5, s5, 6307840
  s_add_u32 s6, s74, 6291456
  s_cmp_eq_u32 s65, 0
  s_cselect_b32 s6, s6, 268435456
  s_waitcnt vmcnt(0)
  v_add_f32 v125, v105, v92
  v_mov_b32 v126, 0
  v_lshlrev_b32 v121, 16, v106
  v_and_b32 v122, 0xffff0000, v106
  v_sub_f32 v72, v72, v125
  v_sub_f32 v73, v73, v125
  v_add_f32 v72, v72, v121
  v_add_f32 v73, v73, v122
  v_cvt_pk_bf16_f32 v0, v72, v73
  v_lshlrev_b32 v121, 16, v107
  v_and_b32 v122, 0xffff0000, v107
  v_sub_f32 v74, v74, v125
  v_sub_f32 v75, v75, v125
  v_add_f32 v74, v74, v121
  v_add_f32 v75, v75, v122
  v_cvt_pk_bf16_f32 v1, v74, v75
  buffer_store_dwordx2 v[0:1], v100, s[12:15], s4 offen sc1
  v_lshlrev_b32 v121, 16, v108
  v_and_b32 v122, 0xffff0000, v108
  v_sub_f32 v76, v76, v125
  v_sub_f32 v77, v77, v125
  v_add_f32 v76, v76, v121
  v_add_f32 v77, v77, v122
  v_cvt_pk_bf16_f32 v2, v76, v77
  v_lshlrev_b32 v121, 16, v109
  v_and_b32 v122, 0xffff0000, v109
  v_sub_f32 v78, v78, v125
  v_sub_f32 v79, v79, v125
  v_add_f32 v78, v78, v121
  v_add_f32 v79, v79, v122
  v_cvt_pk_bf16_f32 v3, v78, v79
  buffer_store_dwordx2 v[2:3], v101, s[12:15], s4 offen sc1
  v_lshlrev_b32 v121, 16, v110
  v_and_b32 v122, 0xffff0000, v110
  v_sub_f32 v80, v80, v125
  v_sub_f32 v81, v81, v125
  v_add_f32 v80, v80, v121
  v_add_f32 v81, v81, v122
  v_cvt_pk_bf16_f32 v4, v80, v81
  v_lshlrev_b32 v121, 16, v111
  v_and_b32 v122, 0xffff0000, v111
  v_sub_f32 v82, v82, v125
  v_sub_f32 v83, v83, v125
  v_add_f32 v82, v82, v121
  v_add_f32 v83, v83, v122
  v_cvt_pk_bf16_f32 v5, v82, v83
  buffer_store_dwordx2 v[4:5], v102, s[12:15], s4 offen sc1
  v_lshlrev_b32 v121, 16, v112
  v_and_b32 v122, 0xffff0000, v112
  v_sub_f32 v84, v84, v125
  v_sub_f32 v85, v85, v125
  v_add_f32 v84, v84, v121
  v_add_f32 v85, v85, v122
  v_cvt_pk_bf16_f32 v6, v84, v85
  v_lshlrev_b32 v121, 16, v113
  v_and_b32 v122, 0xffff0000, v113
  v_sub_f32 v86, v86, v125
  v_sub_f32 v87, v87, v125
  v_add_f32 v86, v86, v121
  v_add_f32 v87, v87, v122
  v_cvt_pk_bf16_f32 v7, v86, v87
  buffer_store_dwordx2 v[6:7], v103, s[12:15], s4 offen sc1
  v_lshlrev_b32 v121, 16, v114
  v_and_b32 v122, 0xffff0000, v114
  v_sub_f32 v88, v88, v125
  v_sub_f32 v89, v89, v125
  v_add_f32 v88, v88, v121
  v_add_f32 v89, v89, v122
  v_cvt_pk_bf16_f32 v8, v88, v89
  v_lshlrev_b32 v121, 16, v115
  v_and_b32 v122, 0xffff0000, v115
  v_sub_f32 v90, v90, v125
  v_sub_f32 v91, v91, v125
  v_add_f32 v90, v90, v121
  v_add_f32 v91, v91, v122
  v_cvt_pk_bf16_f32 v9, v90, v91
  buffer_store_dwordx2 v[8:9], v104, s[12:15], s4 offen sc1
  v_cndmask_b32 v10, 0, v8, s[70:71]
  v_cndmask_b32 v11, 0, v9, s[70:71]
  v_dot2c_f32_bf16 v126, v0, v0
  v_dot2c_f32_bf16 v126, v1, v1
  v_dot2c_f32_bf16 v126, v2, v2
  v_dot2c_f32_bf16 v126, v3, v3
  v_dot2c_f32_bf16 v126, v4, v4
  v_dot2c_f32_bf16 v126, v5, v5
  v_dot2c_f32_bf16 v126, v6, v6
  v_dot2c_f32_bf16 v126, v7, v7
  v_dot2c_f32_bf16 v126, v10, v10
  v_dot2c_f32_bf16 v126, v11, v11
  s_and_b32 s7, s64, 1
  s_lshl_b32 s7, s7, 3
  s_add_u32 s7, s7, s65
  v_mov_b32 v121, v126
  s_nop 1
  v_permlane32_swap_b32 v126, v121
  v_add_f32 v126, v126, v121
  v_mov_b32 v121, v126
  s_nop 1
  v_permlane16_swap_b32 v126, v121
  v_add_f32 v126, v126, v121
  buffer_store_dword v126, v99, s[12:15], s5 offen sc1
  buffer_store_dword v125, v99, s[12:15], s6 offen sc1
  s_lshl_b32 s7, s7, 2
  s_add_u32 s7, s7, s76
  s_add_u32 s7, s7, 6443008
  s_cmp_eq_u32 s25, 0
  s_cselect_b32 s7, s7, 268435456
  v_mov_b32 v121, s100
  s_waitcnt vmcnt(0)
  s_barrier
  buffer_store_dword v121, v165, s[12:15], s7 offen sc1
  s_add_u32 m0, s21, 0
  s_nop 0
  buffer_load_dwordx4 v144, s[8:11], s20 offen offset:0 lds
  buffer_load_dwordx4 v145, s[8:11], s20 offen offset:1024 lds
  buffer_load_dwordx4 v146, s[8:11], s20 offen offset:2048 lds
  buffer_load_dwordx4 v147, s[8:11], s20 offen offset:3072 lds
  s_add_u32 s20, s20, s27
  s_add_u32 m0, s21, 16384
  s_nop 0
  buffer_load_dwordx4 v144, s[8:11], s20 offen offset:0 lds
  buffer_load_dwordx4 v145, s[8:11], s20 offen offset:1024 lds
  buffer_load_dwordx4 v146, s[8:11], s20 offen offset:2048 lds
  buffer_load_dwordx4 v147, s[8:11], s20 offen offset:3072 lds
  s_add_u32 s20, s20, s27
  s_lshl_b32 s5, s31, 7
  s_add_u32 s5, s5, 6443008
  s_cmp_eq_u32 s25, 0
  s_cbranch_scc0 K3_hf_done
  v_bfe_u32 v179, v164, 4, 4
  v_lshlrev_b32 v179, 2, v179
  s_branch K3_hf_0
K3_hf_again:
  s_sleep 2
K3_hf_0:
  buffer_load_dword v178, v179, s[12:15], s5 offen sc1
  s_waitcnt vmcnt(0)
  v_cmp_ne_u32 vcc, s100, v178
  s_cmp_eq_u64 vcc, 0
  s_cbranch_scc0 K3_hf_again
K3_hf_done:
  s_barrier
  s_mov_b32 s5, s88
  buffer_load_dwordx4 a[0:3], v164, s[12:15], s5 offen offset:0 sc1
  buffer_load_dwordx4 a[4:7], v164, s[12:15], s5 offen offset:1024 sc1
  buffer_load_dwordx4 a[8:11], v164, s[12:15], s5 offen offset:2048 sc1
  buffer_load_dwordx4 a[12:15], v164, s[12:15], s5 offen offset:3072 sc1
  s_add_u32 s5, s5, 4096
  buffer_load_dwordx4 a[16:19], v164, s[12:15], s5 offen offset:0 sc1
  buffer_load_dwordx4 a[20:23], v164, s[12:15], s5 offen offset:1024 sc1
  buffer_load_dwordx4 a[24:27], v164, s[12:15], s5 offen offset:2048 sc1
  buffer_load_dwordx4 a[28:31], v164, s[12:15], s5 offen offset:3072 sc1
  s_add_u32 s5, s5, 4096
  buffer_load_dwordx4 a[32:35], v164, s[12:15], s5 offen offset:0 sc1
  buffer_load_dwordx4 a[36:39], v164, s[12:15], s5 offen offset:1024 sc1
  buffer_load_dwordx4 a[40:43], v164, s[12:15], s5 offen offset:2048 sc1
  buffer_load_dwordx4 a[44:47], v164, s[12:15], s5 offen offset:3072 sc1
  s_add_u32 s5, s5, 4096
  buffer_load_dwordx4 a[48:51], v164, s[12:15], s5 offen offset:0 sc1
  buffer_load_dwordx4 a[52:55], v164, s[12:15], s5 offen offset:1024 sc1
  buffer_load_dwordx4 a[56:59], v164, s[12:15], s5 offen offset:2048 sc1
  buffer_load_dwordx4 a[60:63], v164, s[12:15], s5 offen offset:3072 sc1
  s_add_u32 s5, s5, 4096
  buffer_load_dwordx4 a[64:67], v164, s[12:15], s5 offen offset:0 sc1
  buffer_load_dwordx4 a[68:71], v164, s[12:15], s5 offen offset:1024 sc1
  buffer_load_dwordx4 a[72:75], v164, s[12:15], s5 offen offset:2048 sc1
  buffer_load_dwordx4 a[76:79], v164, s[12:15], s5 offen offset:3072 sc1
  s_add_u32 s5, s5, 4096
  buffer_load_dwordx4 a[80:83], v164, s[12:15], s5 offen offset:0 sc1
  buffer_load_dwordx4 a[84:87], v164, s[12:15], s5 offen offset:1024 sc1
  buffer_load_dwordx4 a[88:91], v164, s[12:15], s5 offen offset:2048 sc1
  buffer_load_dwordx4 a[92:95], v164, s[12:15], s5 offen offset:3072 sc1
  s_add_u32 s5, s5, 4096
  buffer_load_dwordx4 a[96:99], v164, s[12:15], s5 offen offset:0 sc1
  buffer_load_dwordx4 a[100:103], v164, s[12:15], s5 offen offset:1024 sc1
  buffer_load_dwordx4 a[104:107], v164, s[12:15], s5 offen offset:2048 sc1
  buffer_load_dwordx4 a[108:111], v164, s[12:15], s5 offen offset:3072 sc1
  s_add_u32 s5, s5, 4096
  buffer_load_dwordx4 a[112:115], v164, s[12:15], s5 offen offset:0 sc1
  buffer_load_dwordx4 a[116:119], v164, s[12:15], s5 offen offset:1024 sc1
  buffer_load_dwordx4 a[120:123], v164, s[12:15], s5 offen offset:2048 sc1
  buffer_load_dwordx4 a[124:127], v164, s[12:15], s5 offen offset:3072 sc1
  s_add_u32 s5, s5, 4096
  buffer_load_dwordx4 a[128:131], v164, s[12:15], s5 offen offset:0 sc1
  buffer_load_dwordx4 a[132:135], v164, s[12:15], s5 offen offset:1024 sc1
  buffer_load_dwordx4 a[136:139], v164, s[12:15], s5 offen offset:2048 sc1
  buffer_load_dwordx4 a[140:143], v164, s[12:15], s5 offen offset:3072 sc1
  v_bfe_u32 v178, v164, 4, 4
  v_lshlrev_b32 v178, 2, v178
  s_lshl_b32 s5, s89, 7
  s_add_u32 s6, s5, 6307840
  s_add_u32 s7, s5, 6291456
  buffer_load_dword v238, v178, s[12:15], s6 offen offset:0 sc1
  buffer_load_dword v239, v178, s[12:15], s6 offen offset:64 sc1
  s_add_u32 s6, s6, 8192
  buffer_load_dword v240, v178, s[12:15], s6 offen offset:0 sc1
  buffer_load_dword v241, v178, s[12:15], s6 offen offset:64 sc1
  s_add_u32 s6, s6, 8192
  buffer_load_dword v242, v178, s[12:15], s6 offen offset:0 sc1
  buffer_load_dword v243, v178, s[12:15], s6 offen offset:64 sc1
  s_add_u32 s6, s6, 8192
  buffer_load_dword v244, v178, s[12:15], s6 offen offset:0 sc1
  buffer_load_dword v245, v178, s[12:15], s6 offen offset:64 sc1
  s_add_u32 s6, s6, 8192
  buffer_load_dword v246, v178, s[12:15], s6 offen offset:0 sc1
  buffer_load_dword v247, v178, s[12:15], s6 offen offset:64 sc1
  s_add_u32 s6, s6, 8192
  buffer_load_dword v248, v178, s[12:15], s6 offen offset:0 sc1
  buffer_load_dword v249, v178, s[12:15], s6 offen offset:64 sc1
  s_add_u32 s6, s6, 8192
  buffer_load_dword v250, v178, s[12:15], s6 offen offset:0 sc1
  buffer_load_dword v251, v178, s[12:15], s6 offen offset:64 sc1
  s_add_u32 s6, s6, 8192
  buffer_load_dword v252, v178, s[12:15], s6 offen offset:0 sc1
  buffer_load_dword v253, v178, s[12:15], s6 offen offset:64 sc1
  buffer_load_dword v168, v178, s[12:15], s7 offen offset:0 sc1
  buffer_load_dword v169, v178, s[12:15], s7 offen offset:64 sc1
  s_waitcnt vmcnt(42)
  s_barrier
  s_add_u32 m0, s21, 32768
  ds_read_b64_tr_b16 a[144:145], v154 offset:0
  ds_read_b64_tr_b16 a[146:147], v154 offset:2048
  ds_read_b64_tr_b16 a[148:149], v157 offset:0
  ds_read_b64_tr_b16 a[150:151], v157 offset:2048
  ds_read_b64_tr_b16 a[152:153], v160 offset:0
  ds_read_b64_tr_b16 a[154:155], v160 offset:2048
  ds_read_b64_tr_b16 a[156:157], v163 offset:0
  ds_read_b64_tr_b16 a[158:159], v163 offset:2048
  ds_read_b64_tr_b16 a[160:161], v154 offset:4096
  ds_read_b64_tr_b16 a[162:163], v154 offset:6144
  buffer_load_dwordx4 v144, s[8:11], s20 offen offset:0 lds
  s_waitcnt lgkmcnt(8)
  s_cmp_lt_u32 s32, 2
  s_cbranch_scc1 K3_B
  .p2align 6
K3_A:
  v_mfma_f32_16x16x32_bf16 v[0:3], a[144:147], a[0:3], 0
  ds_read_b64_tr_b16 a[164:165], v157 offset:4096
  ds_read_b64_tr_b16 a[166:167], v157 offset:6144
  v_mfma_f32_16x16x32_bf16 v[4:7], a[144:147], a[4:7], 0
  s_waitcnt lgkmcnt(8)
  buffer_load_dwordx4 v145, s[8:11], s20 offen offset:1024 lds
  v_mfma_f32_16x16x32_bf16 v[8:11], a[148:151], a[0:3], 0
  ds_read_b64_tr_b16 a[144:145], v160 offset:4096
  ds_read_b64_tr_b16 a[146:147], v160 offset:6144
  v_mfma_f32_16x16x32_bf16 v[12:15], a[148:151], a[4:7], 0
  s_waitcnt lgkmcnt(8)
  v_mfma_f32_16x16x32_bf16 v[16:19], a[152:155], a[0:3], 0
  ds_read_b64_tr_b16 a[148:149], v163 offset:4096
  ds_read_b64_tr_b16 a[150:151], v163 offset:6144
  v_mfma_f32_16x16x32_bf16 v[20:23], a[152:155], a[4:7], 0
  s_waitcnt lgkmcnt(8)
  v_mul_f32 v64, v64, v96
  v_mul_f32 v65, v65, v97
  v_mfma_f32_16x16x32_bf16 v[24:27], a[156:159], a[0:3], 0
  ds_read_b64_tr_b16 a[152:153], v154 offset:8192
  ds_read_b64_tr_b16 a[154:155], v154 offset:10240
  v_mfma_f32_16x16x32_bf16 v[28:31], a[156:159], a[4:7], 0
  s_waitcnt lgkmcnt(8)
  v_cvt_pk_bf16_f32 v128, v64, v65
  v_mul_f32 v66, v66, v98
  v_mfma_f32_16x16x32_bf16 v[32:35], a[160:163], a[0:3], 0
  ds_read_b64_tr_b16 a[156:157], v157 offset:8192
  ds_read_b64_tr_b16 a[158:159], v157 offset:10240
  v_mfma_f32_16x16x32_bf16 v[36:39], a[160:163], a[4:7], 0
  s_waitcnt lgkmcnt(8)
  buffer_load_dwordx4 v146, s[8:11], s20 offen offset:2048 lds
  v_mfma_f32_16x16x32_bf16 v[40:43], a[164:167], a[0:3], 0
  ds_read_b64_tr_b16 a[160:161], v160 offset:8192
  ds_read_b64_tr_b16 a[162:163], v160 offset:10240
  v_mfma_f32_16x16x32_bf16 v[44:47], a[164:167], a[4:7], 0
  s_waitcnt lgkmcnt(8)
  v_mul_f32 v67, v67, v99
  v_cvt_pk_bf16_f32 v129, v66, v67
  v_mfma_f32_16x16x32_bf16 v[48:51], a[144:147], a[0:3], 0
  ds_read_b64_tr_b16 a[164:165], v163 offset:8192
  ds_read_b64_tr_b16 a[166:167], v163 offset:10240
  v_mfma_f32_16x16x32_bf16 v[52:55], a[144:147], a[4:7], 0
  s_waitcnt lgkmcnt(8)
  v_mul_f32 v72, v72, v104
  v_mul_f32 v73, v73, v105
  v_mfma_f32_16x16x32_bf16 v[56:59], a[148:151], a[0:3], 0
  ds_read_b64_tr_b16 a[144:145], v154 offset:12288
  ds_read_b64_tr_b16 a[146:147], v154 offset:14336
  v_mfma_f32_16x16x32_bf16 v[60:63], a[148:151], a[4:7], 0
  s_waitcnt lgkmcnt(8)
  v_cvt_pk_bf16_f32 v130, v72, v73
  v_mul_f32 v74, v74, v106
  v_mfma_f32_16x16x32_bf16 v[0:3], a[152:155], a[8:11], v[0:3]
  ds_read_b64_tr_b16 a[148:149], v157 offset:12288
  ds_read_b64_tr_b16 a[150:151], v157 offset:14336
  v_mfma_f32_16x16x32_bf16 v[4:7], a[152:155], a[12:15], v[4:7]
  s_waitcnt lgkmcnt(8)
  buffer_load_dwordx4 v147, s[8:11], s20 offen offset:3072 lds
  v_mfma_f32_16x16x32_bf16 v[8:11], a[156:159], a[8:11], v[8:11]
  ds_read_b64_tr_b16 a[152:153], v160 offset:12288
  ds_read_b64_tr_b16 a[154:155], v160 offset:14336
  v_mfma_f32_16x16x32_bf16 v[12:15], a[156:159], a[12:15], v[12:15]
  s_waitcnt lgkmcnt(8)
  s_add_u32 s20, s20, s29
  s_add_u32 m0, s21, 49152
  v_mfma_f32_16x16x32_bf16 v[16:19], a[160:163], a[8:11], v[16:19]
  ds_read_b64_tr_b16 a[156:157], v163 offset:12288
  ds_read_b64_tr_b16 a[158:159], v163 offset:14336
  v_mfma_f32_16x16x32_bf16 v[20:23], a[160:163], a[12:15], v[20:23]
  s_waitcnt lgkmcnt(8)
  v_mul_f32 v75, v75, v107
  v_cvt_pk_bf16_f32 v131, v74, v75
  v_mfma_f32_16x16x32_bf16 v[24:27], a[164:167], a[8:11], v[24:27]
  ds_read_b64_tr_b16 a[160:161], v154 offset:16384
  ds_read_b64_tr_b16 a[162:163], v154 offset:18432
  v_mfma_f32_16x16x32_bf16 v[28:31], a[164:167], a[12:15], v[28:31]
  s_waitcnt lgkmcnt(8)
  buffer_store_dwordx4 v[128:131], v164, s[92:95], s23 offen offset:0 sc1
  v_mfma_f32_16x16x32_bf16 v[32:35], a[144:147], a[8:11], v[32:35]
  ds_read_b64_tr_b16 a[164:165], v157 offset:16384
  ds_read_b64_tr_b16 a[166:167], v157 offset:18432
  v_mfma_f32_16x16x32_bf16 v[36:39], a[144:147], a[12:15], v[36:39]
  s_waitcnt lgkmcnt(8)
  buffer_load_dwordx4 v144, s[8:11], s20 offen offset:0 lds
  v_mfma_f32_16x16x32_bf16 v[40:43], a[148:151], a[8:11], v[40:43]
  ds_read_b64_tr_b16 a[144:145], v160 offset:16384
  ds_read_b64_tr_b16 a[146:147], v160 offset:18432
  v_mfma_f32_16x16x32_bf16 v[44:47], a[148:151], a[12:15], v[44:47]
  s_waitcnt lgkmcnt(8)
  v_mul_f32 v68, v68, v100
  v_mul_f32 v69, v69, v101
  v_mfma_f32_16x16x32_bf16 v[48:51], a[152:155], a[8:11], v[48:51]
  ds_read_b64_tr_b16 a[148:149], v163 offset:16384
  ds_read_b64_tr_b16 a[150:151], v163 offset:18432
  v_mfma_f32_16x16x32_bf16 v[52:55], a[152:155], a[12:15], v[52:55]
  s_waitcnt lgkmcnt(8)
  v_cvt_pk_bf16_f32 v132, v68, v69
  v_mul_f32 v70, v70, v102
  v_mfma_f32_16x16x32_bf16 v[56:59], a[156:159], a[8:11], v[56:59]
  ds_read_b64_tr_b16 a[152:153], v154 offset:20480
  ds_read_b64_tr_b16 a[154:155], v154 offset:22528
  v_mfma_f32_16x16x32_bf16 v[60:63], a[156:159], a[12:15], v[60:63]
  s_waitcnt lgkmcnt(8)
  v_mul_f32 v71, v71, v103
  v_cvt_pk_bf16_f32 v133, v70, v71
  v_mfma_f32_16x16x32_bf16 v[0:3], a[160:163], a[16:19], v[0:3]
  ds_read_b64_tr_b16 a[156:157], v157 offset:20480
  ds_read_b64_tr_b16 a[158:159], v157 offset:22528
  v_mfma_f32_16x16x32_bf16 v[4:7], a[160:163], a[20:23], v[4:7]
  s_waitcnt lgkmcnt(8)
  buffer_load_dwordx4 v145, s[8:11], s20 offen offset:1024 lds
  v_mfma_f32_16x16x32_bf16 v[8:11], a[164:167], a[16:19], v[8:11]
  ds_read_b64_tr_b16 a[160:161], v160 offset:20480
  ds_read_b64_tr_b16 a[162:163], v160 offset:22528
  v_mfma_f32_16x16x32_bf16 v[12:15], a[164:167], a[20:23], v[12:15]
  s_waitcnt lgkmcnt(8)
  v_mul_f32 v76, v76, v108
  v_mul_f32 v77, v77, v109
  v_mfma_f32_16x16x32_bf16 v[16:19], a[144:147], a[16:19], v[16:19]
  ds_read_b64_tr_b16 a[164:165], v163 offset:20480
  ds_read_b64_tr_b16 a[166:167], v163 offset:22528
  v_mfma_f32_16x16x32_bf16 v[20:23], a[144:147], a[20:23], v[20:23]
  s_waitcnt lgkmcnt(8)
  v_cvt_pk_bf16_f32 v134, v76, v77
  v_mul_f32 v78, v78, v110
  v_mfma_f32_16x16x32_bf16 v[24:27], a[148:151], a[16:19], v[24:27]
  ds_read_b64_tr_b16 a[144:145], v154 offset:24576
  ds_read_b64_tr_b16 a[146:147], v154 offset:26624
  v_mfma_f32_16x16x32_bf16 v[28:31], a[148:151], a[20:23], v[28:31]
  s_waitcnt lgkmcnt(8)
  v_mul_f32 v79, v79, v111
  v_cvt_pk_bf16_f32 v135, v78, v79
  v_mfma_f32_16x16x32_bf16 v[32:35], a[152:155], a[16:19], v[32:35]
  ds_read_b64_tr_b16 a[148:149], v157 offset:24576
  ds_read_b64_tr_b16 a[150:151], v157 offset:26624
  v_mfma_f32_16x16x32_bf16 v[36:39], a[152:155], a[20:23], v[36:39]
  s_waitcnt lgkmcnt(8)
  buffer_load_dwordx4 v146, s[8:11], s20 offen offset:2048 lds
  v_mfma_f32_16x16x32_bf16 v[40:43], a[156:159], a[16:19], v[40:43]
  ds_read_b64_tr_b16 a[152:153], v160 offset:24576
  ds_read_b64_tr_b16 a[154:155], v160 offset:26624
  v_mfma_f32_16x16x32_bf16 v[44:47], a[156:159], a[20:23], v[44:47]
  s_waitcnt lgkmcnt(8)
  s_cmp_eq_u32 s22, 2
  s_cbranch_scc1 K3_hsA
K3_hsbackA:
  v_mfma_f32_16x16x32_bf16 v[48:51], a[160:163], a[16:19], v[48:51]
  ds_read_b64_tr_b16 a[156:157], v163 offset:24576
  ds_read_b64_tr_b16 a[158:159], v163 offset:26624
  v_mfma_f32_16x16x32_bf16 v[52:55], a[160:163], a[20:23], v[52:55]
  s_waitcnt lgkmcnt(8)
  buffer_load_dwordx4 a[176:179], v164, s[92:95], s43 offen offset:0 sc1
  v_mfma_f32_16x16x32_bf16 v[56:59], a[164:167], a[16:19], v[56:59]
  ds_read_b64_tr_b16 a[160:161], v154 offset:28672
  ds_read_b64_tr_b16 a[162:163], v154 offset:30720
  v_mfma_f32_16x16x32_bf16 v[60:63], a[164:167], a[20:23], v[60:63]
  s_waitcnt lgkmcnt(8)
  buffer_store_dwordx4 v[132:135], v164, s[92:95], s23 offen offset:1024 sc1
  v_mfma_f32_16x16x32_bf16 v[0:3], a[144:147], a[24:27], v[0:3]
  ds_read_b64_tr_b16 a[164:165], v157 offset:28672
  ds_read_b64_tr_b16 a[166:167], v157 offset:30720
  v_mfma_f32_16x16x32_bf16 v[4:7], a[144:147], a[28:31], v[4:7]
  s_waitcnt lgkmcnt(8)
  buffer_load_dwordx4 v147, s[8:11], s20 offen offset:3072 lds
  v_mfma_f32_16x16x32_bf16 v[8:11], a[148:151], a[24:27], v[8:11]
  ds_read_b64_tr_b16 a[144:145], v160 offset:28672
  ds_read_b64_tr_b16 a[146:147], v160 offset:30720
  v_mfma_f32_16x16x32_bf16 v[12:15], a[148:151], a[28:31], v[12:15]
  s_waitcnt lgkmcnt(8)
  s_add_u32 s20, s20, s27
  s_add_u32 m0, s21, 65536
  v_mfma_f32_16x16x32_bf16 v[16:19], a[152:155], a[24:27], v[16:19]
  ds_read_b64_tr_b16 a[148:149], v163 offset:28672
  ds_read_b64_tr_b16 a[150:151], v163 offset:30720
  v_mfma_f32_16x16x32_bf16 v[20:23], a[152:155], a[28:31], v[20:23]
  s_waitcnt lgkmcnt(8)
  buffer_load_dwordx4 a[180:183], v164, s[92:95], s43 offen offset:1024 sc1
  v_mfma_f32_16x16x32_bf16 v[24:27], a[156:159], a[24:27], v[24:27]
  ds_read_b64_tr_b16 a[152:153], v154 offset:32768
  ds_read_b64_tr_b16 a[154:155], v154 offset:34816
  v_mfma_f32_16x16x32_bf16 v[28:31], a[156:159], a[28:31], v[28:31]
  s_waitcnt lgkmcnt(8)
  v_mul_f32 v80, v80, v112
  v_mul_f32 v81, v81, v113
  v_mfma_f32_16x16x32_bf16 v[32:35], a[160:163], a[24:27], v[32:35]
  ds_read_b64_tr_b16 a[156:157], v157 offset:32768
  ds_read_b64_tr_b16 a[158:159], v157 offset:34816
  v_mfma_f32_16x16x32_bf16 v[36:39], a[160:163], a[28:31], v[36:39]
  s_waitcnt lgkmcnt(8)
  buffer_load_dwordx4 v144, s[8:11], s20 offen offset:0 lds
  v_mfma_f32_16x16x32_bf16 v[40:43], a[164:167], a[24:27], v[40:43]
  ds_read_b64_tr_b16 a[160:161], v160 offset:32768
  ds_read_b64_tr_b16 a[162:163], v160 offset:34816
  v_mfma_f32_16x16x32_bf16 v[44:47], a[164:167], a[28:31], v[44:47]
  s_waitcnt lgkmcnt(8)
  v_cvt_pk_bf16_f32 v136, v80, v81
  v_mul_f32 v82, v82, v114
  v_mfma_f32_16x16x32_bf16 v[48:51], a[144:147], a[24:27], v[48:51]
  ds_read_b64_tr_b16 a[164:165], v163 offset:32768
  ds_read_b64_tr_b16 a[166:167], v163 offset:34816
  v_mfma_f32_16x16x32_bf16 v[52:55], a[144:147], a[28:31], v[52:55]
  s_waitcnt lgkmcnt(8)
  v_mul_f32 v83, v83, v115
  v_cvt_pk_bf16_f32 v137, v82, v83
  v_mfma_f32_16x16x32_bf16 v[56:59], a[148:151], a[24:27], v[56:59]
  ds_read_b64_tr_b16 a[144:145], v154 offset:36864
  ds_read_b64_tr_b16 a[146:147], v154 offset:38912
  v_mfma_f32_16x16x32_bf16 v[60:63], a[148:151], a[28:31], v[60:63]
  s_waitcnt lgkmcnt(8)
  v_mul_f32 v88, v88, v120
  v_mul_f32 v89, v89, v121
  v_mfma_f32_16x16x32_bf16 v[0:3], a[152:155], a[32:35], v[0:3]
  ds_read_b64_tr_b16 a[148:149], v157 offset:36864
  ds_read_b64_tr_b16 a[150:151], v157 offset:38912
  v_mfma_f32_16x16x32_bf16 v[4:7], a[152:155], a[36:39], v[4:7]
  s_waitcnt lgkmcnt(8)
  buffer_load_dwordx4 v145, s[8:11], s20 offen offset:1024 lds
  v_mfma_f32_16x16x32_bf16 v[8:11], a[156:159], a[32:35], v[8:11]
  ds_read_b64_tr_b16 a[152:153], v160 offset:36864
  ds_read_b64_tr_b16 a[154:155], v160 offset:38912
  v_mfma_f32_16x16x32_bf16 v[12:15], a[156:159], a[36:39], v[12:15]
  s_waitcnt lgkmcnt(8)
  v_cvt_pk_bf16_f32 v138, v88, v89
  v_mul_f32 v90, v90, v122
  v_mfma_f32_16x16x32_bf16 v[16:19], a[160:163], a[32:35], v[16:19]
  ds_read_b64_tr_b16 a[156:157], v163 offset:36864
  ds_read_b64_tr_b16 a[158:159], v163 offset:38912
  v_mfma_f32_16x16x32_bf16 v[20:23], a[160:163], a[36:39], v[20:23]
  s_waitcnt lgkmcnt(8)
  buffer_load_dwordx4 a[184:187], v164, s[92:95], s43 offen offset:2048 sc1
  v_mfma_f32_16x16x32_bf16 v[24:27], a[164:167], a[32:35], v[24:27]
  ds_read_b64_tr_b16 a[160:161], v154 offset:40960
  ds_read_b64_tr_b16 a[162:163], v154 offset:43008
  v_mfma_f32_16x16x32_bf16 v[28:31], a[164:167], a[36:39], v[28:31]
  s_waitcnt lgkmcnt(8)
  v_mul_f32 v91, v91, v123
  v_cvt_pk_bf16_f32 v139, v90, v91
  v_mfma_f32_16x16x32_bf16 v[32:35], a[144:147], a[32:35], v[32:35]
  ds_read_b64_tr_b16 a[164:165], v157 offset:40960
  ds_read_b64_tr_b16 a[166:167], v157 offset:43008
  v_mfma_f32_16x16x32_bf16 v[36:39], a[144:147], a[36:39], v[36:39]
  s_waitcnt lgkmcnt(8)
  buffer_load_dwordx4 v146, s[8:11], s20 offen offset:2048 lds
  v_mfma_f32_16x16x32_bf16 v[40:43], a[148:151], a[32:35], v[40:43]
  ds_read_b64_tr_b16 a[144:145], v160 offset:40960
  ds_read_b64_tr_b16 a[146:147], v160 offset:43008
  v_mfma_f32_16x16x32_bf16 v[44:47], a[148:151], a[36:39], v[44:47]
  s_waitcnt lgkmcnt(8)
  buffer_store_dwordx4 v[136:139], v164, s[92:95], s23 offen offset:2048 sc1
  v_mfma_f32_16x16x32_bf16 v[48:51], a[152:155], a[32:35], v[48:51]
  ds_read_b64_tr_b16 a[148:149], v163 offset:40960
  ds_read_b64_tr_b16 a[150:151], v163 offset:43008
  v_mfma_f32_16x16x32_bf16 v[52:55], a[152:155], a[36:39], v[52:55]
  s_waitcnt lgkmcnt(8)
  buffer_load_dwordx4 a[188:191], v164, s[92:95], s43 offen offset:3072 sc1
  v_mfma_f32_16x16x32_bf16 v[56:59], a[156:159], a[32:35], v[56:59]
  ds_read_b64_tr_b16 a[152:153], v154 offset:45056
  ds_read_b64_tr_b16 a[154:155], v154 offset:47104
  v_mfma_f32_16x16x32_bf16 v[60:63], a[156:159], a[36:39], v[60:63]
  s_waitcnt lgkmcnt(8)
  s_add_u32 s43, s43, 16384
  v_mul_f32 v84, v84, v116
  v_mfma_f32_16x16x32_bf16 v[0:3], a[160:163], a[40:43], v[0:3]
  ds_read_b64_tr_b16 a[156:157], v157 offset:45056
  ds_read_b64_tr_b16 a[158:159], v157 offset:47104
  v_mfma_f32_16x16x32_bf16 v[4:7], a[160:163], a[44:47], v[4:7]
  s_waitcnt lgkmcnt(8)
  buffer_load_dwordx4 v147, s[8:11], s20 offen offset:3072 lds
  v_mfma_f32_16x16x32_bf16 v[8:11], a[164:167], a[40:43], v[8:11]
  ds_read_b64_tr_b16 a[160:161], v160 offset:45056
  ds_read_b64_tr_b16 a[162:163], v160 offset:47104
  v_mfma_f32_16x16x32_bf16 v[12:15], a[164:167], a[44:47], v[12:15]
  s_waitcnt lgkmcnt(8)
  s_add_u32 s20, s20, s28
  s_add_u32 m0, s21, 81920
  v_mfma_f32_16x16x32_bf16 v[16:19], a[144:147], a[40:43], v[16:19]
  ds_read_b64_tr_b16 a[164:165], v163 offset:45056
  ds_read_b64_tr_b16 a[166:167], v163 offset:47104
  v_mfma_f32_16x16x32_bf16 v[20:23], a[144:147], a[44:47], v[20:23]
  s_waitcnt vmcnt(15) lgkmcnt(8)
  s_barrier
  v_mul_f32 v85, v85, v117
  v_mfma_f32_16x16x32_bf16 v[24:27], a[148:151], a[40:43], v[24:27]
  ds_read_b64_tr_b16 a[144:145], v152 offset:0
  ds_read_b64_tr_b16 a[146:147], v152 offset:2048
  v_mfma_f32_16x16x32_bf16 v[28:31], a[148:151], a[44:47], v[28:31]
  s_waitcnt lgkmcnt(8)
  s_cmp_eq_u32 s35, 0
  s_cbranch_scc1 K3_r2A
K3_r2backA:
  v_mfma_f32_16x16x32_bf16 v[32:35], a[152:155], a[40:43], v[32:35]
  ds_read_b64_tr_b16 a[148:149], v155 offset:0
  ds_read_b64_tr_b16 a[150:151], v155 offset:2048
  v_mfma_f32_16x16x32_bf16 v[36:39], a[152:155], a[44:47], v[36:39]
  s_waitcnt lgkmcnt(8)
  buffer_load_dwordx4 v144, s[8:11], s20 offen offset:0 lds
  v_mfma_f32_16x16x32_bf16 v[40:43], a[156:159], a[40:43], v[40:43]
  ds_read_b64_tr_b16 a[152:153], v158 offset:0
  ds_read_b64_tr_b16 a[154:155], v158 offset:2048
  v_mfma_f32_16x16x32_bf16 v[44:47], a[156:159], a[44:47], v[44:47]
  s_waitcnt lgkmcnt(8)
  v_cvt_pk_bf16_f32 v140, v84, v85
  v_mul_f32 v86, v86, v118
  v_mfma_f32_16x16x32_bf16 v[48:51], a[160:163], a[40:43], v[48:51]
  ds_read_b64_tr_b16 a[156:157], v161 offset:0
  ds_read_b64_tr_b16 a[158:159], v161 offset:2048
  v_mfma_f32_16x16x32_bf16 v[52:55], a[160:163], a[44:47], v[52:55]
  s_waitcnt lgkmcnt(8)
  v_mul_f32 v87, v87, v119
  v_cvt_pk_bf16_f32 v141, v86, v87
  v_mfma_f32_16x16x32_bf16 v[56:59], a[164:167], a[40:43], v[56:59]
  ds_read_b64_tr_b16 a[160:161], v152 offset:4096
  ds_read_b64_tr_b16 a[162:163], v152 offset:6144
  v_mfma_f32_16x16x32_bf16 v[60:63], a[164:167], a[44:47], v[60:63]
  s_waitcnt lgkmcnt(8)
  v_mul_f32 v92, v92, v124
  v_mul_f32 v93, v93, v125
  v_mfma_f32_16x16x32_bf16 v[0:3], a[144:147], a[48:51], v[0:3]
  ds_read_b64_tr_b16 a[164:165], v155 offset:4096
  ds_read_b64_tr_b16 a[166:167], v155 offset:6144
  v_mfma_f32_16x16x32_bf16 v[4:7], a[144:147], a[52:55], v[4:7]
  s_waitcnt lgkmcnt(8)
  buffer_load_dwordx4 v145, s[8:11], s20 offen offset:1024 lds
  v_mfma_f32_16x16x32_bf16 v[8:11], a[148:151], a[48:51], v[8:11]
  ds_read_b64_tr_b16 a[144:145], v158 offset:4096
  ds_read_b64_tr_b16 a[146:147], v158 offset:6144
  v_mfma_f32_16x16x32_bf16 v[12:15], a[148:151], a[52:55], v[12:15]
  s_waitcnt lgkmcnt(8)
  v_cvt_pk_bf16_f32 v142, v92, v93
  v_mul_f32 v94, v94, v126
  v_mfma_f32_16x16x32_bf16 v[16:19], a[152:155], a[48:51], v[16:19]
  ds_read_b64_tr_b16 a[148:149], v161 offset:4096
  ds_read_b64_tr_b16 a[150:151], v161 offset:6144
  v_mfma_f32_16x16x32_bf16 v[20:23], a[152:155], a[52:55], v[20:23]
  s_waitcnt lgkmcnt(8)
  buffer_load_dwordx4 a[192:195], v164, s[92:95], s43 offen offset:0 sc1
  v_mfma_f32_16x16x32_bf16 v[24:27], a[156:159], a[48:51], v[24:27]
  ds_read_b64_tr_b16 a[152:153], v152 offset:8192
  ds_read_b64_tr_b16 a[154:155], v152 offset:10240
  v_mfma_f32_16x16x32_bf16 v[28:31], a[156:159], a[52:55], v[28:31]
  s_waitcnt lgkmcnt(8)
  v_mul_f32 v95, v95, v127
  v_cvt_pk_bf16_f32 v143, v94, v95
  v_mfma_f32_16x16x32_bf16 v[32:35], a[160:163], a[48:51], v[32:35]
  ds_read_b64_tr_b16 a[156:157], v155 offset:8192
  ds_read_b64_tr_b16 a[158:159], v155 offset:10240
  v_mfma_f32_16x16x32_bf16 v[36:39], a[160:163], a[52:55], v[36:39]
  s_waitcnt lgkmcnt(8)
  buffer_load_dwordx4 v146, s[8:11], s20 offen offset:2048 lds
  v_mfma_f32_16x16x32_bf16 v[40:43], a[164:167], a[48:51], v[40:43]
  ds_read_b64_tr_b16 a[160:161], v158 offset:8192
  ds_read_b64_tr_b16 a[162:163], v158 offset:10240
  v_mfma_f32_16x16x32_bf16 v[44:47], a[164:167], a[52:55], v[44:47]
  s_waitcnt lgkmcnt(8)
  buffer_store_dwordx4 v[140:143], v164, s[92:95], s23 offen offset:3072 sc1
  v_mfma_f32_16x16x32_bf16 v[48:51], a[144:147], a[48:51], v[48:51]
  ds_read_b64_tr_b16 a[164:165], v161 offset:8192
  ds_read_b64_tr_b16 a[166:167], v161 offset:10240
  v_mfma_f32_16x16x32_bf16 v[52:55], a[144:147], a[52:55], v[52:55]
  s_waitcnt lgkmcnt(8)
  buffer_load_dwordx4 a[196:199], v164, s[92:95], s43 offen offset:1024 sc1
  v_mfma_f32_16x16x32_bf16 v[56:59], a[148:151], a[48:51], v[56:59]
  ds_read_b64_tr_b16 a[144:145], v152 offset:12288
  ds_read_b64_tr_b16 a[146:147], v152 offset:14336
  v_mfma_f32_16x16x32_bf16 v[60:63], a[148:151], a[52:55], v[60:63]
  s_waitcnt lgkmcnt(8)
  v_mfma_f32_16x16x32_bf16 v[0:3], a[152:155], a[56:59], v[0:3]
  ds_read_b64_tr_b16 a[148:149], v155 offset:12288
  ds_read_b64_tr_b16 a[150:151], v155 offset:14336
  v_mfma_f32_16x16x32_bf16 v[4:7], a[152:155], a[60:63], v[4:7]
  s_waitcnt lgkmcnt(8)
  buffer_load_dwordx4 v147, s[8:11], s20 offen offset:3072 lds
  v_mfma_f32_16x16x32_bf16 v[8:11], a[156:159], a[56:59], v[8:11]
  ds_read_b64_tr_b16 a[152:153], v158 offset:12288
  ds_read_b64_tr_b16 a[154:155], v158 offset:14336
  v_mfma_f32_16x16x32_bf16 v[12:15], a[156:159], a[60:63], v[12:15]
  s_waitcnt lgkmcnt(8)
  s_mov_b32 s20, s24
  s_add_u32 m0, s21, 98304
  v_mfma_f32_16x16x32_bf16 v[16:19], a[160:163], a[56:59], v[16:19]
  ds_read_b64_tr_b16 a[156:157], v161 offset:12288
  ds_read_b64_tr_b16 a[158:159], v161 offset:14336
  v_mfma_f32_16x16x32_bf16 v[20:23], a[160:163], a[60:63], v[20:23]
  s_waitcnt lgkmcnt(8)
  v_mfma_f32_16x16x32_bf16 v[24:27], a[164:167], a[56:59], v[24:27]
  ds_read_b64_tr_b16 a[160:161], v152 offset:16384
  ds_read_b64_tr_b16 a[162:163], v152 offset:18432
  v_mfma_f32_16x16x32_bf16 v[28:31], a[164:167], a[60:63], v[28:31]
  s_waitcnt lgkmcnt(8)
  v_mfma_f32_16x16x32_bf16 v[32:35], a[144:147], a[56:59], v[32:35]
  ds_read_b64_tr_b16 a[164:165], v155 offset:16384
  ds_read_b64_tr_b16 a[166:167], v155 offset:18432
  v_mfma_f32_16x16x32_bf16 v[36:39], a[144:147], a[60:63], v[36:39]
  s_waitcnt lgkmcnt(8)
  buffer_load_dwordx4 v144, s[8:11], s20 offen offset:0 lds
  v_mfma_f32_16x16x32_bf16 v[40:43], a[148:151], a[56:59], v[40:43]
  ds_read_b64_tr_b16 a[144:145], v158 offset:16384
  ds_read_b64_tr_b16 a[146:147], v158 offset:18432
  v_mfma_f32_16x16x32_bf16 v[44:47], a[148:151], a[60:63], v[44:47]
  s_waitcnt lgkmcnt(8)
  buffer_load_dword v177, v188, s[96:99], s61 offen
  v_mfma_f32_16x16x32_bf16 v[48:51], a[152:155], a[56:59], v[48:51]
  ds_read_b64_tr_b16 a[148:149], v161 offset:16384
  ds_read_b64_tr_b16 a[150:151], v161 offset:18432
  v_mfma_f32_16x16x32_bf16 v[52:55], a[152:155], a[60:63], v[52:55]
  s_waitcnt lgkmcnt(8)
  v_mfma_f32_16x16x32_bf16 v[56:59], a[156:159], a[56:59], v[56:59]
  ds_read_b64_tr_b16 a[152:153], v152 offset:20480
  ds_read_b64_tr_b16 a[154:155], v152 offset:22528
  v_mfma_f32_16x16x32_bf16 v[60:63], a[156:159], a[60:63], v[60:63]
  s_waitcnt lgkmcnt(8)
  v_mfma_f32_16x16x32_bf16 v[0:3], a[160:163], a[64:67], v[0:3]
  ds_read_b64_tr_b16 a[156:157], v155 offset:20480
  ds_read_b64_tr_b16 a[158:159], v155 offset:22528
  v_mfma_f32_16x16x32_bf16 v[4:7], a[160:163], a[68:71], v[4:7]
  s_waitcnt lgkmcnt(8)
  buffer_load_dwordx4 v145, s[8:11], s20 offen offset:1024 lds
  v_mfma_f32_16x16x32_bf16 v[8:11], a[164:167], a[64:67], v[8:11]
  ds_read_b64_tr_b16 a[160:161], v158 offset:20480
  ds_read_b64_tr_b16 a[162:163], v158 offset:22528
  v_mfma_f32_16x16x32_bf16 v[12:15], a[164:167], a[68:71], v[12:15]
  s_waitcnt lgkmcnt(8)
  s_add_u32 s61, s61, 512
  s_add_u32 s62, s62, 55296
  v_mfma_f32_16x16x32_bf16 v[16:19], a[144:147], a[64:67], v[16:19]
  ds_read_b64_tr_b16 a[164:165], v161 offset:20480
  ds_read_b64_tr_b16 a[166:167], v161 offset:22528
  v_mfma_f32_16x16x32_bf16 v[20:23], a[144:147], a[68:71], v[20:23]
  s_waitcnt lgkmcnt(8)
  buffer_load_dwordx4 a[200:203], v164, s[92:95], s43 offen offset:2048 sc1
  v_mfma_f32_16x16x32_bf16 v[24:27], a[148:151], a[64:67], v[24:27]
  ds_read_b64_tr_b16 a[144:145], v152 offset:24576
  ds_read_b64_tr_b16 a[146:147], v152 offset:26624
  v_mfma_f32_16x16x32_bf16 v[28:31], a[148:151], a[68:71], v[28:31]
  s_waitcnt lgkmcnt(8)
  s_add_u32 s24, s24, 512
  v_mfma_f32_16x16x32_bf16 v[32:35], a[152:155], a[64:67], v[32:35]
  ds_read_b64_tr_b16 a[148:149], v155 offset:24576
  ds_read_b64_tr_b16 a[150:151], v155 offset:26624
  v_mfma_f32_16x16x32_bf16 v[36:39], a[152:155], a[68:71], v[36:39]
  s_waitcnt lgkmcnt(8)
  buffer_load_dwordx4 v146, s[8:11], s20 offen offset:2048 lds
  v_mfma_f32_16x16x32_bf16 v[40:43], a[156:159], a[64:67], v[40:43]
  ds_read_b64_tr_b16 a[152:153], v158 offset:24576
  ds_read_b64_tr_b16 a[154:155], v158 offset:26624
  v_mfma_f32_16x16x32_bf16 v[44:47], a[156:159], a[68:71], v[44:47]
  s_waitcnt lgkmcnt(8)
  s_cmp_eq_u32 s22, 3
  s_cselect_b32 s61, 268435456, s61
  v_mfma_f32_16x16x32_bf16 v[48:51], a[160:163], a[64:67], v[48:51]
  ds_read_b64_tr_b16 a[156:157], v161 offset:24576
  ds_read_b64_tr_b16 a[158:159], v161 offset:26624
  v_mfma_f32_16x16x32_bf16 v[52:55], a[160:163], a[68:71], v[52:55]
  s_waitcnt lgkmcnt(8)
  buffer_load_dwordx4 a[204:207], v164, s[92:95], s43 offen offset:3072 sc1
  v_mfma_f32_16x16x32_bf16 v[56:59], a[164:167], a[64:67], v[56:59]
  ds_read_b64_tr_b16 a[160:161], v152 offset:28672
  ds_read_b64_tr_b16 a[162:163], v152 offset:30720
  v_mfma_f32_16x16x32_bf16 v[60:63], a[164:167], a[68:71], v[60:63]
  s_waitcnt lgkmcnt(8)
  s_add_u32 s43, s43, 16384
  v_mfma_f32_16x16x32_bf16 v[0:3], a[144:147], a[72:75], v[0:3]
  ds_read_b64_tr_b16 a[164:165], v155 offset:28672
  ds_read_b64_tr_b16 a[166:167], v155 offset:30720
  v_mfma_f32_16x16x32_bf16 v[4:7], a[144:147], a[76:79], v[4:7]
  s_waitcnt lgkmcnt(8)
  buffer_load_dwordx4 v147, s[8:11], s20 offen offset:3072 lds
  v_mfma_f32_16x16x32_bf16 v[8:11], a[148:151], a[72:75], v[8:11]
  ds_read_b64_tr_b16 a[144:145], v158 offset:28672
  ds_read_b64_tr_b16 a[146:147], v158 offset:30720
  v_mfma_f32_16x16x32_bf16 v[12:15], a[148:151], a[76:79], v[12:15]
  s_waitcnt lgkmcnt(8)
  s_add_u32 s20, s20, s27
  s_add_u32 m0, s21, 114688
  v_mfma_f32_16x16x32_bf16 v[16:19], a[152:155], a[72:75], v[16:19]
  ds_read_b64_tr_b16 a[148:149], v161 offset:28672
  ds_read_b64_tr_b16 a[150:151], v161 offset:30720
  v_mfma_f32_16x16x32_bf16 v[20:23], a[152:155], a[76:79], v[20:23]
  s_waitcnt lgkmcnt(8)
  v_mfma_f32_16x16x32_bf16 v[24:27], a[156:159], a[72:75], v[24:27]
  ds_read_b64_tr_b16 a[152:153], v152 offset:32768
  ds_read_b64_tr_b16 a[154:155], v152 offset:34816
  v_mfma_f32_16x16x32_bf16 v[28:31], a[156:159], a[76:79], v[28:31]
  s_waitcnt lgkmcnt(8)
  v_mfma_f32_16x16x32_bf16 v[32:35], a[160:163], a[72:75], v[32:35]
  ds_read_b64_tr_b16 a[156:157], v155 offset:32768
  ds_read_b64_tr_b16 a[158:159], v155 offset:34816
  v_mfma_f32_16x16x32_bf16 v[36:39], a[160:163], a[76:79], v[36:39]
  s_waitcnt lgkmcnt(8)
  buffer_load_dwordx4 v144, s[8:11], s20 offen offset:0 lds
  v_mfma_f32_16x16x32_bf16 v[40:43], a[164:167], a[72:75], v[40:43]
  ds_read_b64_tr_b16 a[160:161], v158 offset:32768
  ds_read_b64_tr_b16 a[162:163], v158 offset:34816
  v_mfma_f32_16x16x32_bf16 v[44:47], a[164:167], a[76:79], v[44:47]
  s_waitcnt lgkmcnt(8)
  v_mfma_f32_16x16x32_bf16 v[48:51], a[144:147], a[72:75], v[48:51]
  ds_read_b64_tr_b16 a[164:165], v161 offset:32768
  ds_read_b64_tr_b16 a[166:167], v161 offset:34816
  v_mfma_f32_16x16x32_bf16 v[52:55], a[144:147], a[76:79], v[52:55]
  s_waitcnt lgkmcnt(8)
  buffer_load_dwordx4 a[208:211], v164, s[92:95], s43 offen offset:0 sc1
  v_mfma_f32_16x16x32_bf16 v[56:59], a[148:151], a[72:75], v[56:59]
  ds_read_b64_tr_b16 a[144:145], v152 offset:36864
  ds_read_b64_tr_b16 a[146:147], v152 offset:38912
  v_mfma_f32_16x16x32_bf16 v[60:63], a[148:151], a[76:79], v[60:63]
  s_waitcnt lgkmcnt(8)
  v_mfma_f32_16x16x32_bf16 v[0:3], a[152:155], a[80:83], v[0:3]
  ds_read_b64_tr_b16 a[148:149], v155 offset:36864
  ds_read_b64_tr_b16 a[150:151], v155 offset:38912
  v_mfma_f32_16x16x32_bf16 v[4:7], a[152:155], a[84:87], v[4:7]
  s_waitcnt lgkmcnt(8)
  buffer_load_dwordx4 v145, s[8:11], s20 offen offset:1024 lds
  v_mfma_f32_16x16x32_bf16 v[8:11], a[156:159], a[80:83], v[8:11]
  ds_read_b64_tr_b16 a[152:153], v158 offset:36864
  ds_read_b64_tr_b16 a[154:155], v158 offset:38912
  v_mfma_f32_16x16x32_bf16 v[12:15], a[156:159], a[84:87], v[12:15]
  s_waitcnt lgkmcnt(8)
  v_mfma_f32_16x16x32_bf16 v[16:19], a[160:163], a[80:83], v[16:19]
  ds_read_b64_tr_b16 a[156:157], v161 offset:36864
  ds_read_b64_tr_b16 a[158:159], v161 offset:38912
  v_mfma_f32_16x16x32_bf16 v[20:23], a[160:163], a[84:87], v[20:23]
  s_waitcnt lgkmcnt(8)
  buffer_load_dwordx4 a[212:215], v164, s[92:95], s43 offen offset:1024 sc1
  v_mfma_f32_16x16x32_bf16 v[24:27], a[164:167], a[80:83], v[24:27]
  ds_read_b64_tr_b16 a[160:161], v152 offset:40960
  ds_read_b64_tr_b16 a[162:163], v152 offset:43008
  v_mfma_f32_16x16x32_bf16 v[28:31], a[164:167], a[84:87], v[28:31]
  s_waitcnt lgkmcnt(8)
  v_mfma_f32_16x16x32_bf16 v[32:35], a[144:147], a[80:83], v[32:35]
  ds_read_b64_tr_b16 a[164:165], v155 offset:40960
  ds_read_b64_tr_b16 a[166:167], v155 offset:43008
  v_mfma_f32_16x16x32_bf16 v[36:39], a[144:147], a[84:87], v[36:39]
  s_waitcnt lgkmcnt(8)
  buffer_load_dwordx4 v146, s[8:11], s20 offen offset:2048 lds
  v_mfma_f32_16x16x32_bf16 v[40:43], a[148:151], a[80:83], v[40:43]
  ds_read_b64_tr_b16 a[144:145], v158 offset:40960
  ds_read_b64_tr_b16 a[146:147], v158 offset:43008
  v_mfma_f32_16x16x32_bf16 v[44:47], a[148:151], a[84:87], v[44:47]
  s_waitcnt lgkmcnt(8)
  v_mfma_f32_16x16x32_bf16 v[48:51], a[152:155], a[80:83], v[48:51]
  ds_read_b64_tr_b16 a[148:149], v161 offset:40960
  ds_read_b64_tr_b16 a[150:151], v161 offset:43008
  v_mfma_f32_16x16x32_bf16 v[52:55], a[152:155], a[84:87], v[52:55]
  s_waitcnt lgkmcnt(8)
  v_mfma_f32_16x16x32_bf16 v[56:59], a[156:159], a[80:83], v[56:59]
  ds_read_b64_tr_b16 a[152:153], v152 offset:45056
  ds_read_b64_tr_b16 a[154:155], v152 offset:47104
  v_mfma_f32_16x16x32_bf16 v[60:63], a[156:159], a[84:87], v[60:63]
  s_waitcnt lgkmcnt(8)
  v_mfma_f32_16x16x32_bf16 v[0:3], a[160:163], a[88:91], v[0:3]
  ds_read_b64_tr_b16 a[156:157], v155 offset:45056
  ds_read_b64_tr_b16 a[158:159], v155 offset:47104
  v_mfma_f32_16x16x32_bf16 v[4:7], a[160:163], a[92:95], v[4:7]
  s_waitcnt lgkmcnt(8)
  buffer_load_dwordx4 v147, s[8:11], s20 offen offset:3072 lds
  v_mfma_f32_16x16x32_bf16 v[8:11], a[164:167], a[88:91], v[8:11]
  ds_read_b64_tr_b16 a[160:161], v158 offset:45056
  ds_read_b64_tr_b16 a[162:163], v158 offset:47104
  v_mfma_f32_16x16x32_bf16 v[12:15], a[164:167], a[92:95], v[12:15]
  s_waitcnt lgkmcnt(8)
  s_add_u32 s20, s20, s28
  s_add_u32 m0, s21, 131072
  v_mfma_f32_16x16x32_bf16 v[16:19], a[144:147], a[88:91], v[16:19]
  ds_read_b64_tr_b16 a[164:165], v161 offset:45056
  ds_read_b64_tr_b16 a[166:167], v161 offset:47104
  v_mfma_f32_16x16x32_bf16 v[20:23], a[144:147], a[92:95], v[20:23]
  s_waitcnt vmcnt(13) lgkmcnt(8)
  s_barrier
  v_mfma_f32_16x16x32_bf16 v[24:27], a[148:151], a[88:91], v[24:27]
  ds_read_b64_tr_b16 a[144:145], v153 offset:0
  ds_read_b64_tr_b16 a[146:147], v153 offset:2048
  v_mfma_f32_16x16x32_bf16 v[28:31], a[148:151], a[92:95], v[28:31]
  s_waitcnt lgkmcnt(8)
  v_mov_b32 v176, s35
  v_mfma_f32_16x16x32_bf16 v[32:35], a[152:155], a[88:91], v[32:35]
  ds_read_b64_tr_b16 a[148:149], v156 offset:0
  ds_read_b64_tr_b16 a[150:151], v156 offset:2048
  v_mfma_f32_16x16x32_bf16 v[36:39], a[152:155], a[92:95], v[36:39]
  s_waitcnt lgkmcnt(8)
  buffer_load_dwordx4 v144, s[8:11], s20 offen offset:0 lds
  v_mfma_f32_16x16x32_bf16 v[40:43], a[156:159], a[88:91], v[40:43]
  ds_read_b64_tr_b16 a[152:153], v159 offset:0
  ds_read_b64_tr_b16 a[154:155], v159 offset:2048
  v_mfma_f32_16x16x32_bf16 v[44:47], a[156:159], a[92:95], v[44:47]
  s_waitcnt lgkmcnt(8)
  buffer_store_dword v176, v165, s[12:15], s34 offen sc1
  v_mfma_f32_16x16x32_bf16 v[48:51], a[160:163], a[88:91], v[48:51]
  ds_read_b64_tr_b16 a[156:157], v162 offset:0
  ds_read_b64_tr_b16 a[158:159], v162 offset:2048
  v_mfma_f32_16x16x32_bf16 v[52:55], a[160:163], a[92:95], v[52:55]
  s_waitcnt lgkmcnt(8)
  v_mfma_f32_16x16x32_bf16 v[56:59], a[164:167], a[88:91], v[56:59]
  ds_read_b64_tr_b16 a[160:161], v153 offset:4096
  ds_read_b64_tr_b16 a[162:163], v153 offset:6144
  v_mfma_f32_16x16x32_bf16 v[60:63], a[164:167], a[92:95], v[60:63]
  s_waitcnt lgkmcnt(8)
  v_mfma_f32_16x16x32_bf16 v[0:3], a[144:147], a[96:99], v[0:3]
  ds_read_b64_tr_b16 a[164:165], v156 offset:4096
  ds_read_b64_tr_b16 a[166:167], v156 offset:6144
  v_mfma_f32_16x16x32_bf16 v[4:7], a[144:147], a[100:103], v[4:7]
  s_waitcnt lgkmcnt(8)
  buffer_load_dwordx4 v145, s[8:11], s20 offen offset:1024 lds
  v_mfma_f32_16x16x32_bf16 v[8:11], a[148:151], a[96:99], v[8:11]
  ds_read_b64_tr_b16 a[144:145], v159 offset:4096
  ds_read_b64_tr_b16 a[146:147], v159 offset:6144
  v_mfma_f32_16x16x32_bf16 v[12:15], a[148:151], a[100:103], v[12:15]
  s_waitcnt lgkmcnt(8)
  v_mfma_f32_16x16x32_bf16 v[16:19], a[152:155], a[96:99], v[16:19]
  ds_read_b64_tr_b16 a[148:149], v162 offset:4096
  ds_read_b64_tr_b16 a[150:151], v162 offset:6144
  v_mfma_f32_16x16x32_bf16 v[20:23], a[152:155], a[100:103], v[20:23]
  s_waitcnt lgkmcnt(8)
  buffer_load_dwordx4 a[216:219], v164, s[92:95], s43 offen offset:2048 sc1
  v_mfma_f32_16x16x32_bf16 v[24:27], a[156:159], a[96:99], v[24:27]
  ds_read_b64_tr_b16 a[152:153], v153 offset:8192
  ds_read_b64_tr_b16 a[154:155], v153 offset:10240
  v_mfma_f32_16x16x32_bf16 v[28:31], a[156:159], a[100:103], v[28:31]
  s_waitcnt lgkmcnt(8)
  v_mfma_f32_16x16x32_bf16 v[32:35], a[160:163], a[96:99], v[32:35]
  ds_read_b64_tr_b16 a[156:157], v156 offset:8192
  ds_read_b64_tr_b16 a[158:159], v156 offset:10240
  v_mfma_f32_16x16x32_bf16 v[36:39], a[160:163], a[100:103], v[36:39]
  s_waitcnt lgkmcnt(8)
  buffer_load_dwordx4 v146, s[8:11], s20 offen offset:2048 lds
  v_mfma_f32_16x16x32_bf16 v[40:43], a[164:167], a[96:99], v[40:43]
  ds_read_b64_tr_b16 a[160:161], v159 offset:8192
  ds_read_b64_tr_b16 a[162:163], v159 offset:10240
  v_mfma_f32_16x16x32_bf16 v[44:47], a[164:167], a[100:103], v[44:47]
  s_waitcnt lgkmcnt(8)
  v_mfma_f32_16x16x32_bf16 v[48:51], a[144:147], a[96:99], v[48:51]
  ds_read_b64_tr_b16 a[164:165], v162 offset:8192
  ds_read_b64_tr_b16 a[166:167], v162 offset:10240
  v_mfma_f32_16x16x32_bf16 v[52:55], a[144:147], a[100:103], v[52:55]
  s_waitcnt lgkmcnt(8)
  buffer_load_dwordx4 a[220:223], v164, s[92:95], s43 offen offset:3072 sc1
  v_mfma_f32_16x16x32_bf16 v[56:59], a[148:151], a[96:99], v[56:59]
  ds_read_b64_tr_b16 a[144:145], v153 offset:12288
  ds_read_b64_tr_b16 a[146:147], v153 offset:14336
  v_mfma_f32_16x16x32_bf16 v[60:63], a[148:151], a[100:103], v[60:63]
  s_waitcnt lgkmcnt(8)
  s_add_u32 s43, s43, 16384
  v_mfma_f32_16x16x32_bf16 v[0:3], a[152:155], a[104:107], v[0:3]
  ds_read_b64_tr_b16 a[148:149], v156 offset:12288
  ds_read_b64_tr_b16 a[150:151], v156 offset:14336
  v_mfma_f32_16x16x32_bf16 v[4:7], a[152:155], a[108:111], v[4:7]
  s_waitcnt lgkmcnt(8)
  buffer_load_dwordx4 v147, s[8:11], s20 offen offset:3072 lds
  v_mfma_f32_16x16x32_bf16 v[8:11], a[156:159], a[104:107], v[8:11]
  ds_read_b64_tr_b16 a[152:153], v159 offset:12288
  ds_read_b64_tr_b16 a[154:155], v159 offset:14336
  v_mfma_f32_16x16x32_bf16 v[12:15], a[156:159], a[108:111], v[12:15]
  s_waitcnt lgkmcnt(8)
  s_add_u32 s20, s20, s29
  s_add_u32 m0, s21, 0
  v_mfma_f32_16x16x32_bf16 v[16:19], a[160:163], a[104:107], v[16:19]
  ds_read_b64_tr_b16 a[156:157], v162 offset:12288
  ds_read_b64_tr_b16 a[158:159], v162 offset:14336
  v_mfma_f32_16x16x32_bf16 v[20:23], a[160:163], a[108:111], v[20:23]
  s_waitcnt lgkmcnt(8)
  v_mfma_f32_16x16x32_bf16 v[24:27], a[164:167], a[104:107], v[24:27]
  ds_read_b64_tr_b16 a[160:161], v153 offset:16384
  ds_read_b64_tr_b16 a[162:163], v153 offset:18432
  v_mfma_f32_16x16x32_bf16 v[28:31], a[164:167], a[108:111], v[28:31]
  s_waitcnt lgkmcnt(8)
  v_mfma_f32_16x16x32_bf16 v[32:35], a[144:147], a[104:107], v[32:35]
  ds_read_b64_tr_b16 a[164:165], v156 offset:16384
  ds_read_b64_tr_b16 a[166:167], v156 offset:18432
  v_mfma_f32_16x16x32_bf16 v[36:39], a[144:147], a[108:111], v[36:39]
  s_waitcnt lgkmcnt(8)
  buffer_load_dwordx4 v144, s[8:11], s20 offen offset:0 lds
  v_mfma_f32_16x16x32_bf16 v[40:43], a[148:151], a[104:107], v[40:43]
  ds_read_b64_tr_b16 a[144:145], v159 offset:16384
  ds_read_b64_tr_b16 a[146:147], v159 offset:18432
  v_mfma_f32_16x16x32_bf16 v[44:47], a[148:151], a[108:111], v[44:47]
  s_waitcnt lgkmcnt(8)
  v_mfma_f32_16x16x32_bf16 v[48:51], a[152:155], a[104:107], v[48:51]
  ds_read_b64_tr_b16 a[148:149], v162 offset:16384
  ds_read_b64_tr_b16 a[150:151], v162 offset:18432
  v_mfma_f32_16x16x32_bf16 v[52:55], a[152:155], a[108:111], v[52:55]
  s_waitcnt lgkmcnt(8)
  buffer_load_dwordx4 a[224:227], v164, s[92:95], s43 offen offset:0 sc1
  v_mfma_f32_16x16x32_bf16 v[56:59], a[156:159], a[104:107], v[56:59]
  ds_read_b64_tr_b16 a[152:153], v153 offset:20480
  ds_read_b64_tr_b16 a[154:155], v153 offset:22528
  v_mfma_f32_16x16x32_bf16 v[60:63], a[156:159], a[108:111], v[60:63]
  s_waitcnt lgkmcnt(8)
  v_mfma_f32_16x16x32_bf16 v[0:3], a[160:163], a[112:115], v[0:3]
  ds_read_b64_tr_b16 a[156:157], v156 offset:20480
  ds_read_b64_tr_b16 a[158:159], v156 offset:22528
  v_mfma_f32_16x16x32_bf16 v[4:7], a[160:163], a[116:119], v[4:7]
  s_waitcnt lgkmcnt(8)
  buffer_load_dwordx4 v145, s[8:11], s20 offen offset:1024 lds
  v_mfma_f32_16x16x32_bf16 v[8:11], a[164:167], a[112:115], v[8:11]
  ds_read_b64_tr_b16 a[160:161], v159 offset:20480
  ds_read_b64_tr_b16 a[162:163], v159 offset:22528
  v_mfma_f32_16x16x32_bf16 v[12:15], a[164:167], a[116:119], v[12:15]
  s_waitcnt lgkmcnt(8)
  v_mfma_f32_16x16x32_bf16 v[16:19], a[144:147], a[112:115], v[16:19]
  ds_read_b64_tr_b16 a[164:165], v162 offset:20480
  ds_read_b64_tr_b16 a[166:167], v162 offset:22528
  v_mfma_f32_16x16x32_bf16 v[20:23], a[144:147], a[116:119], v[20:23]
  s_waitcnt lgkmcnt(8)
  v_mfma_f32_16x16x32_bf16 v[24:27], a[148:151], a[112:115], v[24:27]
  ds_read_b64_tr_b16 a[144:145], v153 offset:24576
  ds_read_b64_tr_b16 a[146:147], v153 offset:26624
  v_mfma_f32_16x16x32_bf16 v[28:31], a[148:151], a[116:119], v[28:31]
  s_waitcnt lgkmcnt(8)
  buffer_load_dwordx4 v[172:175], off, s[12:15], s33 sc1
  v_mfma_f32_16x16x32_bf16 v[32:35], a[152:155], a[112:115], v[32:35]
  ds_read_b64_tr_b16 a[148:149], v156 offset:24576
  ds_read_b64_tr_b16 a[150:151], v156 offset:26624
  v_mfma_f32_16x16x32_bf16 v[36:39], a[152:155], a[116:119], v[36:39]
  s_waitcnt lgkmcnt(8)
  buffer_load_dwordx4 v146, s[8:11], s20 offen offset:2048 lds
  v_mfma_f32_16x16x32_bf16 v[40:43], a[156:159], a[112:115], v[40:43]
  ds_read_b64_tr_b16 a[152:153], v159 offset:24576
  ds_read_b64_tr_b16 a[154:155], v159 offset:26624
  v_mfma_f32_16x16x32_bf16 v[44:47], a[156:159], a[116:119], v[44:47]
  s_waitcnt lgkmcnt(8)
  v_mfma_f32_16x16x32_bf16 v[48:51], a[160:163], a[112:115], v[48:51]
  ds_read_b64_tr_b16 a[156:157], v162 offset:24576
  ds_read_b64_tr_b16 a[158:159], v162 offset:26624
  v_mfma_f32_16x16x32_bf16 v[52:55], a[160:163], a[116:119], v[52:55]
  s_waitcnt lgkmcnt(8)
  buffer_load_dwordx4 a[228:231], v164, s[92:95], s43 offen offset:1024 sc1
  v_mfma_f32_16x16x32_bf16 v[56:59], a[164:167], a[112:115], v[56:59]
  ds_read_b64_tr_b16 a[160:161], v153 offset:28672
  ds_read_b64_tr_b16 a[162:163], v153 offset:30720
  v_mfma_f32_16x16x32_bf16 v[60:63], a[164:167], a[116:119], v[60:63]
  s_waitcnt lgkmcnt(8)
  s_mov_b32 s23, s26
  s_add_u32 s26, s26, 65536
  v_mfma_f32_16x16x32_bf16 v[0:3], a[144:147], a[120:123], v[0:3]
  ds_read_b64_tr_b16 a[164:165], v156 offset:28672
  ds_read_b64_tr_b16 a[166:167], v156 offset:30720
  v_mfma_f32_16x16x32_bf16 v[4:7], a[144:147], a[124:127], v[4:7]
  s_waitcnt lgkmcnt(8)
  buffer_load_dwordx4 v147, s[8:11], s20 offen offset:3072 lds
  v_mfma_f32_16x16x32_bf16 v[8:11], a[148:151], a[120:123], v[8:11]
  ds_read_b64_tr_b16 a[144:145], v159 offset:28672
  ds_read_b64_tr_b16 a[146:147], v159 offset:30720
  v_mfma_f32_16x16x32_bf16 v[12:15], a[148:151], a[124:127], v[12:15]
  s_waitcnt lgkmcnt(8)
  s_add_u32 s20, s20, s27
  s_add_u32 m0, s21, 16384
  v_mfma_f32_16x16x32_bf16 v[16:19], a[152:155], a[120:123], v[16:19]
  ds_read_b64_tr_b16 a[148:149], v162 offset:28672
  ds_read_b64_tr_b16 a[150:151], v162 offset:30720
  v_mfma_f32_16x16x32_bf16 v[20:23], a[152:155], a[124:127], v[20:23]
  s_waitcnt lgkmcnt(8)
  s_add_u32 s35, s35, 1
  v_mfma_f32_16x16x32_bf16 v[24:27], a[156:159], a[120:123], v[24:27]
  ds_read_b64_tr_b16 a[152:153], v153 offset:32768
  ds_read_b64_tr_b16 a[154:155], v153 offset:34816
  v_mfma_f32_16x16x32_bf16 v[28:31], a[156:159], a[124:127], v[28:31]
  s_waitcnt lgkmcnt(8)
  v_mfma_f32_16x16x32_bf16 v[32:35], a[160:163], a[120:123], v[32:35]
  ds_read_b64_tr_b16 a[156:157], v156 offset:32768
  ds_read_b64_tr_b16 a[158:159], v156 offset:34816
  v_mfma_f32_16x16x32_bf16 v[36:39], a[160:163], a[124:127], v[36:39]
  s_waitcnt lgkmcnt(8)
  buffer_load_dwordx4 v144, s[8:11], s20 offen offset:0 lds
  v_mfma_f32_16x16x32_bf16 v[40:43], a[164:167], a[120:123], v[40:43]
  ds_read_b64_tr_b16 a[160:161], v159 offset:32768
  ds_read_b64_tr_b16 a[162:163], v159 offset:34816
  v_mfma_f32_16x16x32_bf16 v[44:47], a[164:167], a[124:127], v[44:47]
  s_waitcnt lgkmcnt(8)
  v_mfma_f32_16x16x32_bf16 v[48:51], a[144:147], a[120:123], v[48:51]
  ds_read_b64_tr_b16 a[164:165], v162 offset:32768
  ds_read_b64_tr_b16 a[166:167], v162 offset:34816
  v_mfma_f32_16x16x32_bf16 v[52:55], a[144:147], a[124:127], v[52:55]
  s_waitcnt lgkmcnt(8)
  buffer_load_dwordx4 a[232:235], v164, s[92:95], s43 offen offset:2048 sc1
  v_mfma_f32_16x16x32_bf16 v[56:59], a[148:151], a[120:123], v[56:59]
  ds_read_b64_tr_b16 a[144:145], v153 offset:36864
  ds_read_b64_tr_b16 a[146:147], v153 offset:38912
  v_mfma_f32_16x16x32_bf16 v[60:63], a[148:151], a[124:127], v[60:63]
  s_waitcnt lgkmcnt(8)
  v_mfma_f32_16x16x32_bf16 v[0:3], a[152:155], a[128:131], v[0:3]
  ds_read_b64_tr_b16 a[148:149], v156 offset:36864
  ds_read_b64_tr_b16 a[150:151], v156 offset:38912
  v_mfma_f32_16x16x32_bf16 v[4:7], a[152:155], a[132:135], v[4:7]
  s_waitcnt lgkmcnt(8)
  buffer_load_dwordx4 v145, s[8:11], s20 offen offset:1024 lds
  v_mfma_f32_16x16x32_bf16 v[8:11], a[156:159], a[128:131], v[8:11]
  ds_read_b64_tr_b16 a[152:153], v159 offset:36864
  ds_read_b64_tr_b16 a[154:155], v159 offset:38912
  v_mfma_f32_16x16x32_bf16 v[12:15], a[156:159], a[132:135], v[12:15]
  s_waitcnt lgkmcnt(8)
  v_mfma_f32_16x16x32_bf16 v[16:19], a[160:163], a[128:131], v[16:19]
  ds_read_b64_tr_b16 a[156:157], v162 offset:36864
  ds_read_b64_tr_b16 a[158:159], v162 offset:38912
  v_mfma_f32_16x16x32_bf16 v[20:23], a[160:163], a[132:135], v[20:23]
  s_waitcnt lgkmcnt(8)
  v_mfma_f32_16x16x32_bf16 v[24:27], a[164:167], a[128:131], v[24:27]
  ds_read_b64_tr_b16 a[160:161], v153 offset:40960
  ds_read_b64_tr_b16 a[162:163], v153 offset:43008
  v_mfma_f32_16x16x32_bf16 v[28:31], a[164:167], a[132:135], v[28:31]
  s_waitcnt lgkmcnt(8)
  v_mfma_f32_16x16x32_bf16 v[32:35], a[144:147], a[128:131], v[32:35]
  ds_read_b64_tr_b16 a[164:165], v156 offset:40960
  ds_read_b64_tr_b16 a[166:167], v156 offset:43008
  v_mfma_f32_16x16x32_bf16 v[36:39], a[144:147], a[132:135], v[36:39]
  s_waitcnt lgkmcnt(8)
  buffer_load_dwordx4 v146, s[8:11], s20 offen offset:2048 lds
  v_mfma_f32_16x16x32_bf16 v[40:43], a[148:151], a[128:131], v[40:43]
  ds_read_b64_tr_b16 a[144:145], v159 offset:40960
  ds_read_b64_tr_b16 a[146:147], v159 offset:43008
  v_mfma_f32_16x16x32_bf16 v[44:47], a[148:151], a[132:135], v[44:47]
  s_waitcnt lgkmcnt(8)
  v_mfma_f32_16x16x32_bf16 v[48:51], a[152:155], a[128:131], v[48:51]
  ds_read_b64_tr_b16 a[148:149], v162 offset:40960
  ds_read_b64_tr_b16 a[150:151], v162 offset:43008
  v_mfma_f32_16x16x32_bf16 v[52:55], a[152:155], a[132:135], v[52:55]
  s_waitcnt lgkmcnt(8)
  buffer_load_dwordx4 a[236:239], v164, s[92:95], s43 offen offset:3072 sc1
  v_mfma_f32_16x16x32_bf16 v[56:59], a[156:159], a[128:131], v[56:59]
  ds_read_b64_tr_b16 a[152:153], v153 offset:45056
  ds_read_b64_tr_b16 a[154:155], v153 offset:47104
  v_mfma_f32_16x16x32_bf16 v[60:63], a[156:159], a[132:135], v[60:63]
  s_waitcnt lgkmcnt(8)
  s_mov_b32 s43, 268435456
  v_mfma_f32_16x16x32_bf16 v[0:3], a[160:163], a[136:139], v[0:3]
  ds_read_b64_tr_b16 a[156:157], v156 offset:45056
  ds_read_b64_tr_b16 a[158:159], v156 offset:47104
  v_mfma_f32_16x16x32_bf16 v[4:7], a[160:163], a[140:143], v[4:7]
  s_waitcnt lgkmcnt(8)
  buffer_load_dwordx4 v147, s[8:11], s20 offen offset:3072 lds
  v_mfma_f32_16x16x32_bf16 v[8:11], a[164:167], a[136:139], v[8:11]
  ds_read_b64_tr_b16 a[160:161], v159 offset:45056
  ds_read_b64_tr_b16 a[162:163], v159 offset:47104
  v_mfma_f32_16x16x32_bf16 v[12:15], a[164:167], a[140:143], v[12:15]
  s_waitcnt lgkmcnt(8)
  s_add_u32 s20, s20, s28
  s_add_u32 m0, s21, 32768
  v_mfma_f32_16x16x32_bf16 v[16:19], a[144:147], a[136:139], v[16:19]
  ds_read_b64_tr_b16 a[164:165], v162 offset:45056
  ds_read_b64_tr_b16 a[166:167], v162 offset:47104
  v_mfma_f32_16x16x32_bf16 v[20:23], a[144:147], a[140:143], v[20:23]
  s_waitcnt vmcnt(13) lgkmcnt(8)
  s_barrier
  v_mfma_f32_16x16x32_bf16 v[24:27], a[148:151], a[136:139], v[24:27]
  ds_read_b64_tr_b16 a[144:145], v154 offset:0
  ds_read_b64_tr_b16 a[146:147], v154 offset:2048
  v_mfma_f32_16x16x32_bf16 v[28:31], a[148:151], a[140:143], v[28:31]
  s_waitcnt lgkmcnt(8)
  v_mfma_f32_16x16x32_bf16 v[32:35], a[152:155], a[136:139], v[32:35]
  ds_read_b64_tr_b16 a[148:149], v157 offset:0
  ds_read_b64_tr_b16 a[150:151], v157 offset:2048
  v_mfma_f32_16x16x32_bf16 v[36:39], a[152:155], a[140:143], v[36:39]
  s_waitcnt lgkmcnt(8)
  buffer_load_dwordx4 v144, s[8:11], s20 offen offset:0 lds
  v_mfma_f32_16x16x32_bf16 v[40:43], a[156:159], a[136:139], v[40:43]
  ds_read_b64_tr_b16 a[152:153], v160 offset:0
  ds_read_b64_tr_b16 a[154:155], v160 offset:2048
  v_mfma_f32_16x16x32_bf16 v[44:47], a[156:159], a[140:143], v[44:47]
  s_waitcnt lgkmcnt(8)
  v_mfma_f32_16x16x32_bf16 v[48:51], a[160:163], a[136:139], v[48:51]
  ds_read_b64_tr_b16 a[156:157], v163 offset:0
  ds_read_b64_tr_b16 a[158:159], v163 offset:2048
  v_mfma_f32_16x16x32_bf16 v[52:55], a[160:163], a[140:143], v[52:55]
  s_waitcnt lgkmcnt(8)
  s_sub_u32 s22, s22, 1
  v_mfma_f32_16x16x32_bf16 v[56:59], a[164:167], a[136:139], v[56:59]
  ds_read_b64_tr_b16 a[160:161], v154 offset:4096
  ds_read_b64_tr_b16 a[162:163], v154 offset:6144
  v_mfma_f32_16x16x32_bf16 v[60:63], a[164:167], a[140:143], v[60:63]
  s_waitcnt lgkmcnt(8)
K3_B:
  v_mfma_f32_16x16x32_bf16 v[64:67], a[144:147], a[0:3], 0
  ds_read_b64_tr_b16 a[164:165], v157 offset:4096
  ds_read_b64_tr_b16 a[166:167], v157 offset:6144
  v_mfma_f32_16x16x32_bf16 v[68:71], a[144:147], a[4:7], 0
  s_waitcnt lgkmcnt(8)
  buffer_load_dwordx4 v145, s[8:11], s20 offen offset:1024 lds
  v_mfma_f32_16x16x32_bf16 v[72:75], a[148:151], a[0:3], 0
  ds_read_b64_tr_b16 a[144:145], v160 offset:4096
  ds_read_b64_tr_b16 a[146:147], v160 offset:6144
  v_mfma_f32_16x16x32_bf16 v[76:79], a[148:151], a[4:7], 0
  s_waitcnt lgkmcnt(8)
  v_mfma_f32_16x16x32_bf16 v[80:83], a[152:155], a[0:3], 0
  ds_read_b64_tr_b16 a[148:149], v163 offset:4096
  ds_read_b64_tr_b16 a[150:151], v163 offset:6144
  v_mfma_f32_16x16x32_bf16 v[84:87], a[152:155], a[4:7], 0
  s_waitcnt lgkmcnt(8)
  v_mul_f32 v0, v0, v32
  v_mul_f32 v1, v1, v33
  v_mfma_f32_16x16x32_bf16 v[88:91], a[156:159], a[0:3], 0
  ds_read_b64_tr_b16 a[152:153], v154 offset:8192
  ds_read_b64_tr_b16 a[154:155], v154 offset:10240
  v_mfma_f32_16x16x32_bf16 v[92:95], a[156:159], a[4:7], 0
  s_waitcnt lgkmcnt(8)
  v_cvt_pk_bf16_f32 v128, v0, v1
  v_mul_f32 v2, v2, v34
  v_mfma_f32_16x16x32_bf16 v[96:99], a[160:163], a[0:3], 0
  ds_read_b64_tr_b16 a[156:157], v157 offset:8192
  ds_read_b64_tr_b16 a[158:159], v157 offset:10240
  v_mfma_f32_16x16x32_bf16 v[100:103], a[160:163], a[4:7], 0
  s_waitcnt lgkmcnt(8)
  buffer_load_dwordx4 v146, s[8:11], s20 offen offset:2048 lds
  v_mfma_f32_16x16x32_bf16 v[104:107], a[164:167], a[0:3], 0
  ds_read_b64_tr_b16 a[160:161], v160 offset:8192
  ds_read_b64_tr_b16 a[162:163], v160 offset:10240
  v_mfma_f32_16x16x32_bf16 v[108:111], a[164:167], a[4:7], 0
  s_waitcnt lgkmcnt(8)
  v_mul_f32 v3, v3, v35
  v_cvt_pk_bf16_f32 v129, v2, v3
  v_mfma_f32_16x16x32_bf16 v[112:115], a[144:147], a[0:3], 0
  ds_read_b64_tr_b16 a[164:165], v163 offset:8192
  ds_read_b64_tr_b16 a[166:167], v163 offset:10240
  v_mfma_f32_16x16x32_bf16 v[116:119], a[144:147], a[4:7], 0
  s_waitcnt lgkmcnt(8)
  v_mul_f32 v8, v8, v40
  v_mul_f32 v9, v9, v41
  v_mfma_f32_16x16x32_bf16 v[120:123], a[148:151], a[0:3], 0
  ds_read_b64_tr_b16 a[144:145], v154 offset:12288
  ds_read_b64_tr_b16 a[146:147], v154 offset:14336
  v_mfma_f32_16x16x32_bf16 v[124:127], a[148:151], a[4:7], 0
  s_waitcnt lgkmcnt(8)
  v_cvt_pk_bf16_f32 v130, v8, v9
  v_mul_f32 v10, v10, v42
  v_mfma_f32_16x16x32_bf16 v[64:67], a[152:155], a[8:11], v[64:67]
  ds_read_b64_tr_b16 a[148:149], v157 offset:12288
  ds_read_b64_tr_b16 a[150:151], v157 offset:14336
  v_mfma_f32_16x16x32_bf16 v[68:71], a[152:155], a[12:15], v[68:71]
  s_waitcnt lgkmcnt(8)
  buffer_load_dwordx4 v147, s[8:11], s20 offen offset:3072 lds
  v_mfma_f32_16x16x32_bf16 v[72:75], a[156:159], a[8:11], v[72:75]
  ds_read_b64_tr_b16 a[152:153], v160 offset:12288
  ds_read_b64_tr_b16 a[154:155], v160 offset:14336
  v_mfma_f32_16x16x32_bf16 v[76:79], a[156:159], a[12:15], v[76:79]
  s_waitcnt lgkmcnt(8)
  s_add_u32 s20, s20, s29
  s_add_u32 m0, s21, 49152
  v_mfma_f32_16x16x32_bf16 v[80:83], a[160:163], a[8:11], v[80:83]
  ds_read_b64_tr_b16 a[156:157], v163 offset:12288
  ds_read_b64_tr_b16 a[158:159], v163 offset:14336
  v_mfma_f32_16x16x32_bf16 v[84:87], a[160:163], a[12:15], v[84:87]
  s_waitcnt lgkmcnt(8)
  v_mul_f32 v11, v11, v43
  v_cvt_pk_bf16_f32 v131, v10, v11
  v_mfma_f32_16x16x32_bf16 v[88:91], a[164:167], a[8:11], v[88:91]
  ds_read_b64_tr_b16 a[160:161], v154 offset:16384
  ds_read_b64_tr_b16 a[162:163], v154 offset:18432
  v_mfma_f32_16x16x32_bf16 v[92:95], a[164:167], a[12:15], v[92:95]
  s_waitcnt lgkmcnt(8)
  buffer_store_dwordx4 v[128:131], v164, s[92:95], s23 offen offset:0 sc1
  v_mfma_f32_16x16x32_bf16 v[96:99], a[144:147], a[8:11], v[96:99]
  ds_read_b64_tr_b16 a[164:165], v157 offset:16384
  ds_read_b64_tr_b16 a[166:167], v157 offset:18432
  v_mfma_f32_16x16x32_bf16 v[100:103], a[144:147], a[12:15], v[100:103]
  s_waitcnt lgkmcnt(8)
  buffer_load_dwordx4 v144, s[8:11], s20 offen offset:0 lds
  v_mfma_f32_16x16x32_bf16 v[104:107], a[148:151], a[8:11], v[104:107]
  ds_read_b64_tr_b16 a[144:145], v160 offset:16384
  ds_read_b64_tr_b16 a[146:147], v160 offset:18432
  v_mfma_f32_16x16x32_bf16 v[108:111], a[148:151], a[12:15], v[108:111]
  s_waitcnt lgkmcnt(8)
  v_mul_f32 v4, v4, v36
  v_mul_f32 v5, v5, v37
  v_mfma_f32_16x16x32_bf16 v[112:115], a[152:155], a[8:11], v[112:115]
  ds_read_b64_tr_b16 a[148:149], v163 offset:16384
  ds_read_b64_tr_b16 a[150:151], v163 offset:18432
  v_mfma_f32_16x16x32_bf16 v[116:119], a[152:155], a[12:15], v[116:119]
  s_waitcnt lgkmcnt(8)
  v_cvt_pk_bf16_f32 v132, v4, v5
  v_mul_f32 v6, v6, v38
  v_mfma_f32_16x16x32_bf16 v[120:123], a[156:159], a[8:11], v[120:123]
  ds_read_b64_tr_b16 a[152:153], v154 offset:20480
  ds_read_b64_tr_b16 a[154:155], v154 offset:22528
  v_mfma_f32_16x16x32_bf16 v[124:127], a[156:159], a[12:15], v[124:127]
  s_waitcnt lgkmcnt(8)
  v_mul_f32 v7, v7, v39
  v_cvt_pk_bf16_f32 v133, v6, v7
  v_mfma_f32_16x16x32_bf16 v[64:67], a[160:163], a[16:19], v[64:67]
  ds_read_b64_tr_b16 a[156:157], v157 offset:20480
  ds_read_b64_tr_b16 a[158:159], v157 offset:22528
  v_mfma_f32_16x16x32_bf16 v[68:71], a[160:163], a[20:23], v[68:71]
  s_waitcnt lgkmcnt(8)
  buffer_load_dwordx4 v145, s[8:11], s20 offen offset:1024 lds
  v_mfma_f32_16x16x32_bf16 v[72:75], a[164:167], a[16:19], v[72:75]
  ds_read_b64_tr_b16 a[160:161], v160 offset:20480
  ds_read_b64_tr_b16 a[162:163], v160 offset:22528
  v_mfma_f32_16x16x32_bf16 v[76:79], a[164:167], a[20:23], v[76:79]
  s_waitcnt lgkmcnt(8)
  v_mul_f32 v12, v12, v44
  v_mul_f32 v13, v13, v45
  v_mfma_f32_16x16x32_bf16 v[80:83], a[144:147], a[16:19], v[80:83]
  ds_read_b64_tr_b16 a[164:165], v163 offset:20480
  ds_read_b64_tr_b16 a[166:167], v163 offset:22528
  v_mfma_f32_16x16x32_bf16 v[84:87], a[144:147], a[20:23], v[84:87]
  s_waitcnt lgkmcnt(8)
  v_cvt_pk_bf16_f32 v134, v12, v13
  v_mul_f32 v14, v14, v46
  v_mfma_f32_16x16x32_bf16 v[88:91], a[148:151], a[16:19], v[88:91]
  ds_read_b64_tr_b16 a[144:145], v154 offset:24576
  ds_read_b64_tr_b16 a[146:147], v154 offset:26624
  v_mfma_f32_16x16x32_bf16 v[92:95], a[148:151], a[20:23], v[92:95]
  s_waitcnt lgkmcnt(8)
  v_mul_f32 v15, v15, v47
  v_cvt_pk_bf16_f32 v135, v14, v15
  v_mfma_f32_16x16x32_bf16 v[96:99], a[152:155], a[16:19], v[96:99]
  ds_read_b64_tr_b16 a[148:149], v157 offset:24576
  ds_read_b64_tr_b16 a[150:151], v157 offset:26624
  v_mfma_f32_16x16x32_bf16 v[100:103], a[152:155], a[20:23], v[100:103]
  s_waitcnt lgkmcnt(8)
  buffer_load_dwordx4 v146, s[8:11], s20 offen offset:2048 lds
  v_mfma_f32_16x16x32_bf16 v[104:107], a[156:159], a[16:19], v[104:107]
  ds_read_b64_tr_b16 a[152:153], v160 offset:24576
  ds_read_b64_tr_b16 a[154:155], v160 offset:26624
  v_mfma_f32_16x16x32_bf16 v[108:111], a[156:159], a[20:23], v[108:111]
  s_waitcnt lgkmcnt(8)
  s_cmp_eq_u32 s22, 1
  s_cbranch_scc1 K3_hsB
K3_hsbackB:
  v_mfma_f32_16x16x32_bf16 v[112:115], a[160:163], a[16:19], v[112:115]
  ds_read_b64_tr_b16 a[156:157], v163 offset:24576
  ds_read_b64_tr_b16 a[158:159], v163 offset:26624
  v_mfma_f32_16x16x32_bf16 v[116:119], a[160:163], a[20:23], v[116:119]
  s_waitcnt lgkmcnt(8)
  buffer_load_dwordx4 a[240:243], v164, s[92:95], s43 offen offset:0 sc1
  v_mfma_f32_16x16x32_bf16 v[120:123], a[164:167], a[16:19], v[120:123]
  ds_read_b64_tr_b16 a[160:161], v154 offset:28672
  ds_read_b64_tr_b16 a[162:163], v154 offset:30720
  v_mfma_f32_16x16x32_bf16 v[124:127], a[164:167], a[20:23], v[124:127]
  s_waitcnt lgkmcnt(8)
  buffer_store_dwordx4 v[132:135], v164, s[92:95], s23 offen offset:1024 sc1
  v_mfma_f32_16x16x32_bf16 v[64:67], a[144:147], a[24:27], v[64:67]
  ds_read_b64_tr_b16 a[164:165], v157 offset:28672
  ds_read_b64_tr_b16 a[166:167], v157 offset:30720
  v_mfma_f32_16x16x32_bf16 v[68:71], a[144:147], a[28:31], v[68:71]
  s_waitcnt lgkmcnt(8)
  buffer_load_dwordx4 v147, s[8:11], s20 offen offset:3072 lds
  v_mfma_f32_16x16x32_bf16 v[72:75], a[148:151], a[24:27], v[72:75]
  ds_read_b64_tr_b16 a[144:145], v160 offset:28672
  ds_read_b64_tr_b16 a[146:147], v160 offset:30720
  v_mfma_f32_16x16x32_bf16 v[76:79], a[148:151], a[28:31], v[76:79]
  s_waitcnt lgkmcnt(8)
  s_add_u32 s20, s20, s27
  s_add_u32 m0, s21, 65536
  v_mfma_f32_16x16x32_bf16 v[80:83], a[152:155], a[24:27], v[80:83]
  ds_read_b64_tr_b16 a[148:149], v163 offset:28672
  ds_read_b64_tr_b16 a[150:151], v163 offset:30720
  v_mfma_f32_16x16x32_bf16 v[84:87], a[152:155], a[28:31], v[84:87]
  s_waitcnt lgkmcnt(8)
  buffer_load_dwordx4 a[244:247], v164, s[92:95], s43 offen offset:1024 sc1
  v_mfma_f32_16x16x32_bf16 v[88:91], a[156:159], a[24:27], v[88:91]
  ds_read_b64_tr_b16 a[152:153], v154 offset:32768
  ds_read_b64_tr_b16 a[154:155], v154 offset:34816
  v_mfma_f32_16x16x32_bf16 v[92:95], a[156:159], a[28:31], v[92:95]
  s_waitcnt lgkmcnt(8)
  v_mul_f32 v16, v16, v48
  v_mul_f32 v17, v17, v49
  v_mfma_f32_16x16x32_bf16 v[96:99], a[160:163], a[24:27], v[96:99]
  ds_read_b64_tr_b16 a[156:157], v157 offset:32768
  ds_read_b64_tr_b16 a[158:159], v157 offset:34816
  v_mfma_f32_16x16x32_bf16 v[100:103], a[160:163], a[28:31], v[100:103]
  s_waitcnt lgkmcnt(8)
  buffer_load_dwordx4 v144, s[8:11], s20 offen offset:0 lds
  v_mfma_f32_16x16x32_bf16 v[104:107], a[164:167], a[24:27], v[104:107]
  ds_read_b64_tr_b16 a[160:161], v160 offset:32768
  ds_read_b64_tr_b16 a[162:163], v160 offset:34816
  v_mfma_f32_16x16x32_bf16 v[108:111], a[164:167], a[28:31], v[108:111]
  s_waitcnt lgkmcnt(8)
  v_cvt_pk_bf16_f32 v136, v16, v17
  v_mul_f32 v18, v18, v50
  v_mfma_f32_16x16x32_bf16 v[112:115], a[144:147], a[24:27], v[112:115]
  ds_read_b64_tr_b16 a[164:165], v163 offset:32768
  ds_read_b64_tr_b16 a[166:167], v163 offset:34816
  v_mfma_f32_16x16x32_bf16 v[116:119], a[144:147], a[28:31], v[116:119]
  s_waitcnt lgkmcnt(8)
  v_mul_f32 v19, v19, v51
  v_cvt_pk_bf16_f32 v137, v18, v19
  v_mfma_f32_16x16x32_bf16 v[120:123], a[148:151], a[24:27], v[120:123]
  ds_read_b64_tr_b16 a[144:145], v154 offset:36864
  ds_read_b64_tr_b16 a[146:147], v154 offset:38912
  v_mfma_f32_16x16x32_bf16 v[124:127], a[148:151], a[28:31], v[124:127]
  s_waitcnt lgkmcnt(8)
  v_mul_f32 v24, v24, v56
  v_mul_f32 v25, v25, v57
  v_mfma_f32_16x16x32_bf16 v[64:67], a[152:155], a[32:35], v[64:67]
  ds_read_b64_tr_b16 a[148:149], v157 offset:36864
  ds_read_b64_tr_b16 a[150:151], v157 offset:38912
  v_mfma_f32_16x16x32_bf16 v[68:71], a[152:155], a[36:39], v[68:71]
  s_waitcnt lgkmcnt(8)
  buffer_load_dwordx4 v145, s[8:11], s20 offen offset:1024 lds
  v_mfma_f32_16x16x32_bf16 v[72:75], a[156:159], a[32:35], v[72:75]
  ds_read_b64_tr_b16 a[152:153], v160 offset:36864
  ds_read_b64_tr_b16 a[154:155], v160 offset:38912
  v_mfma_f32_16x16x32_bf16 v[76:79], a[156:159], a[36:39], v[76:79]
  s_waitcnt lgkmcnt(8)
  v_cvt_pk_bf16_f32 v138, v24, v25
  v_mul_f32 v26, v26, v58
  v_mfma_f32_16x16x32_bf16 v[80:83], a[160:163], a[32:35], v[80:83]
  ds_read_b64_tr_b16 a[156:157], v163 offset:36864
  ds_read_b64_tr_b16 a[158:159], v163 offset:38912
  v_mfma_f32_16x16x32_bf16 v[84:87], a[160:163], a[36:39], v[84:87]
  s_waitcnt lgkmcnt(8)
  buffer_load_dwordx4 a[248:251], v164, s[92:95], s43 offen offset:2048 sc1
  v_mfma_f32_16x16x32_bf16 v[88:91], a[164:167], a[32:35], v[88:91]
  ds_read_b64_tr_b16 a[160:161], v154 offset:40960
  ds_read_b64_tr_b16 a[162:163], v154 offset:43008
  v_mfma_f32_16x16x32_bf16 v[92:95], a[164:167], a[36:39], v[92:95]
  s_waitcnt lgkmcnt(8)
  v_mul_f32 v27, v27, v59
  v_cvt_pk_bf16_f32 v139, v26, v27
  v_mfma_f32_16x16x32_bf16 v[96:99], a[144:147], a[32:35], v[96:99]
  ds_read_b64_tr_b16 a[164:165], v157 offset:40960
  ds_read_b64_tr_b16 a[166:167], v157 offset:43008
  v_mfma_f32_16x16x32_bf16 v[100:103], a[144:147], a[36:39], v[100:103]
  s_waitcnt lgkmcnt(8)
  buffer_load_dwordx4 v146, s[8:11], s20 offen offset:2048 lds
  v_mfma_f32_16x16x32_bf16 v[104:107], a[148:151], a[32:35], v[104:107]
  ds_read_b64_tr_b16 a[144:145], v160 offset:40960
  ds_read_b64_tr_b16 a[146:147], v160 offset:43008
  v_mfma_f32_16x16x32_bf16 v[108:111], a[148:151], a[36:39], v[108:111]
  s_waitcnt lgkmcnt(8)
  buffer_store_dwordx4 v[136:139], v164, s[92:95], s23 offen offset:2048 sc1
  v_mfma_f32_16x16x32_bf16 v[112:115], a[152:155], a[32:35], v[112:115]
  ds_read_b64_tr_b16 a[148:149], v163 offset:40960
  ds_read_b64_tr_b16 a[150:151], v163 offset:43008
  v_mfma_f32_16x16x32_bf16 v[116:119], a[152:155], a[36:39], v[116:119]
  s_waitcnt lgkmcnt(8)
  buffer_load_dwordx4 a[252:255], v164, s[92:95], s43 offen offset:3072 sc1
  v_mfma_f32_16x16x32_bf16 v[120:123], a[156:159], a[32:35], v[120:123]
  ds_read_b64_tr_b16 a[152:153], v154 offset:45056
  ds_read_b64_tr_b16 a[154:155], v154 offset:47104
  v_mfma_f32_16x16x32_bf16 v[124:127], a[156:159], a[36:39], v[124:127]
  s_waitcnt lgkmcnt(8)
  s_add_u32 s43, s43, 16384
  v_mul_f32 v20, v20, v52
  v_mfma_f32_16x16x32_bf16 v[64:67], a[160:163], a[40:43], v[64:67]
  ds_read_b64_tr_b16 a[156:157], v157 offset:45056
  ds_read_b64_tr_b16 a[158:159], v157 offset:47104
  v_mfma_f32_16x16x32_bf16 v[68:71], a[160:163], a[44:47], v[68:71]
  s_waitcnt lgkmcnt(8)
  buffer_load_dwordx4 v147, s[8:11], s20 offen offset:3072 lds
  v_mfma_f32_16x16x32_bf16 v[72:75], a[164:167], a[40:43], v[72:75]
  ds_read_b64_tr_b16 a[160:161], v160 offset:45056
  ds_read_b64_tr_b16 a[162:163], v160 offset:47104
  v_mfma_f32_16x16x32_bf16 v[76:79], a[164:167], a[44:47], v[76:79]
  s_waitcnt lgkmcnt(8)
  s_add_u32 s20, s20, s28
  s_add_u32 m0, s21, 81920
  v_mfma_f32_16x16x32_bf16 v[80:83], a[144:147], a[40:43], v[80:83]
  ds_read_b64_tr_b16 a[164:165], v163 offset:45056
  ds_read_b64_tr_b16 a[166:167], v163 offset:47104
  v_mfma_f32_16x16x32_bf16 v[84:87], a[144:147], a[44:47], v[84:87]
  s_waitcnt vmcnt(15) lgkmcnt(8)
  s_barrier
  v_mul_f32 v21, v21, v53
  v_mfma_f32_16x16x32_bf16 v[88:91], a[148:151], a[40:43], v[88:91]
  ds_read_b64_tr_b16 a[144:145], v152 offset:0
  ds_read_b64_tr_b16 a[146:147], v152 offset:2048
  v_mfma_f32_16x16x32_bf16 v[92:95], a[148:151], a[44:47], v[92:95]
  s_waitcnt lgkmcnt(8)
  s_cmp_eq_u32 s35, 0
  s_cbranch_scc1 K3_r2B
K3_r2backB:
  v_mfma_f32_16x16x32_bf16 v[96:99], a[152:155], a[40:43], v[96:99]
  ds_read_b64_tr_b16 a[148:149], v155 offset:0
  ds_read_b64_tr_b16 a[150:151], v155 offset:2048
  v_mfma_f32_16x16x32_bf16 v[100:103], a[152:155], a[44:47], v[100:103]
  s_waitcnt lgkmcnt(8)
  buffer_load_dwordx4 v144, s[8:11], s20 offen offset:0 lds
  v_mfma_f32_16x16x32_bf16 v[104:107], a[156:159], a[40:43], v[104:107]
  ds_read_b64_tr_b16 a[152:153], v158 offset:0
  ds_read_b64_tr_b16 a[154:155], v158 offset:2048
  v_mfma_f32_16x16x32_bf16 v[108:111], a[156:159], a[44:47], v[108:111]
  s_waitcnt lgkmcnt(8)
  v_cvt_pk_bf16_f32 v140, v20, v21
  v_mul_f32 v22, v22, v54
  v_mfma_f32_16x16x32_bf16 v[112:115], a[160:163], a[40:43], v[112:115]
  ds_read_b64_tr_b16 a[156:157], v161 offset:0
  ds_read_b64_tr_b16 a[158:159], v161 offset:2048
  v_mfma_f32_16x16x32_bf16 v[116:119], a[160:163], a[44:47], v[116:119]
  s_waitcnt lgkmcnt(8)
  v_mul_f32 v23, v23, v55
  v_cvt_pk_bf16_f32 v141, v22, v23
  v_mfma_f32_16x16x32_bf16 v[120:123], a[164:167], a[40:43], v[120:123]
  ds_read_b64_tr_b16 a[160:161], v152 offset:4096
  ds_read_b64_tr_b16 a[162:163], v152 offset:6144
  v_mfma_f32_16x16x32_bf16 v[124:127], a[164:167], a[44:47], v[124:127]
  s_waitcnt lgkmcnt(8)
  v_mul_f32 v28, v28, v60
  v_mul_f32 v29, v29, v61
  v_mfma_f32_16x16x32_bf16 v[64:67], a[144:147], a[48:51], v[64:67]
  ds_read_b64_tr_b16 a[164:165], v155 offset:4096
  ds_read_b64_tr_b16 a[166:167], v155 offset:6144
  v_mfma_f32_16x16x32_bf16 v[68:71], a[144:147], a[52:55], v[68:71]
  s_waitcnt lgkmcnt(8)
  buffer_load_dwordx4 v145, s[8:11], s20 offen offset:1024 lds
  v_mfma_f32_16x16x32_bf16 v[72:75], a[148:151], a[48:51], v[72:75]
  ds_read_b64_tr_b16 a[144:145], v158 offset:4096
  ds_read_b64_tr_b16 a[146:147], v158 offset:6144
  v_mfma_f32_16x16x32_bf16 v[76:79], a[148:151], a[52:55], v[76:79]
  s_waitcnt lgkmcnt(8)
  v_cvt_pk_bf16_f32 v142, v28, v29
  v_mul_f32 v30, v30, v62
  v_mfma_f32_16x16x32_bf16 v[80:83], a[152:155], a[48:51], v[80:83]
  ds_read_b64_tr_b16 a[148:149], v161 offset:4096
  ds_read_b64_tr_b16 a[150:151], v161 offset:6144
  v_mfma_f32_16x16x32_bf16 v[84:87], a[152:155], a[52:55], v[84:87]
  s_waitcnt lgkmcnt(8)
  buffer_load_dwordx4 v[192:195], v164, s[92:95], s43 offen offset:0 sc1
  v_mfma_f32_16x16x32_bf16 v[88:91], a[156:159], a[48:51], v[88:91]
  ds_read_b64_tr_b16 a[152:153], v152 offset:8192
  ds_read_b64_tr_b16 a[154:155], v152 offset:10240
  v_mfma_f32_16x16x32_bf16 v[92:95], a[156:159], a[52:55], v[92:95]
  s_waitcnt lgkmcnt(8)
  v_mul_f32 v31, v31, v63
  v_cvt_pk_bf16_f32 v143, v30, v31
  v_mfma_f32_16x16x32_bf16 v[96:99], a[160:163], a[48:51], v[96:99]
  ds_read_b64_tr_b16 a[156:157], v155 offset:8192
  ds_read_b64_tr_b16 a[158:159], v155 offset:10240
  v_mfma_f32_16x16x32_bf16 v[100:103], a[160:163], a[52:55], v[100:103]
  s_waitcnt lgkmcnt(8)
  buffer_load_dwordx4 v146, s[8:11], s20 offen offset:2048 lds
  v_mfma_f32_16x16x32_bf16 v[104:107], a[164:167], a[48:51], v[104:107]
  ds_read_b64_tr_b16 a[160:161], v158 offset:8192
  ds_read_b64_tr_b16 a[162:163], v158 offset:10240
  v_mfma_f32_16x16x32_bf16 v[108:111], a[164:167], a[52:55], v[108:111]
  s_waitcnt lgkmcnt(8)
  buffer_store_dwordx4 v[140:143], v164, s[92:95], s23 offen offset:3072 sc1
  v_mfma_f32_16x16x32_bf16 v[112:115], a[144:147], a[48:51], v[112:115]
  ds_read_b64_tr_b16 a[164:165], v161 offset:8192
  ds_read_b64_tr_b16 a[166:167], v161 offset:10240
  v_mfma_f32_16x16x32_bf16 v[116:119], a[144:147], a[52:55], v[116:119]
  s_waitcnt lgkmcnt(8)
  buffer_load_dwordx4 v[196:199], v164, s[92:95], s43 offen offset:1024 sc1
  v_mfma_f32_16x16x32_bf16 v[120:123], a[148:151], a[48:51], v[120:123]
  ds_read_b64_tr_b16 a[144:145], v152 offset:12288
  ds_read_b64_tr_b16 a[146:147], v152 offset:14336
  v_mfma_f32_16x16x32_bf16 v[124:127], a[148:151], a[52:55], v[124:127]
  s_waitcnt lgkmcnt(8)
  v_mov_b64 v[0:1], 0
  v_mov_b64 v[2:3], 0
  v_mfma_f32_16x16x32_bf16 v[64:67], a[152:155], a[56:59], v[64:67]
  ds_read_b64_tr_b16 a[148:149], v155 offset:12288
  ds_read_b64_tr_b16 a[150:151], v155 offset:14336
  v_mfma_f32_16x16x32_bf16 v[68:71], a[152:155], a[60:63], v[68:71]
  s_waitcnt lgkmcnt(8)
  buffer_load_dwordx4 v147, s[8:11], s20 offen offset:3072 lds
  v_mfma_f32_16x16x32_bf16 v[72:75], a[156:159], a[56:59], v[72:75]
  ds_read_b64_tr_b16 a[152:153], v158 offset:12288
  ds_read_b64_tr_b16 a[154:155], v158 offset:14336
  v_mfma_f32_16x16x32_bf16 v[76:79], a[156:159], a[60:63], v[76:79]
  s_waitcnt lgkmcnt(8)
  s_mov_b32 s20, s24
  s_add_u32 m0, s21, 98304
  v_mfma_f32_16x16x32_bf16 v[80:83], a[160:163], a[56:59], v[80:83]
  ds_read_b64_tr_b16 a[156:157], v161 offset:12288
  ds_read_b64_tr_b16 a[158:159], v161 offset:14336
  v_mfma_f32_16x16x32_bf16 v[84:87], a[160:163], a[60:63], v[84:87]
  s_waitcnt lgkmcnt(8)
  v_mov_b64 v[4:5], 0
  v_mov_b64 v[6:7], 0
  v_mfma_f32_16x16x32_bf16 v[88:91], a[164:167], a[56:59], v[88:91]
  ds_read_b64_tr_b16 a[160:161], v152 offset:16384
  ds_read_b64_tr_b16 a[162:163], v152 offset:18432
  v_mfma_f32_16x16x32_bf16 v[92:95], a[164:167], a[60:63], v[92:95]
  s_waitcnt lgkmcnt(8)
  s_cmp_eq_u32 s22, 1
  s_cbranch_scc1 K3_switch
K3_switch_back:
  v_mfma_f32_16x16x32_bf16 v[96:99], a[144:147], a[56:59], v[96:99]
  ds_read_b64_tr_b16 a[164:165], v155 offset:16384
  ds_read_b64_tr_b16 a[166:167], v155 offset:18432
  v_mfma_f32_16x16x32_bf16 v[100:103], a[144:147], a[60:63], v[100:103]
  s_waitcnt lgkmcnt(8)
  buffer_load_dwordx4 v144, s[8:11], s20 offen offset:0 lds
  v_mfma_f32_16x16x32_bf16 v[104:107], a[148:151], a[56:59], v[104:107]
  ds_read_b64_tr_b16 a[144:145], v158 offset:16384
  ds_read_b64_tr_b16 a[146:147], v158 offset:18432
  v_mfma_f32_16x16x32_bf16 v[108:111], a[148:151], a[60:63], v[108:111]
  s_waitcnt lgkmcnt(8)
  buffer_load_dword v177, v188, s[96:99], s61 offen
  v_mfma_f32_16x16x32_bf16 v[112:115], a[152:155], a[56:59], v[112:115]
  ds_read_b64_tr_b16 a[148:149], v161 offset:16384
  ds_read_b64_tr_b16 a[150:151], v161 offset:18432
  v_mfma_f32_16x16x32_bf16 v[116:119], a[152:155], a[60:63], v[116:119]
  s_waitcnt lgkmcnt(8)
  v_mov_b64 v[8:9], 0
  v_mov_b64 v[10:11], 0
  v_mfma_f32_16x16x32_bf16 v[120:123], a[156:159], a[56:59], v[120:123]
  ds_read_b64_tr_b16 a[152:153], v152 offset:20480
  ds_read_b64_tr_b16 a[154:155], v152 offset:22528
  v_mfma_f32_16x16x32_bf16 v[124:127], a[156:159], a[60:63], v[124:127]
  s_waitcnt lgkmcnt(8)
  v_mov_b64 v[12:13], 0
  v_mov_b64 v[14:15], 0
  v_mfma_f32_16x16x32_bf16 v[64:67], a[160:163], a[64:67], v[64:67]
  ds_read_b64_tr_b16 a[156:157], v155 offset:20480
  ds_read_b64_tr_b16 a[158:159], v155 offset:22528
  v_mfma_f32_16x16x32_bf16 v[68:71], a[160:163], a[68:71], v[68:71]
  s_waitcnt lgkmcnt(8)
  buffer_load_dwordx4 v145, s[8:11], s20 offen offset:1024 lds
  v_mfma_f32_16x16x32_bf16 v[72:75], a[164:167], a[64:67], v[72:75]
  ds_read_b64_tr_b16 a[160:161], v158 offset:20480
  ds_read_b64_tr_b16 a[162:163], v158 offset:22528
  v_mfma_f32_16x16x32_bf16 v[76:79], a[164:167], a[68:71], v[76:79]
  s_waitcnt lgkmcnt(8)
  s_add_u32 s61, s61, 512
  s_add_u32 s62, s62, 55296
  v_mfma_f32_16x16x32_bf16 v[80:83], a[144:147], a[64:67], v[80:83]
  ds_read_b64_tr_b16 a[164:165], v161 offset:20480
  ds_read_b64_tr_b16 a[166:167], v161 offset:22528
  v_mfma_f32_16x16x32_bf16 v[84:87], a[144:147], a[68:71], v[84:87]
  s_waitcnt lgkmcnt(8)
  buffer_load_dwordx4 v[200:203], v164, s[92:95], s43 offen offset:2048 sc1
  v_mfma_f32_16x16x32_bf16 v[88:91], a[148:151], a[64:67], v[88:91]
  ds_read_b64_tr_b16 a[144:145], v152 offset:24576
  ds_read_b64_tr_b16 a[146:147], v152 offset:26624
  v_mfma_f32_16x16x32_bf16 v[92:95], a[148:151], a[68:71], v[92:95]
  s_waitcnt lgkmcnt(8)
  s_add_u32 s24, s24, 512
  v_mov_b64 v[16:17], 0
  v_mfma_f32_16x16x32_bf16 v[96:99], a[152:155], a[64:67], v[96:99]
  ds_read_b64_tr_b16 a[148:149], v155 offset:24576
  ds_read_b64_tr_b16 a[150:151], v155 offset:26624
  v_mfma_f32_16x16x32_bf16 v[100:103], a[152:155], a[68:71], v[100:103]
  s_waitcnt lgkmcnt(8)
  buffer_load_dwordx4 v146, s[8:11], s20 offen offset:2048 lds
  v_mfma_f32_16x16x32_bf16 v[104:107], a[156:159], a[64:67], v[104:107]
  ds_read_b64_tr_b16 a[152:153], v158 offset:24576
  ds_read_b64_tr_b16 a[154:155], v158 offset:26624
  v_mfma_f32_16x16x32_bf16 v[108:111], a[156:159], a[68:71], v[108:111]
  s_waitcnt lgkmcnt(8)
  s_cmp_eq_u32 s22, 3
  s_cselect_b32 s61, 268435456, s61
  v_mfma_f32_16x16x32_bf16 v[112:115], a[160:163], a[64:67], v[112:115]
  ds_read_b64_tr_b16 a[156:157], v161 offset:24576
  ds_read_b64_tr_b16 a[158:159], v161 offset:26624
  v_mfma_f32_16x16x32_bf16 v[116:119], a[160:163], a[68:71], v[116:119]
  s_waitcnt lgkmcnt(8)
  buffer_load_dwordx4 v[204:207], v164, s[92:95], s43 offen offset:3072 sc1
  v_mfma_f32_16x16x32_bf16 v[120:123], a[164:167], a[64:67], v[120:123]
  ds_read_b64_tr_b16 a[160:161], v152 offset:28672
  ds_read_b64_tr_b16 a[162:163], v152 offset:30720
  v_mfma_f32_16x16x32_bf16 v[124:127], a[164:167], a[68:71], v[124:127]
  s_waitcnt lgkmcnt(8)
  s_add_u32 s43, s43, 16384
  v_mov_b64 v[18:19], 0
  v_mfma_f32_16x16x32_bf16 v[64:67], a[144:147], a[72:75], v[64:67]
  ds_read_b64_tr_b16 a[164:165], v155 offset:28672
  ds_read_b64_tr_b16 a[166:167], v155 offset:30720
  v_mfma_f32_16x16x32_bf16 v[68:71], a[144:147], a[76:79], v[68:71]
  s_waitcnt lgkmcnt(8)
  buffer_load_dwordx4 v147, s[8:11], s20 offen offset:3072 lds
  v_mfma_f32_16x16x32_bf16 v[72:75], a[148:151], a[72:75], v[72:75]
  ds_read_b64_tr_b16 a[144:145], v158 offset:28672
  ds_read_b64_tr_b16 a[146:147], v158 offset:30720
  v_mfma_f32_16x16x32_bf16 v[76:79], a[148:151], a[76:79], v[76:79]
  s_waitcnt lgkmcnt(8)
  s_add_u32 s20, s20, s27
  s_add_u32 m0, s21, 114688
  v_mfma_f32_16x16x32_bf16 v[80:83], a[152:155], a[72:75], v[80:83]
  ds_read_b64_tr_b16 a[148:149], v161 offset:28672
  ds_read_b64_tr_b16 a[150:151], v161 offset:30720
  v_mfma_f32_16x16x32_bf16 v[84:87], a[152:155], a[76:79], v[84:87]
  s_waitcnt lgkmcnt(8)
  v_mov_b64 v[20:21], 0
  v_mov_b64 v[22:23], 0
  v_mfma_f32_16x16x32_bf16 v[88:91], a[156:159], a[72:75], v[88:91]
  ds_read_b64_tr_b16 a[152:153], v152 offset:32768
  ds_read_b64_tr_b16 a[154:155], v152 offset:34816
  v_mfma_f32_16x16x32_bf16 v[92:95], a[156:159], a[76:79], v[92:95]
  s_waitcnt lgkmcnt(8)
  v_mov_b64 v[24:25], 0
  v_mov_b64 v[26:27], 0
  v_mfma_f32_16x16x32_bf16 v[96:99], a[160:163], a[72:75], v[96:99]
  ds_read_b64_tr_b16 a[156:157], v155 offset:32768
  ds_read_b64_tr_b16 a[158:159], v155 offset:34816
  v_mfma_f32_16x16x32_bf16 v[100:103], a[160:163], a[76:79], v[100:103]
  s_waitcnt lgkmcnt(8)
  buffer_load_dwordx4 v144, s[8:11], s20 offen offset:0 lds
  v_mfma_f32_16x16x32_bf16 v[104:107], a[164:167], a[72:75], v[104:107]
  ds_read_b64_tr_b16 a[160:161], v158 offset:32768
  ds_read_b64_tr_b16 a[162:163], v158 offset:34816
  v_mfma_f32_16x16x32_bf16 v[108:111], a[164:167], a[76:79], v[108:111]
  s_waitcnt lgkmcnt(8)
  v_mov_b64 v[28:29], 0
  v_mov_b64 v[30:31], 0
  v_mfma_f32_16x16x32_bf16 v[112:115], a[144:147], a[72:75], v[112:115]
  ds_read_b64_tr_b16 a[164:165], v161 offset:32768
  ds_read_b64_tr_b16 a[166:167], v161 offset:34816
  v_mfma_f32_16x16x32_bf16 v[116:119], a[144:147], a[76:79], v[116:119]
  s_waitcnt lgkmcnt(8)
  buffer_load_dwordx4 v[208:211], v164, s[92:95], s43 offen offset:0 sc1
  v_mfma_f32_16x16x32_bf16 v[120:123], a[148:151], a[72:75], v[120:123]
  ds_read_b64_tr_b16 a[144:145], v152 offset:36864
  ds_read_b64_tr_b16 a[146:147], v152 offset:38912
  v_mfma_f32_16x16x32_bf16 v[124:127], a[148:151], a[76:79], v[124:127]
  s_waitcnt lgkmcnt(8)
  v_mov_b64 v[32:33], 0
  v_mov_b64 v[34:35], 0
  v_mfma_f32_16x16x32_bf16 v[64:67], a[152:155], a[80:83], v[64:67]
  ds_read_b64_tr_b16 a[148:149], v155 offset:36864
  ds_read_b64_tr_b16 a[150:151], v155 offset:38912
  v_mfma_f32_16x16x32_bf16 v[68:71], a[152:155], a[84:87], v[68:71]
  s_waitcnt lgkmcnt(8)
  buffer_load_dwordx4 v145, s[8:11], s20 offen offset:1024 lds
  v_mfma_f32_16x16x32_bf16 v[72:75], a[156:159], a[80:83], v[72:75]
  ds_read_b64_tr_b16 a[152:153], v158 offset:36864
  ds_read_b64_tr_b16 a[154:155], v158 offset:38912
  v_mfma_f32_16x16x32_bf16 v[76:79], a[156:159], a[84:87], v[76:79]
  s_waitcnt lgkmcnt(8)
  v_mov_b64 v[36:37], 0
  v_mov_b64 v[38:39], 0
  v_mfma_f32_16x16x32_bf16 v[80:83], a[160:163], a[80:83], v[80:83]
  ds_read_b64_tr_b16 a[156:157], v161 offset:36864
  ds_read_b64_tr_b16 a[158:159], v161 offset:38912
  v_mfma_f32_16x16x32_bf16 v[84:87], a[160:163], a[84:87], v[84:87]
  s_waitcnt lgkmcnt(8)
  buffer_load_dwordx4 v[212:215], v164, s[92:95], s43 offen offset:1024 sc1
  v_mfma_f32_16x16x32_bf16 v[88:91], a[164:167], a[80:83], v[88:91]
  ds_read_b64_tr_b16 a[160:161], v152 offset:40960
  ds_read_b64_tr_b16 a[162:163], v152 offset:43008
  v_mfma_f32_16x16x32_bf16 v[92:95], a[164:167], a[84:87], v[92:95]
  s_waitcnt lgkmcnt(8)
  v_mov_b64 v[40:41], 0
  v_mov_b64 v[42:43], 0
  v_mfma_f32_16x16x32_bf16 v[96:99], a[144:147], a[80:83], v[96:99]
  ds_read_b64_tr_b16 a[164:165], v155 offset:40960
  ds_read_b64_tr_b16 a[166:167], v155 offset:43008
  v_mfma_f32_16x16x32_bf16 v[100:103], a[144:147], a[84:87], v[100:103]
  s_waitcnt lgkmcnt(8)
  buffer_load_dwordx4 v146, s[8:11], s20 offen offset:2048 lds
  v_mfma_f32_16x16x32_bf16 v[104:107], a[148:151], a[80:83], v[104:107]
  ds_read_b64_tr_b16 a[144:145], v158 offset:40960
  ds_read_b64_tr_b16 a[146:147], v158 offset:43008
  v_mfma_f32_16x16x32_bf16 v[108:111], a[148:151], a[84:87], v[108:111]
  s_waitcnt lgkmcnt(8)
  v_mov_b64 v[44:45], 0
  v_mov_b64 v[46:47], 0
  v_mfma_f32_16x16x32_bf16 v[112:115], a[152:155], a[80:83], v[112:115]
  ds_read_b64_tr_b16 a[148:149], v161 offset:40960
  ds_read_b64_tr_b16 a[150:151], v161 offset:43008
  v_mfma_f32_16x16x32_bf16 v[116:119], a[152:155], a[84:87], v[116:119]
  s_waitcnt lgkmcnt(8)
  v_mov_b64 v[48:49], 0
  v_mov_b64 v[50:51], 0
  v_mfma_f32_16x16x32_bf16 v[120:123], a[156:159], a[80:83], v[120:123]
  ds_read_b64_tr_b16 a[152:153], v152 offset:45056
  ds_read_b64_tr_b16 a[154:155], v152 offset:47104
  v_mfma_f32_16x16x32_bf16 v[124:127], a[156:159], a[84:87], v[124:127]
  s_waitcnt lgkmcnt(8)
  v_mov_b64 v[52:53], 0
  v_mov_b64 v[54:55], 0
  v_mfma_f32_16x16x32_bf16 v[64:67], a[160:163], a[88:91], v[64:67]
  ds_read_b64_tr_b16 a[156:157], v155 offset:45056
  ds_read_b64_tr_b16 a[158:159], v155 offset:47104
  v_mfma_f32_16x16x32_bf16 v[68:71], a[160:163], a[92:95], v[68:71]
  s_waitcnt lgkmcnt(8)
  buffer_load_dwordx4 v147, s[8:11], s20 offen offset:3072 lds
  v_mfma_f32_16x16x32_bf16 v[72:75], a[164:167], a[88:91], v[72:75]
  ds_read_b64_tr_b16 a[160:161], v158 offset:45056
  ds_read_b64_tr_b16 a[162:163], v158 offset:47104
  v_mfma_f32_16x16x32_bf16 v[76:79], a[164:167], a[92:95], v[76:79]
  s_waitcnt lgkmcnt(8)
  s_add_u32 s20, s20, s28
  s_add_u32 m0, s21, 131072
  v_mfma_f32_16x16x32_bf16 v[80:83], a[144:147], a[88:91], v[80:83]
  ds_read_b64_tr_b16 a[164:165], v161 offset:45056
  ds_read_b64_tr_b16 a[166:167], v161 offset:47104
  v_mfma_f32_16x16x32_bf16 v[84:87], a[144:147], a[92:95], v[84:87]
  s_waitcnt vmcnt(13) lgkmcnt(8)
  s_barrier
  v_mov_b64 v[56:57], 0
  v_mfma_f32_16x16x32_bf16 v[88:91], a[148:151], a[88:91], v[88:91]
  ds_read_b64_tr_b16 a[144:145], v153 offset:0
  ds_read_b64_tr_b16 a[146:147], v153 offset:2048
  v_mfma_f32_16x16x32_bf16 v[92:95], a[148:151], a[92:95], v[92:95]
  s_waitcnt lgkmcnt(8)
  v_mov_b32 v176, s35
  v_mov_b64 v[58:59], 0
  v_mfma_f32_16x16x32_bf16 v[96:99], a[152:155], a[88:91], v[96:99]
  ds_read_b64_tr_b16 a[148:149], v156 offset:0
  ds_read_b64_tr_b16 a[150:151], v156 offset:2048
  v_mfma_f32_16x16x32_bf16 v[100:103], a[152:155], a[92:95], v[100:103]
  s_waitcnt lgkmcnt(8)
  buffer_load_dwordx4 v144, s[8:11], s20 offen offset:0 lds
  v_mfma_f32_16x16x32_bf16 v[104:107], a[156:159], a[88:91], v[104:107]
  ds_read_b64_tr_b16 a[152:153], v159 offset:0
  ds_read_b64_tr_b16 a[154:155], v159 offset:2048
  v_mfma_f32_16x16x32_bf16 v[108:111], a[156:159], a[92:95], v[108:111]
  s_waitcnt lgkmcnt(8)
  buffer_store_dword v176, v165, s[12:15], s34 offen sc1
  v_mfma_f32_16x16x32_bf16 v[112:115], a[160:163], a[88:91], v[112:115]
  ds_read_b64_tr_b16 a[156:157], v162 offset:0
  ds_read_b64_tr_b16 a[158:159], v162 offset:2048
  v_mfma_f32_16x16x32_bf16 v[116:119], a[160:163], a[92:95], v[116:119]
  s_waitcnt lgkmcnt(8)
  v_mov_b64 v[60:61], 0
  v_mov_b64 v[62:63], 0
  v_mfma_f32_16x16x32_bf16 v[120:123], a[164:167], a[88:91], v[120:123]
  ds_read_b64_tr_b16 a[160:161], v153 offset:4096
  ds_read_b64_tr_b16 a[162:163], v153 offset:6144
  v_mfma_f32_16x16x32_bf16 v[124:127], a[164:167], a[92:95], v[124:127]
  s_waitcnt lgkmcnt(8)
  v_mfma_f32_16x16x32_bf16 v[64:67], a[144:147], a[96:99], v[64:67]
  ds_read_b64_tr_b16 a[164:165], v156 offset:4096
  ds_read_b64_tr_b16 a[166:167], v156 offset:6144
  v_mfma_f32_16x16x32_bf16 v[68:71], a[144:147], a[100:103], v[68:71]
  s_waitcnt lgkmcnt(8)
  buffer_load_dwordx4 v145, s[8:11], s20 offen offset:1024 lds
  v_mfma_f32_16x16x32_bf16 v[72:75], a[148:151], a[96:99], v[72:75]
  ds_read_b64_tr_b16 a[144:145], v159 offset:4096
  ds_read_b64_tr_b16 a[146:147], v159 offset:6144
  v_mfma_f32_16x16x32_bf16 v[76:79], a[148:151], a[100:103], v[76:79]
  s_waitcnt lgkmcnt(8)
  v_mfma_f32_16x16x32_bf16 v[80:83], a[152:155], a[96:99], v[80:83]
  ds_read_b64_tr_b16 a[148:149], v162 offset:4096
  ds_read_b64_tr_b16 a[150:151], v162 offset:6144
  v_mfma_f32_16x16x32_bf16 v[84:87], a[152:155], a[100:103], v[84:87]
  s_waitcnt lgkmcnt(8)
  buffer_load_dwordx4 v[216:219], v164, s[92:95], s43 offen offset:2048 sc1
  v_mfma_f32_16x16x32_bf16 v[88:91], a[156:159], a[96:99], v[88:91]
  ds_read_b64_tr_b16 a[152:153], v153 offset:8192
  ds_read_b64_tr_b16 a[154:155], v153 offset:10240
  v_mfma_f32_16x16x32_bf16 v[92:95], a[156:159], a[100:103], v[92:95]
  s_waitcnt lgkmcnt(8)
  v_mfma_f32_16x16x32_bf16 v[96:99], a[160:163], a[96:99], v[96:99]
  ds_read_b64_tr_b16 a[156:157], v156 offset:8192
  ds_read_b64_tr_b16 a[158:159], v156 offset:10240
  v_mfma_f32_16x16x32_bf16 v[100:103], a[160:163], a[100:103], v[100:103]
  s_waitcnt lgkmcnt(8)
  buffer_load_dwordx4 v146, s[8:11], s20 offen offset:2048 lds
  v_mfma_f32_16x16x32_bf16 v[104:107], a[164:167], a[96:99], v[104:107]
  ds_read_b64_tr_b16 a[160:161], v159 offset:8192
  ds_read_b64_tr_b16 a[162:163], v159 offset:10240
  v_mfma_f32_16x16x32_bf16 v[108:111], a[164:167], a[100:103], v[108:111]
  s_waitcnt lgkmcnt(8)
  v_mfma_f32_16x16x32_bf16 v[112:115], a[144:147], a[96:99], v[112:115]
  ds_read_b64_tr_b16 a[164:165], v162 offset:8192
  ds_read_b64_tr_b16 a[166:167], v162 offset:10240
  v_mfma_f32_16x16x32_bf16 v[116:119], a[144:147], a[100:103], v[116:119]
  s_waitcnt lgkmcnt(8)
  buffer_load_dwordx4 v[220:223], v164, s[92:95], s43 offen offset:3072 sc1
  v_mfma_f32_16x16x32_bf16 v[120:123], a[148:151], a[96:99], v[120:123]
  ds_read_b64_tr_b16 a[144:145], v153 offset:12288
  ds_read_b64_tr_b16 a[146:147], v153 offset:14336
  v_mfma_f32_16x16x32_bf16 v[124:127], a[148:151], a[100:103], v[124:127]
  s_waitcnt lgkmcnt(8)
  s_add_u32 s43, s43, 16384
  v_mfma_f32_16x16x32_bf16 v[64:67], a[152:155], a[104:107], v[64:67]
  ds_read_b64_tr_b16 a[148:149], v156 offset:12288
  ds_read_b64_tr_b16 a[150:151], v156 offset:14336
  v_mfma_f32_16x16x32_bf16 v[68:71], a[152:155], a[108:111], v[68:71]
  s_waitcnt lgkmcnt(8)
  buffer_load_dwordx4 v147, s[8:11], s20 offen offset:3072 lds
  v_mfma_f32_16x16x32_bf16 v[72:75], a[156:159], a[104:107], v[72:75]
  ds_read_b64_tr_b16 a[152:153], v159 offset:12288
  ds_read_b64_tr_b16 a[154:155], v159 offset:14336
  v_mfma_f32_16x16x32_bf16 v[76:79], a[156:159], a[108:111], v[76:79]
  s_waitcnt lgkmcnt(8)
  s_add_u32 s20, s20, s29
  s_add_u32 m0, s21, 0
  v_mfma_f32_16x16x32_bf16 v[80:83], a[160:163], a[104:107], v[80:83]
  ds_read_b64_tr_b16 a[156:157], v162 offset:12288
  ds_read_b64_tr_b16 a[158:159], v162 offset:14336
  v_mfma_f32_16x16x32_bf16 v[84:87], a[160:163], a[108:111], v[84:87]
  s_waitcnt lgkmcnt(8)
  v_mfma_f32_16x16x32_bf16 v[88:91], a[164:167], a[104:107], v[88:91]
  ds_read_b64_tr_b16 a[160:161], v153 offset:16384
  ds_read_b64_tr_b16 a[162:163], v153 offset:18432
  v_mfma_f32_16x16x32_bf16 v[92:95], a[164:167], a[108:111], v[92:95]
  s_waitcnt lgkmcnt(8)
  v_mfma_f32_16x16x32_bf16 v[96:99], a[144:147], a[104:107], v[96:99]
  ds_read_b64_tr_b16 a[164:165], v156 offset:16384
  ds_read_b64_tr_b16 a[166:167], v156 offset:18432
  v_mfma_f32_16x16x32_bf16 v[100:103], a[144:147], a[108:111], v[100:103]
  s_waitcnt lgkmcnt(8)
  buffer_load_dwordx4 v144, s[8:11], s20 offen offset:0 lds
  v_mfma_f32_16x16x32_bf16 v[104:107], a[148:151], a[104:107], v[104:107]
  ds_read_b64_tr_b16 a[144:145], v159 offset:16384
  ds_read_b64_tr_b16 a[146:147], v159 offset:18432
  v_mfma_f32_16x16x32_bf16 v[108:111], a[148:151], a[108:111], v[108:111]
  s_waitcnt lgkmcnt(8)
  v_mfma_f32_16x16x32_bf16 v[112:115], a[152:155], a[104:107], v[112:115]
  ds_read_b64_tr_b16 a[148:149], v162 offset:16384
  ds_read_b64_tr_b16 a[150:151], v162 offset:18432
  v_mfma_f32_16x16x32_bf16 v[116:119], a[152:155], a[108:111], v[116:119]
  s_waitcnt lgkmcnt(8)
  buffer_load_dwordx4 v[224:227], v164, s[92:95], s43 offen offset:0 sc1
  v_mfma_f32_16x16x32_bf16 v[120:123], a[156:159], a[104:107], v[120:123]
  ds_read_b64_tr_b16 a[152:153], v153 offset:20480
  ds_read_b64_tr_b16 a[154:155], v153 offset:22528
  v_mfma_f32_16x16x32_bf16 v[124:127], a[156:159], a[108:111], v[124:127]
  s_waitcnt lgkmcnt(8)
  v_mfma_f32_16x16x32_bf16 v[64:67], a[160:163], a[112:115], v[64:67]
  ds_read_b64_tr_b16 a[156:157], v156 offset:20480
  ds_read_b64_tr_b16 a[158:159], v156 offset:22528
  v_mfma_f32_16x16x32_bf16 v[68:71], a[160:163], a[116:119], v[68:71]
  s_waitcnt lgkmcnt(8)
  buffer_load_dwordx4 v145, s[8:11], s20 offen offset:1024 lds
  v_mfma_f32_16x16x32_bf16 v[72:75], a[164:167], a[112:115], v[72:75]
  ds_read_b64_tr_b16 a[160:161], v159 offset:20480
  ds_read_b64_tr_b16 a[162:163], v159 offset:22528
  v_mfma_f32_16x16x32_bf16 v[76:79], a[164:167], a[116:119], v[76:79]
  s_waitcnt lgkmcnt(8)
  v_mfma_f32_16x16x32_bf16 v[80:83], a[144:147], a[112:115], v[80:83]
  ds_read_b64_tr_b16 a[164:165], v162 offset:20480
  ds_read_b64_tr_b16 a[166:167], v162 offset:22528
  v_mfma_f32_16x16x32_bf16 v[84:87], a[144:147], a[116:119], v[84:87]
  s_waitcnt lgkmcnt(8)
  v_mfma_f32_16x16x32_bf16 v[88:91], a[148:151], a[112:115], v[88:91]
  ds_read_b64_tr_b16 a[144:145], v153 offset:24576
  ds_read_b64_tr_b16 a[146:147], v153 offset:26624
  v_mfma_f32_16x16x32_bf16 v[92:95], a[148:151], a[116:119], v[92:95]
  s_waitcnt lgkmcnt(8)
  buffer_load_dwordx4 v[172:175], off, s[12:15], s33 sc1
  v_mfma_f32_16x16x32_bf16 v[96:99], a[152:155], a[112:115], v[96:99]
  ds_read_b64_tr_b16 a[148:149], v156 offset:24576
  ds_read_b64_tr_b16 a[150:151], v156 offset:26624
  v_mfma_f32_16x16x32_bf16 v[100:103], a[152:155], a[116:119], v[100:103]
  s_waitcnt lgkmcnt(8)
  buffer_load_dwordx4 v146, s[8:11], s20 offen offset:2048 lds
  v_mfma_f32_16x16x32_bf16 v[104:107], a[156:159], a[112:115], v[104:107]
  ds_read_b64_tr_b16 a[152:153], v159 offset:24576
  ds_read_b64_tr_b16 a[154:155], v159 offset:26624
  v_mfma_f32_16x16x32_bf16 v[108:111], a[156:159], a[116:119], v[108:111]
  s_waitcnt lgkmcnt(8)
  v_mfma_f32_16x16x32_bf16 v[112:115], a[160:163], a[112:115], v[112:115]
  ds_read_b64_tr_b16 a[156:157], v162 offset:24576
  ds_read_b64_tr_b16 a[158:159], v162 offset:26624
  v_mfma_f32_16x16x32_bf16 v[116:119], a[160:163], a[116:119], v[116:119]
  s_waitcnt lgkmcnt(8)
  buffer_load_dwordx4 v[228:231], v164, s[92:95], s43 offen offset:1024 sc1
  v_mfma_f32_16x16x32_bf16 v[120:123], a[164:167], a[112:115], v[120:123]
  ds_read_b64_tr_b16 a[160:161], v153 offset:28672
  ds_read_b64_tr_b16 a[162:163], v153 offset:30720
  v_mfma_f32_16x16x32_bf16 v[124:127], a[164:167], a[116:119], v[124:127]
  s_waitcnt lgkmcnt(8)
  s_mov_b32 s23, s26
  s_add_u32 s26, s26, 65536
  v_mfma_f32_16x16x32_bf16 v[64:67], a[144:147], a[120:123], v[64:67]
  ds_read_b64_tr_b16 a[164:165], v156 offset:28672
  ds_read_b64_tr_b16 a[166:167], v156 offset:30720
  v_mfma_f32_16x16x32_bf16 v[68:71], a[144:147], a[124:127], v[68:71]
  s_waitcnt lgkmcnt(8)
  buffer_load_dwordx4 v147, s[8:11], s20 offen offset:3072 lds
  v_mfma_f32_16x16x32_bf16 v[72:75], a[148:151], a[120:123], v[72:75]
  ds_read_b64_tr_b16 a[144:145], v159 offset:28672
  ds_read_b64_tr_b16 a[146:147], v159 offset:30720
  v_mfma_f32_16x16x32_bf16 v[76:79], a[148:151], a[124:127], v[76:79]
  s_waitcnt lgkmcnt(8)
  s_add_u32 s20, s20, s27
  s_add_u32 m0, s21, 16384
  v_mfma_f32_16x16x32_bf16 v[80:83], a[152:155], a[120:123], v[80:83]
  ds_read_b64_tr_b16 a[148:149], v162 offset:28672
  ds_read_b64_tr_b16 a[150:151], v162 offset:30720
  v_mfma_f32_16x16x32_bf16 v[84:87], a[152:155], a[124:127], v[84:87]
  s_waitcnt lgkmcnt(8)
  s_add_u32 s35, s35, 1
  v_mfma_f32_16x16x32_bf16 v[88:91], a[156:159], a[120:123], v[88:91]
  ds_read_b64_tr_b16 a[152:153], v153 offset:32768
  ds_read_b64_tr_b16 a[154:155], v153 offset:34816
  v_mfma_f32_16x16x32_bf16 v[92:95], a[156:159], a[124:127], v[92:95]
  s_waitcnt lgkmcnt(8)
  v_mfma_f32_16x16x32_bf16 v[96:99], a[160:163], a[120:123], v[96:99]
  ds_read_b64_tr_b16 a[156:157], v156 offset:32768
  ds_read_b64_tr_b16 a[158:159], v156 offset:34816
  v_mfma_f32_16x16x32_bf16 v[100:103], a[160:163], a[124:127], v[100:103]
  s_waitcnt lgkmcnt(8)
  buffer_load_dwordx4 v144, s[8:11], s20 offen offset:0 lds
  v_mfma_f32_16x16x32_bf16 v[104:107], a[164:167], a[120:123], v[104:107]
  ds_read_b64_tr_b16 a[160:161], v159 offset:32768
  ds_read_b64_tr_b16 a[162:163], v159 offset:34816
  v_mfma_f32_16x16x32_bf16 v[108:111], a[164:167], a[124:127], v[108:111]
  s_waitcnt lgkmcnt(8)
  v_mfma_f32_16x16x32_bf16 v[112:115], a[144:147], a[120:123], v[112:115]
  ds_read_b64_tr_b16 a[164:165], v162 offset:32768
  ds_read_b64_tr_b16 a[166:167], v162 offset:34816
  v_mfma_f32_16x16x32_bf16 v[116:119], a[144:147], a[124:127], v[116:119]
  s_waitcnt lgkmcnt(8)
  buffer_load_dwordx4 v[232:235], v164, s[92:95], s43 offen offset:2048 sc1
  v_mfma_f32_16x16x32_bf16 v[120:123], a[148:151], a[120:123], v[120:123]
  ds_read_b64_tr_b16 a[144:145], v153 offset:36864
  ds_read_b64_tr_b16 a[146:147], v153 offset:38912
  v_mfma_f32_16x16x32_bf16 v[124:127], a[148:151], a[124:127], v[124:127]
  s_waitcnt lgkmcnt(8)
  v_mfma_f32_16x16x32_bf16 v[64:67], a[152:155], a[128:131], v[64:67]
  ds_read_b64_tr_b16 a[148:149], v156 offset:36864
  ds_read_b64_tr_b16 a[150:151], v156 offset:38912
  v_mfma_f32_16x16x32_bf16 v[68:71], a[152:155], a[132:135], v[68:71]
  s_waitcnt vmcnt(5) lgkmcnt(8)
  buffer_load_dwordx4 v145, s[8:11], s20 offen offset:1024 lds
  v_mfma_f32_16x16x32_bf16 v[72:75], a[156:159], a[128:131], v[72:75]
  ds_read_b64_tr_b16 a[152:153], v159 offset:36864
  ds_read_b64_tr_b16 a[154:155], v159 offset:38912
  v_mfma_f32_16x16x32_bf16 v[76:79], a[156:159], a[132:135], v[76:79]
  s_waitcnt lgkmcnt(8)
  v_min3_u32 v172, v172, v173, v174
  v_mfma_f32_16x16x32_bf16 v[80:83], a[160:163], a[128:131], v[80:83]
  ds_read_b64_tr_b16 a[156:157], v162 offset:36864
  ds_read_b64_tr_b16 a[158:159], v162 offset:38912
  v_mfma_f32_16x16x32_bf16 v[84:87], a[160:163], a[132:135], v[84:87]
  s_waitcnt lgkmcnt(8)
  v_min_u32 v172, v172, v175
  v_lshlrev_b32 v173, 16, v172
  v_mfma_f32_16x16x32_bf16 v[88:91], a[164:167], a[128:131], v[88:91]
  ds_read_b64_tr_b16 a[160:161], v153 offset:40960
  ds_read_b64_tr_b16 a[162:163], v153 offset:43008
  v_mfma_f32_16x16x32_bf16 v[92:95], a[164:167], a[132:135], v[92:95]
  s_waitcnt lgkmcnt(8)
  s_nop 0
  v_readfirstlane_b32 s36, v173
  v_mfma_f32_16x16x32_bf16 v[96:99], a[144:147], a[128:131], v[96:99]
  ds_read_b64_tr_b16 a[164:165], v156 offset:40960
  ds_read_b64_tr_b16 a[166:167], v156 offset:43008
  v_mfma_f32_16x16x32_bf16 v[100:103], a[144:147], a[132:135], v[100:103]
  s_waitcnt lgkmcnt(8)
  buffer_load_dwordx4 v146, s[8:11], s20 offen offset:2048 lds
  v_mfma_f32_16x16x32_bf16 v[104:107], a[148:151], a[128:131], v[104:107]
  ds_read_b64_tr_b16 a[144:145], v159 offset:40960
  ds_read_b64_tr_b16 a[146:147], v159 offset:43008
  v_mfma_f32_16x16x32_bf16 v[108:111], a[148:151], a[132:135], v[108:111]
  s_waitcnt lgkmcnt(8)
  buffer_load_dwordx4 v[172:175], off, s[12:15], s33 sc1
  v_mfma_f32_16x16x32_bf16 v[112:115], a[152:155], a[128:131], v[112:115]
  ds_read_b64_tr_b16 a[148:149], v162 offset:40960
  ds_read_b64_tr_b16 a[150:151], v162 offset:43008
  v_mfma_f32_16x16x32_bf16 v[116:119], a[152:155], a[132:135], v[116:119]
  s_waitcnt lgkmcnt(8)
  buffer_load_dwordx4 v[236:239], v164, s[92:95], s43 offen offset:3072 sc1
  v_mfma_f32_16x16x32_bf16 v[120:123], a[156:159], a[128:131], v[120:123]
  ds_read_b64_tr_b16 a[152:153], v153 offset:45056
  ds_read_b64_tr_b16 a[154:155], v153 offset:47104
  v_mfma_f32_16x16x32_bf16 v[124:127], a[156:159], a[132:135], v[124:127]
  s_waitcnt lgkmcnt(8)
  s_mov_b32 s43, 268435456
  v_mfma_f32_16x16x32_bf16 v[64:67], a[160:163], a[136:139], v[64:67]
  ds_read_b64_tr_b16 a[156:157], v156 offset:45056
  ds_read_b64_tr_b16 a[158:159], v156 offset:47104
  v_mfma_f32_16x16x32_bf16 v[68:71], a[160:163], a[140:143], v[68:71]
  s_waitcnt lgkmcnt(8)
  buffer_load_dwordx4 v147, s[8:11], s20 offen offset:3072 lds
  v_mfma_f32_16x16x32_bf16 v[72:75], a[164:167], a[136:139], v[72:75]
  ds_read_b64_tr_b16 a[160:161], v159 offset:45056
  ds_read_b64_tr_b16 a[162:163], v159 offset:47104
  v_mfma_f32_16x16x32_bf16 v[76:79], a[164:167], a[140:143], v[76:79]
  s_waitcnt lgkmcnt(8)
  s_add_u32 s20, s20, s28
  s_add_u32 m0, s21, 32768
  v_mfma_f32_16x16x32_bf16 v[80:83], a[144:147], a[136:139], v[80:83]
  ds_read_b64_tr_b16 a[164:165], v162 offset:45056
  ds_read_b64_tr_b16 a[166:167], v162 offset:47104
  v_mfma_f32_16x16x32_bf16 v[84:87], a[144:147], a[140:143], v[84:87]
  s_waitcnt vmcnt(14) lgkmcnt(8)
  s_barrier
  v_mfma_f32_16x16x32_bf16 v[88:91], a[148:151], a[136:139], v[88:91]
  ds_read_b64_tr_b16 a[144:145], v154 offset:0
  ds_read_b64_tr_b16 a[146:147], v154 offset:2048
  v_mfma_f32_16x16x32_bf16 v[92:95], a[148:151], a[140:143], v[92:95]
  s_waitcnt lgkmcnt(8)
  v_mfma_f32_16x16x32_bf16 v[96:99], a[152:155], a[136:139], v[96:99]
  ds_read_b64_tr_b16 a[148:149], v157 offset:0
  ds_read_b64_tr_b16 a[150:151], v157 offset:2048
  v_mfma_f32_16x16x32_bf16 v[100:103], a[152:155], a[140:143], v[100:103]
  s_waitcnt lgkmcnt(8)
  buffer_load_dwordx4 v144, s[8:11], s20 offen offset:0 lds
  v_mfma_f32_16x16x32_bf16 v[104:107], a[156:159], a[136:139], v[104:107]
  ds_read_b64_tr_b16 a[152:153], v160 offset:0
  ds_read_b64_tr_b16 a[154:155], v160 offset:2048
  v_mfma_f32_16x16x32_bf16 v[108:111], a[156:159], a[140:143], v[108:111]
  s_waitcnt lgkmcnt(8)
  v_mfma_f32_16x16x32_bf16 v[112:115], a[160:163], a[136:139], v[112:115]
  ds_read_b64_tr_b16 a[156:157], v163 offset:0
  ds_read_b64_tr_b16 a[158:159], v163 offset:2048
  v_mfma_f32_16x16x32_bf16 v[116:119], a[160:163], a[140:143], v[116:119]
  s_waitcnt lgkmcnt(8)
  s_sub_u32 s22, s22, 1
  v_mfma_f32_16x16x32_bf16 v[120:123], a[164:167], a[136:139], v[120:123]
  ds_read_b64_tr_b16 a[160:161], v154 offset:4096
  ds_read_b64_tr_b16 a[162:163], v154 offset:6144
  v_mfma_f32_16x16x32_bf16 v[124:127], a[164:167], a[140:143], v[124:127]
  s_waitcnt lgkmcnt(8)
  s_cmp_eq_u32 s22, 0
  s_cbranch_scc0 K3_A
  s_nop 3
  v_mul_f32 v64, v64, v96
  v_mul_f32 v65, v65, v97
  v_cvt_pk_bf16_f32 v128, v64, v65
  v_mul_f32 v66, v66, v98
  v_mul_f32 v67, v67, v99
  v_cvt_pk_bf16_f32 v129, v66, v67
  v_mul_f32 v72, v72, v104
  v_mul_f32 v73, v73, v105
  v_cvt_pk_bf16_f32 v130, v72, v73
  v_mul_f32 v74, v74, v106
  v_mul_f32 v75, v75, v107
  v_cvt_pk_bf16_f32 v131, v74, v75
  buffer_store_dwordx4 v[128:131], v164, s[92:95], s23 offen offset:0 sc1
  v_mul_f32 v68, v68, v100
  v_mul_f32 v69, v69, v101
  v_cvt_pk_bf16_f32 v132, v68, v69
  v_mul_f32 v70, v70, v102
  v_mul_f32 v71, v71, v103
  v_cvt_pk_bf16_f32 v133, v70, v71
  v_mul_f32 v76, v76, v108
  v_mul_f32 v77, v77, v109
  v_cvt_pk_bf16_f32 v134, v76, v77
  v_mul_f32 v78, v78, v110
  v_mul_f32 v79, v79, v111
  v_cvt_pk_bf16_f32 v135, v78, v79
  buffer_store_dwordx4 v[132:135], v164, s[92:95], s23 offen offset:1024 sc1
  v_mul_f32 v80, v80, v112
  v_mul_f32 v81, v81, v113
  v_cvt_pk_bf16_f32 v136, v80, v81
  v_mul_f32 v82, v82, v114
  v_mul_f32 v83, v83, v115
  v_cvt_pk_bf16_f32 v137, v82, v83
  v_mul_f32 v88, v88, v120
  v_mul_f32 v89, v89, v121
  v_cvt_pk_bf16_f32 v138, v88, v89
  v_mul_f32 v90, v90, v122
  v_mul_f32 v91, v91, v123
  v_cvt_pk_bf16_f32 v139, v90, v91
  buffer_store_dwordx4 v[136:139], v164, s[92:95], s23 offen offset:2048 sc1
  v_mul_f32 v84, v84, v116
  v_mul_f32 v85, v85, v117
  v_cvt_pk_bf16_f32 v140, v84, v85
  v_mul_f32 v86, v86, v118
  v_mul_f32 v87, v87, v119
  v_cvt_pk_bf16_f32 v141, v86, v87
  v_mul_f32 v92, v92, v124
  v_mul_f32 v93, v93, v125
  v_cvt_pk_bf16_f32 v142, v92, v93
  v_mul_f32 v94, v94, v126
  v_mul_f32 v95, v95, v127
  v_cvt_pk_bf16_f32 v143, v94, v95
  buffer_store_dwordx4 v[140:143], v164, s[92:95], s23 offen offset:3072 sc1
  s_cmp_eq_u32 s32, 3
  s_cbranch_scc1 K3_G2six
K3_G2four:
  v_mfma_f32_16x16x32_bf16 v[0:3], a[144:147], a[176:179], 0
  ds_read_b64_tr_b16 a[164:165], v157 offset:4096
  ds_read_b64_tr_b16 a[166:167], v157 offset:6144
  v_mfma_f32_16x16x32_bf16 v[4:7], a[144:147], a[180:183], 0
  s_waitcnt lgkmcnt(8)
  buffer_load_dwordx4 v145, s[8:11], s20 offen offset:1024 lds
  v_mfma_f32_16x16x32_bf16 v[8:11], a[148:151], a[176:179], 0
  ds_read_b64_tr_b16 a[144:145], v160 offset:4096
  ds_read_b64_tr_b16 a[146:147], v160 offset:6144
  v_mfma_f32_16x16x32_bf16 v[12:15], a[148:151], a[180:183], 0
  s_waitcnt lgkmcnt(8)
  s_cmp_lt_u32 s38, s36
  s_cbranch_scc0 K3_slow_four8
K3_back_four8:
  v_mfma_f32_16x16x32_bf16 v[16:19], a[152:155], a[176:179], 0
  ds_read_b64_tr_b16 a[148:149], v163 offset:4096
  ds_read_b64_tr_b16 a[150:151], v163 offset:6144
  v_mfma_f32_16x16x32_bf16 v[20:23], a[152:155], a[180:183], 0
  s_waitcnt lgkmcnt(8)
  buffer_load_dwordx4 v[240:243], v164, s[92:95], s38 offen offset:0 sc1
  v_mfma_f32_16x16x32_bf16 v[24:27], a[156:159], a[176:179], 0
  ds_read_b64_tr_b16 a[152:153], v154 offset:8192
  ds_read_b64_tr_b16 a[154:155], v154 offset:10240
  v_mfma_f32_16x16x32_bf16 v[28:31], a[156:159], a[180:183], 0
  s_waitcnt lgkmcnt(8)
  v_mfma_f32_16x16x32_bf16 v[32:35], a[160:163], a[176:179], 0
  ds_read_b64_tr_b16 a[156:157], v157 offset:8192
  ds_read_b64_tr_b16 a[158:159], v157 offset:10240
  v_mfma_f32_16x16x32_bf16 v[36:39], a[160:163], a[180:183], 0
  s_waitcnt lgkmcnt(8)
  buffer_load_dwordx4 v146, s[8:11], s20 offen offset:2048 lds
  v_mfma_f32_16x16x32_bf16 v[40:43], a[164:167], a[176:179], 0
  ds_read_b64_tr_b16 a[160:161], v160 offset:8192
  ds_read_b64_tr_b16 a[162:163], v160 offset:10240
  v_mfma_f32_16x16x32_bf16 v[44:47], a[164:167], a[180:183], 0
  s_waitcnt lgkmcnt(8)
  v_mfma_f32_16x16x32_bf16 v[48:51], a[144:147], a[176:179], 0
  ds_read_b64_tr_b16 a[164:165], v163 offset:8192
  ds_read_b64_tr_b16 a[166:167], v163 offset:10240
  v_mfma_f32_16x16x32_bf16 v[52:55], a[144:147], a[180:183], 0
  s_waitcnt lgkmcnt(8)
  buffer_load_dwordx4 v[244:247], v164, s[92:95], s38 offen offset:1024 sc1
  v_mfma_f32_16x16x32_bf16 v[56:59], a[148:151], a[176:179], 0
  ds_read_b64_tr_b16 a[144:145], v154 offset:12288
  ds_read_b64_tr_b16 a[146:147], v154 offset:14336
  v_mfma_f32_16x16x32_bf16 v[60:63], a[148:151], a[180:183], 0
  s_waitcnt lgkmcnt(8)
  v_mfma_f32_16x16x32_bf16 v[0:3], a[152:155], a[184:187], v[0:3]
  ds_read_b64_tr_b16 a[148:149], v157 offset:12288
  ds_read_b64_tr_b16 a[150:151], v157 offset:14336
  v_mfma_f32_16x16x32_bf16 v[4:7], a[152:155], a[188:191], v[4:7]
  s_waitcnt lgkmcnt(8)
  buffer_load_dwordx4 v147, s[8:11], s20 offen offset:3072 lds
  v_mfma_f32_16x16x32_bf16 v[8:11], a[156:159], a[184:187], v[8:11]
  ds_read_b64_tr_b16 a[152:153], v160 offset:12288
  ds_read_b64_tr_b16 a[154:155], v160 offset:14336
  v_mfma_f32_16x16x32_bf16 v[12:15], a[156:159], a[188:191], v[12:15]
  s_waitcnt lgkmcnt(8)
  s_add_u32 s20, s20, s27
  s_add_u32 m0, s21, 49152
  v_mfma_f32_16x16x32_bf16 v[16:19], a[160:163], a[184:187], v[16:19]
  ds_read_b64_tr_b16 a[156:157], v163 offset:12288
  ds_read_b64_tr_b16 a[158:159], v163 offset:14336
  v_mfma_f32_16x16x32_bf16 v[20:23], a[160:163], a[188:191], v[20:23]
  s_waitcnt lgkmcnt(8)
  buffer_load_dwordx4 v[248:251], v164, s[92:95], s38 offen offset:2048 sc1
  v_mfma_f32_16x16x32_bf16 v[24:27], a[164:167], a[184:187], v[24:27]
  ds_read_b64_tr_b16 a[160:161], v154 offset:16384
  ds_read_b64_tr_b16 a[162:163], v154 offset:18432
  v_mfma_f32_16x16x32_bf16 v[28:31], a[164:167], a[188:191], v[28:31]
  s_waitcnt lgkmcnt(8)
  v_mfma_f32_16x16x32_bf16 v[32:35], a[144:147], a[184:187], v[32:35]
  ds_read_b64_tr_b16 a[164:165], v157 offset:16384
  ds_read_b64_tr_b16 a[166:167], v157 offset:18432
  v_mfma_f32_16x16x32_bf16 v[36:39], a[144:147], a[188:191], v[36:39]
  s_waitcnt lgkmcnt(8)
  buffer_load_dwordx4 v144, s[8:11], s20 offen offset:0 lds
  v_mfma_f32_16x16x32_bf16 v[40:43], a[148:151], a[184:187], v[40:43]
  ds_read_b64_tr_b16 a[144:145], v160 offset:16384
  ds_read_b64_tr_b16 a[146:147], v160 offset:18432
  v_mfma_f32_16x16x32_bf16 v[44:47], a[148:151], a[188:191], v[44:47]
  s_waitcnt lgkmcnt(8)
  v_mfma_f32_16x16x32_bf16 v[48:51], a[152:155], a[184:187], v[48:51]
  ds_read_b64_tr_b16 a[148:149], v163 offset:16384
  ds_read_b64_tr_b16 a[150:151], v163 offset:18432
  v_mfma_f32_16x16x32_bf16 v[52:55], a[152:155], a[188:191], v[52:55]
  s_waitcnt lgkmcnt(8)
  buffer_load_dwordx4 v[252:255], v164, s[92:95], s38 offen offset:3072 sc1
  v_mfma_f32_16x16x32_bf16 v[56:59], a[156:159], a[184:187], v[56:59]
  ds_read_b64_tr_b16 a[152:153], v154 offset:20480
  ds_read_b64_tr_b16 a[154:155], v154 offset:22528
  v_mfma_f32_16x16x32_bf16 v[60:63], a[156:159], a[188:191], v[60:63]
  s_waitcnt vmcnt(63) lgkmcnt(8)
  s_add_u32 s38, s38, 16384
  v_mfma_f32_16x16x32_bf16 v[0:3], a[160:163], a[192:195], v[0:3]
  ds_read_b64_tr_b16 a[156:157], v157 offset:20480
  ds_read_b64_tr_b16 a[158:159], v157 offset:22528
  v_mfma_f32_16x16x32_bf16 v[4:7], a[160:163], a[196:199], v[4:7]
  s_waitcnt lgkmcnt(8)
  buffer_load_dwordx4 v145, s[8:11], s20 offen offset:1024 lds
  v_mfma_f32_16x16x32_bf16 v[8:11], a[164:167], a[192:195], v[8:11]
  ds_read_b64_tr_b16 a[160:161], v160 offset:20480
  ds_read_b64_tr_b16 a[162:163], v160 offset:22528
  v_mfma_f32_16x16x32_bf16 v[12:15], a[164:167], a[196:199], v[12:15]
  s_waitcnt lgkmcnt(8)
  v_mfma_f32_16x16x32_bf16 v[16:19], a[144:147], a[192:195], v[16:19]
  ds_read_b64_tr_b16 a[164:165], v163 offset:20480
  ds_read_b64_tr_b16 a[166:167], v163 offset:22528
  v_mfma_f32_16x16x32_bf16 v[20:23], a[144:147], a[196:199], v[20:23]
  s_waitcnt lgkmcnt(8)
  v_mfma_f32_16x16x32_bf16 v[24:27], a[148:151], a[192:195], v[24:27]
  ds_read_b64_tr_b16 a[144:145], v154 offset:24576
  ds_read_b64_tr_b16 a[146:147], v154 offset:26624
  v_mfma_f32_16x16x32_bf16 v[28:31], a[148:151], a[196:199], v[28:31]
  s_waitcnt lgkmcnt(8)
  v_mfma_f32_16x16x32_bf16 v[32:35], a[152:155], a[192:195], v[32:35]
  ds_read_b64_tr_b16 a[148:149], v157 offset:24576
  ds_read_b64_tr_b16 a[150:151], v157 offset:26624
  v_mfma_f32_16x16x32_bf16 v[36:39], a[152:155], a[196:199], v[36:39]
  s_waitcnt lgkmcnt(8)
  buffer_load_dwordx4 v146, s[8:11], s20 offen offset:2048 lds
  v_mfma_f32_16x16x32_bf16 v[40:43], a[156:159], a[192:195], v[40:43]
  ds_read_b64_tr_b16 a[152:153], v160 offset:24576
  ds_read_b64_tr_b16 a[154:155], v160 offset:26624
  v_mfma_f32_16x16x32_bf16 v[44:47], a[156:159], a[196:199], v[44:47]
  s_waitcnt lgkmcnt(8)
  v_mfma_f32_16x16x32_bf16 v[48:51], a[160:163], a[192:195], v[48:51]
  ds_read_b64_tr_b16 a[156:157], v163 offset:24576
  ds_read_b64_tr_b16 a[158:159], v163 offset:26624
  v_mfma_f32_16x16x32_bf16 v[52:55], a[160:163], a[196:199], v[52:55]
  s_waitcnt lgkmcnt(8)
  v_mfma_f32_16x16x32_bf16 v[56:59], a[164:167], a[192:195], v[56:59]
  ds_read_b64_tr_b16 a[160:161], v154 offset:28672
  ds_read_b64_tr_b16 a[162:163], v154 offset:30720
  v_mfma_f32_16x16x32_bf16 v[60:63], a[164:167], a[196:199], v[60:63]
  s_waitcnt lgkmcnt(8)
  v_mfma_f32_16x16x32_bf16 v[0:3], a[144:147], a[200:203], v[0:3]
  ds_read_b64_tr_b16 a[164:165], v157 offset:28672
  ds_read_b64_tr_b16 a[166:167], v157 offset:30720
  v_mfma_f32_16x16x32_bf16 v[4:7], a[144:147], a[204:207], v[4:7]
  s_waitcnt lgkmcnt(8)
  buffer_load_dwordx4 v147, s[8:11], s20 offen offset:3072 lds
  v_mfma_f32_16x16x32_bf16 v[8:11], a[148:151], a[200:203], v[8:11]
  ds_read_b64_tr_b16 a[144:145], v160 offset:28672
  ds_read_b64_tr_b16 a[146:147], v160 offset:30720
  v_mfma_f32_16x16x32_bf16 v[12:15], a[148:151], a[204:207], v[12:15]
  s_waitcnt lgkmcnt(8)
  s_add_u32 s20, s20, s27
  s_add_u32 m0, s21, 65536
  v_mfma_f32_16x16x32_bf16 v[16:19], a[152:155], a[200:203], v[16:19]
  ds_read_b64_tr_b16 a[148:149], v163 offset:28672
  ds_read_b64_tr_b16 a[150:151], v163 offset:30720
  v_mfma_f32_16x16x32_bf16 v[20:23], a[152:155], a[204:207], v[20:23]
  s_waitcnt lgkmcnt(8)
  buffer_load_dwordx4 a[176:179], v164, s[92:95], s38 offen offset:0 sc1
  v_mfma_f32_16x16x32_bf16 v[24:27], a[156:159], a[200:203], v[24:27]
  ds_read_b64_tr_b16 a[152:153], v154 offset:32768
  ds_read_b64_tr_b16 a[154:155], v154 offset:34816
  v_mfma_f32_16x16x32_bf16 v[28:31], a[156:159], a[204:207], v[28:31]
  s_waitcnt lgkmcnt(8)
  v_mfma_f32_16x16x32_bf16 v[32:35], a[160:163], a[200:203], v[32:35]
  ds_read_b64_tr_b16 a[156:157], v157 offset:32768
  ds_read_b64_tr_b16 a[158:159], v157 offset:34816
  v_mfma_f32_16x16x32_bf16 v[36:39], a[160:163], a[204:207], v[36:39]
  s_waitcnt lgkmcnt(8)
  buffer_load_dwordx4 v144, s[8:11], s20 offen offset:0 lds
  v_mfma_f32_16x16x32_bf16 v[40:43], a[164:167], a[200:203], v[40:43]
  ds_read_b64_tr_b16 a[160:161], v160 offset:32768
  ds_read_b64_tr_b16 a[162:163], v160 offset:34816
  v_mfma_f32_16x16x32_bf16 v[44:47], a[164:167], a[204:207], v[44:47]
  s_waitcnt lgkmcnt(8)
  v_mfma_f32_16x16x32_bf16 v[48:51], a[144:147], a[200:203], v[48:51]
  ds_read_b64_tr_b16 a[164:165], v163 offset:32768
  ds_read_b64_tr_b16 a[166:167], v163 offset:34816
  v_mfma_f32_16x16x32_bf16 v[52:55], a[144:147], a[204:207], v[52:55]
  s_waitcnt lgkmcnt(8)
  buffer_load_dwordx4 a[180:183], v164, s[92:95], s38 offen offset:1024 sc1
  v_mfma_f32_16x16x32_bf16 v[56:59], a[148:151], a[200:203], v[56:59]
  ds_read_b64_tr_b16 a[144:145], v154 offset:36864
  ds_read_b64_tr_b16 a[146:147], v154 offset:38912
  v_mfma_f32_16x16x32_bf16 v[60:63], a[148:151], a[204:207], v[60:63]
  s_waitcnt vmcnt(63) lgkmcnt(8)
  v_mfma_f32_16x16x32_bf16 v[0:3], a[152:155], a[208:211], v[0:3]
  ds_read_b64_tr_b16 a[148:149], v157 offset:36864
  ds_read_b64_tr_b16 a[150:151], v157 offset:38912
  v_mfma_f32_16x16x32_bf16 v[4:7], a[152:155], a[212:215], v[4:7]
  s_waitcnt lgkmcnt(8)
  buffer_load_dwordx4 v145, s[8:11], s20 offen offset:1024 lds
  v_mfma_f32_16x16x32_bf16 v[8:11], a[156:159], a[208:211], v[8:11]
  ds_read_b64_tr_b16 a[152:153], v160 offset:36864
  ds_read_b64_tr_b16 a[154:155], v160 offset:38912
  v_mfma_f32_16x16x32_bf16 v[12:15], a[156:159], a[212:215], v[12:15]
  s_waitcnt lgkmcnt(8)
  v_mfma_f32_16x16x32_bf16 v[16:19], a[160:163], a[208:211], v[16:19]
  ds_read_b64_tr_b16 a[156:157], v163 offset:36864
  ds_read_b64_tr_b16 a[158:159], v163 offset:38912
  v_mfma_f32_16x16x32_bf16 v[20:23], a[160:163], a[212:215], v[20:23]
  s_waitcnt lgkmcnt(8)
  buffer_load_dwordx4 a[184:187], v164, s[92:95], s38 offen offset:2048 sc1
  v_mfma_f32_16x16x32_bf16 v[24:27], a[164:167], a[208:211], v[24:27]
  ds_read_b64_tr_b16 a[160:161], v154 offset:40960
  ds_read_b64_tr_b16 a[162:163], v154 offset:43008
  v_mfma_f32_16x16x32_bf16 v[28:31], a[164:167], a[212:215], v[28:31]
  s_waitcnt lgkmcnt(8)
  v_mfma_f32_16x16x32_bf16 v[32:35], a[144:147], a[208:211], v[32:35]
  ds_read_b64_tr_b16 a[164:165], v157 offset:40960
  ds_read_b64_tr_b16 a[166:167], v157 offset:43008
  v_mfma_f32_16x16x32_bf16 v[36:39], a[144:147], a[212:215], v[36:39]
  s_waitcnt lgkmcnt(8)
  buffer_load_dwordx4 v146, s[8:11], s20 offen offset:2048 lds
  v_mfma_f32_16x16x32_bf16 v[40:43], a[148:151], a[208:211], v[40:43]
  ds_read_b64_tr_b16 a[144:145], v160 offset:40960
  ds_read_b64_tr_b16 a[146:147], v160 offset:43008
  v_mfma_f32_16x16x32_bf16 v[44:47], a[148:151], a[212:215], v[44:47]
  s_waitcnt lgkmcnt(8)
  v_mfma_f32_16x16x32_bf16 v[48:51], a[152:155], a[208:211], v[48:51]
  ds_read_b64_tr_b16 a[148:149], v163 offset:40960
  ds_read_b64_tr_b16 a[150:151], v163 offset:43008
  v_mfma_f32_16x16x32_bf16 v[52:55], a[152:155], a[212:215], v[52:55]
  s_waitcnt lgkmcnt(8)
  buffer_load_dwordx4 a[188:191], v164, s[92:95], s38 offen offset:3072 sc1
  v_mfma_f32_16x16x32_bf16 v[56:59], a[156:159], a[208:211], v[56:59]
  ds_read_b64_tr_b16 a[152:153], v154 offset:45056
  ds_read_b64_tr_b16 a[154:155], v154 offset:47104
  v_mfma_f32_16x16x32_bf16 v[60:63], a[156:159], a[212:215], v[60:63]
  s_waitcnt lgkmcnt(8)
  s_add_u32 s38, s38, 16384
  v_mfma_f32_16x16x32_bf16 v[0:3], a[160:163], a[216:219], v[0:3]
  ds_read_b64_tr_b16 a[156:157], v157 offset:45056
  ds_read_b64_tr_b16 a[158:159], v157 offset:47104
  v_mfma_f32_16x16x32_bf16 v[4:7], a[160:163], a[220:223], v[4:7]
  s_waitcnt lgkmcnt(8)
  buffer_load_dwordx4 v147, s[8:11], s20 offen offset:3072 lds
  v_mfma_f32_16x16x32_bf16 v[8:11], a[164:167], a[216:219], v[8:11]
  ds_read_b64_tr_b16 a[160:161], v160 offset:45056
  ds_read_b64_tr_b16 a[162:163], v160 offset:47104
  v_mfma_f32_16x16x32_bf16 v[12:15], a[164:167], a[220:223], v[12:15]
  s_waitcnt lgkmcnt(8)
  s_add_u32 s20, s20, s27
  s_add_u32 m0, s21, 81920
  v_mfma_f32_16x16x32_bf16 v[16:19], a[144:147], a[216:219], v[16:19]
  ds_read_b64_tr_b16 a[164:165], v163 offset:45056
  ds_read_b64_tr_b16 a[166:167], v163 offset:47104
  v_mfma_f32_16x16x32_bf16 v[20:23], a[144:147], a[220:223], v[20:23]
  s_waitcnt vmcnt(14) lgkmcnt(8)
  s_barrier
  v_mfma_f32_16x16x32_bf16 v[24:27], a[148:151], a[216:219], v[24:27]
  ds_read_b64_tr_b16 a[144:145], v152 offset:0
  ds_read_b64_tr_b16 a[146:147], v152 offset:2048
  v_mfma_f32_16x16x32_bf16 v[28:31], a[148:151], a[220:223], v[28:31]
  s_waitcnt lgkmcnt(8)
  v_mov_b32 v176, 15
  v_mfma_f32_16x16x32_bf16 v[32:35], a[152:155], a[216:219], v[32:35]
  ds_read_b64_tr_b16 a[148:149], v155 offset:0
  ds_read_b64_tr_b16 a[150:151], v155 offset:2048
  v_mfma_f32_16x16x32_bf16 v[36:39], a[152:155], a[220:223], v[36:39]
  s_waitcnt lgkmcnt(8)
  buffer_load_dwordx4 v144, s[8:11], s20 offen offset:0 lds
  v_mfma_f32_16x16x32_bf16 v[40:43], a[156:159], a[216:219], v[40:43]
  ds_read_b64_tr_b16 a[152:153], v158 offset:0
  ds_read_b64_tr_b16 a[154:155], v158 offset:2048
  v_mfma_f32_16x16x32_bf16 v[44:47], a[156:159], a[220:223], v[44:47]
  s_waitcnt lgkmcnt(8)
  buffer_store_dword v176, v165, s[12:15], s34 offen sc1
  v_mfma_f32_16x16x32_bf16 v[48:51], a[160:163], a[216:219], v[48:51]
  ds_read_b64_tr_b16 a[156:157], v161 offset:0
  ds_read_b64_tr_b16 a[158:159], v161 offset:2048
  v_mfma_f32_16x16x32_bf16 v[52:55], a[160:163], a[220:223], v[52:55]
  s_waitcnt lgkmcnt(8)
  v_mfma_f32_16x16x32_bf16 v[56:59], a[164:167], a[216:219], v[56:59]
  ds_read_b64_tr_b16 a[160:161], v152 offset:4096
  ds_read_b64_tr_b16 a[162:163], v152 offset:6144
  v_mfma_f32_16x16x32_bf16 v[60:63], a[164:167], a[220:223], v[60:63]
  s_waitcnt vmcnt(63) lgkmcnt(8)
  v_mfma_f32_16x16x32_bf16 v[0:3], a[144:147], a[224:227], v[0:3]
  ds_read_b64_tr_b16 a[164:165], v155 offset:4096
  ds_read_b64_tr_b16 a[166:167], v155 offset:6144
  v_mfma_f32_16x16x32_bf16 v[4:7], a[144:147], a[228:231], v[4:7]
  s_waitcnt lgkmcnt(8)
  buffer_load_dwordx4 v145, s[8:11], s20 offen offset:1024 lds
  v_mfma_f32_16x16x32_bf16 v[8:11], a[148:151], a[224:227], v[8:11]
  ds_read_b64_tr_b16 a[144:145], v158 offset:4096
  ds_read_b64_tr_b16 a[146:147], v158 offset:6144
  v_mfma_f32_16x16x32_bf16 v[12:15], a[148:151], a[228:231], v[12:15]
  s_waitcnt lgkmcnt(8)
  v_mfma_f32_16x16x32_bf16 v[16:19], a[152:155], a[224:227], v[16:19]
  ds_read_b64_tr_b16 a[148:149], v161 offset:4096
  ds_read_b64_tr_b16 a[150:151], v161 offset:6144
  v_mfma_f32_16x16x32_bf16 v[20:23], a[152:155], a[228:231], v[20:23]
  s_waitcnt lgkmcnt(8)
  buffer_load_dwordx4 a[192:195], v164, s[92:95], s38 offen offset:0 sc1
  v_mfma_f32_16x16x32_bf16 v[24:27], a[156:159], a[224:227], v[24:27]
  ds_read_b64_tr_b16 a[152:153], v152 offset:8192
  ds_read_b64_tr_b16 a[154:155], v152 offset:10240
  v_mfma_f32_16x16x32_bf16 v[28:31], a[156:159], a[228:231], v[28:31]
  s_waitcnt lgkmcnt(8)
  v_mfma_f32_16x16x32_bf16 v[32:35], a[160:163], a[224:227], v[32:35]
  ds_read_b64_tr_b16 a[156:157], v155 offset:8192
  ds_read_b64_tr_b16 a[158:159], v155 offset:10240
  v_mfma_f32_16x16x32_bf16 v[36:39], a[160:163], a[228:231], v[36:39]
  s_waitcnt lgkmcnt(8)
  buffer_load_dwordx4 v146, s[8:11], s20 offen offset:2048 lds
  v_mfma_f32_16x16x32_bf16 v[40:43], a[164:167], a[224:227], v[40:43]
  ds_read_b64_tr_b16 a[160:161], v158 offset:8192
  ds_read_b64_tr_b16 a[162:163], v158 offset:10240
  v_mfma_f32_16x16x32_bf16 v[44:47], a[164:167], a[228:231], v[44:47]
  s_waitcnt lgkmcnt(8)
  v_mfma_f32_16x16x32_bf16 v[48:51], a[144:147], a[224:227], v[48:51]
  ds_read_b64_tr_b16 a[164:165], v161 offset:8192
  ds_read_b64_tr_b16 a[166:167], v161 offset:10240
  v_mfma_f32_16x16x32_bf16 v[52:55], a[144:147], a[228:231], v[52:55]
  s_waitcnt lgkmcnt(8)
  buffer_load_dwordx4 a[196:199], v164, s[92:95], s38 offen offset:1024 sc1
  v_mfma_f32_16x16x32_bf16 v[56:59], a[148:151], a[224:227], v[56:59]
  ds_read_b64_tr_b16 a[144:145], v152 offset:12288
  ds_read_b64_tr_b16 a[146:147], v152 offset:14336
  v_mfma_f32_16x16x32_bf16 v[60:63], a[148:151], a[228:231], v[60:63]
  s_waitcnt lgkmcnt(8)
  v_mfma_f32_16x16x32_bf16 v[0:3], a[152:155], a[232:235], v[0:3]
  ds_read_b64_tr_b16 a[148:149], v155 offset:12288
  ds_read_b64_tr_b16 a[150:151], v155 offset:14336
  v_mfma_f32_16x16x32_bf16 v[4:7], a[152:155], a[236:239], v[4:7]
  s_waitcnt lgkmcnt(8)
  buffer_load_dwordx4 v147, s[8:11], s20 offen offset:3072 lds
  v_mfma_f32_16x16x32_bf16 v[8:11], a[156:159], a[232:235], v[8:11]
  ds_read_b64_tr_b16 a[152:153], v158 offset:12288
  ds_read_b64_tr_b16 a[154:155], v158 offset:14336
  v_mfma_f32_16x16x32_bf16 v[12:15], a[156:159], a[236:239], v[12:15]
  s_waitcnt lgkmcnt(8)
  s_add_u32 s20, s20, s27
  s_add_u32 m0, s21, 98304
  v_mfma_f32_16x16x32_bf16 v[16:19], a[160:163], a[232:235], v[16:19]
  ds_read_b64_tr_b16 a[156:157], v161 offset:12288
  ds_read_b64_tr_b16 a[158:159], v161 offset:14336
  v_mfma_f32_16x16x32_bf16 v[20:23], a[160:163], a[236:239], v[20:23]
  s_waitcnt lgkmcnt(8)
  buffer_load_dwordx4 a[200:203], v164, s[92:95], s38 offen offset:2048 sc1
  v_mfma_f32_16x16x32_bf16 v[24:27], a[164:167], a[232:235], v[24:27]
  ds_read_b64_tr_b16 a[160:161], v152 offset:16384
  ds_read_b64_tr_b16 a[162:163], v152 offset:18432
  v_mfma_f32_16x16x32_bf16 v[28:31], a[164:167], a[236:239], v[28:31]
  s_waitcnt lgkmcnt(8)
  v_mfma_f32_16x16x32_bf16 v[32:35], a[144:147], a[232:235], v[32:35]
  ds_read_b64_tr_b16 a[164:165], v155 offset:16384
  ds_read_b64_tr_b16 a[166:167], v155 offset:18432
  v_mfma_f32_16x16x32_bf16 v[36:39], a[144:147], a[236:239], v[36:39]
  s_waitcnt lgkmcnt(8)
  buffer_load_dwordx4 v144, s[8:11], s20 offen offset:0 lds
  v_mfma_f32_16x16x32_bf16 v[40:43], a[148:151], a[232:235], v[40:43]
  ds_read_b64_tr_b16 a[144:145], v158 offset:16384
  ds_read_b64_tr_b16 a[146:147], v158 offset:18432
  v_mfma_f32_16x16x32_bf16 v[44:47], a[148:151], a[236:239], v[44:47]
  s_waitcnt lgkmcnt(8)
  v_mfma_f32_16x16x32_bf16 v[48:51], a[152:155], a[232:235], v[48:51]
  ds_read_b64_tr_b16 a[148:149], v161 offset:16384
  ds_read_b64_tr_b16 a[150:151], v161 offset:18432
  v_mfma_f32_16x16x32_bf16 v[52:55], a[152:155], a[236:239], v[52:55]
  s_waitcnt lgkmcnt(8)
  buffer_load_dwordx4 a[204:207], v164, s[92:95], s38 offen offset:3072 sc1
  v_mfma_f32_16x16x32_bf16 v[56:59], a[156:159], a[232:235], v[56:59]
  ds_read_b64_tr_b16 a[152:153], v152 offset:20480
  ds_read_b64_tr_b16 a[154:155], v152 offset:22528
  v_mfma_f32_16x16x32_bf16 v[60:63], a[156:159], a[236:239], v[60:63]
  s_waitcnt vmcnt(63) lgkmcnt(8)
  s_add_u32 s38, s38, 16384
  v_mfma_f32_16x16x32_bf16 v[0:3], a[160:163], a[240:243], v[0:3]
  ds_read_b64_tr_b16 a[156:157], v155 offset:20480
  ds_read_b64_tr_b16 a[158:159], v155 offset:22528
  v_mfma_f32_16x16x32_bf16 v[4:7], a[160:163], a[244:247], v[4:7]
  s_waitcnt lgkmcnt(8)
  buffer_load_dwordx4 v145, s[8:11], s20 offen offset:1024 lds
  v_mfma_f32_16x16x32_bf16 v[8:11], a[164:167], a[240:243], v[8:11]
  ds_read_b64_tr_b16 a[160:161], v158 offset:20480
  ds_read_b64_tr_b16 a[162:163], v158 offset:22528
  v_mfma_f32_16x16x32_bf16 v[12:15], a[164:167], a[244:247], v[12:15]
  s_waitcnt lgkmcnt(8)
  v_mfma_f32_16x16x32_bf16 v[16:19], a[144:147], a[240:243], v[16:19]
  ds_read_b64_tr_b16 a[164:165], v161 offset:20480
  ds_read_b64_tr_b16 a[166:167], v161 offset:22528
  v_mfma_f32_16x16x32_bf16 v[20:23], a[144:147], a[244:247], v[20:23]
  s_waitcnt lgkmcnt(8)
  v_mfma_f32_16x16x32_bf16 v[24:27], a[148:151], a[240:243], v[24:27]
  ds_read_b64_tr_b16 a[144:145], v152 offset:24576
  ds_read_b64_tr_b16 a[146:147], v152 offset:26624
  v_mfma_f32_16x16x32_bf16 v[28:31], a[148:151], a[244:247], v[28:31]
  s_waitcnt lgkmcnt(8)
  v_mfma_f32_16x16x32_bf16 v[32:35], a[152:155], a[240:243], v[32:35]
  ds_read_b64_tr_b16 a[148:149], v155 offset:24576
  ds_read_b64_tr_b16 a[150:151], v155 offset:26624
  v_mfma_f32_16x16x32_bf16 v[36:39], a[152:155], a[244:247], v[36:39]
  s_waitcnt lgkmcnt(8)
  buffer_load_dwordx4 v146, s[8:11], s20 offen offset:2048 lds
  v_mfma_f32_16x16x32_bf16 v[40:43], a[156:159], a[240:243], v[40:43]
  ds_read_b64_tr_b16 a[152:153], v158 offset:24576
  ds_read_b64_tr_b16 a[154:155], v158 offset:26624
  v_mfma_f32_16x16x32_bf16 v[44:47], a[156:159], a[244:247], v[44:47]
  s_waitcnt lgkmcnt(8)
  v_mfma_f32_16x16x32_bf16 v[48:51], a[160:163], a[240:243], v[48:51]
  ds_read_b64_tr_b16 a[156:157], v161 offset:24576
  ds_read_b64_tr_b16 a[158:159], v161 offset:26624
  v_mfma_f32_16x16x32_bf16 v[52:55], a[160:163], a[244:247], v[52:55]
  s_waitcnt lgkmcnt(8)
  buffer_load_dwordx4 a[208:211], v164, s[92:95], s38 offen offset:0 sc1
  v_mfma_f32_16x16x32_bf16 v[56:59], a[164:167], a[240:243], v[56:59]
  ds_read_b64_tr_b16 a[160:161], v152 offset:28672
  ds_read_b64_tr_b16 a[162:163], v152 offset:30720
  v_mfma_f32_16x16x32_bf16 v[60:63], a[164:167], a[244:247], v[60:63]
  s_waitcnt lgkmcnt(8)
  v_mfma_f32_16x16x32_bf16 v[0:3], a[144:147], a[248:251], v[0:3]
  ds_read_b64_tr_b16 a[164:165], v155 offset:28672
  ds_read_b64_tr_b16 a[166:167], v155 offset:30720
  v_mfma_f32_16x16x32_bf16 v[4:7], a[144:147], a[252:255], v[4:7]
  s_waitcnt lgkmcnt(8)
  buffer_load_dwordx4 v147, s[8:11], s20 offen offset:3072 lds
  v_mfma_f32_16x16x32_bf16 v[8:11], a[148:151], a[248:251], v[8:11]
  ds_read_b64_tr_b16 a[144:145], v158 offset:28672
  ds_read_b64_tr_b16 a[146:147], v158 offset:30720
  v_mfma_f32_16x16x32_bf16 v[12:15], a[148:151], a[252:255], v[12:15]
  s_waitcnt lgkmcnt(8)
  s_add_u32 s20, s20, s27
  s_add_u32 m0, s21, 114688
  v_mfma_f32_16x16x32_bf16 v[16:19], a[152:155], a[248:251], v[16:19]
  ds_read_b64_tr_b16 a[148:149], v161 offset:28672
  ds_read_b64_tr_b16 a[150:151], v161 offset:30720
  v_mfma_f32_16x16x32_bf16 v[20:23], a[152:155], a[252:255], v[20:23]
  s_waitcnt lgkmcnt(8)
  buffer_load_dwordx4 a[212:215], v164, s[92:95], s38 offen offset:1024 sc1
  v_mfma_f32_16x16x32_bf16 v[24:27], a[156:159], a[248:251], v[24:27]
  ds_read_b64_tr_b16 a[152:153], v152 offset:32768
  ds_read_b64_tr_b16 a[154:155], v152 offset:34816
  v_mfma_f32_16x16x32_bf16 v[28:31], a[156:159], a[252:255], v[28:31]
  s_waitcnt lgkmcnt(8)
  v_mfma_f32_16x16x32_bf16 v[32:35], a[160:163], a[248:251], v[32:35]
  ds_read_b64_tr_b16 a[156:157], v155 offset:32768
  ds_read_b64_tr_b16 a[158:159], v155 offset:34816
  v_mfma_f32_16x16x32_bf16 v[36:39], a[160:163], a[252:255], v[36:39]
  s_waitcnt lgkmcnt(8)
  buffer_load_dwordx4 v144, s[8:11], s20 offen offset:0 lds
  v_mfma_f32_16x16x32_bf16 v[40:43], a[164:167], a[248:251], v[40:43]
  ds_read_b64_tr_b16 a[160:161], v158 offset:32768
  ds_read_b64_tr_b16 a[162:163], v158 offset:34816
  v_mfma_f32_16x16x32_bf16 v[44:47], a[164:167], a[252:255], v[44:47]
  s_waitcnt lgkmcnt(8)
  v_mfma_f32_16x16x32_bf16 v[48:51], a[144:147], a[248:251], v[48:51]
  ds_read_b64_tr_b16 a[164:165], v161 offset:32768
  ds_read_b64_tr_b16 a[166:167], v161 offset:34816
  v_mfma_f32_16x16x32_bf16 v[52:55], a[144:147], a[252:255], v[52:55]
  s_waitcnt lgkmcnt(8)
  buffer_load_dwordx4 a[216:219], v164, s[92:95], s38 offen offset:2048 sc1
  v_mfma_f32_16x16x32_bf16 v[56:59], a[148:151], a[248:251], v[56:59]
  ds_read_b64_tr_b16 a[144:145], v152 offset:36864
  ds_read_b64_tr_b16 a[146:147], v152 offset:38912
  v_mfma_f32_16x16x32_bf16 v[60:63], a[148:151], a[252:255], v[60:63]
  s_waitcnt vmcnt(63) lgkmcnt(8)
  v_mfma_f32_16x16x32_bf16 v[0:3], a[152:155], v[192:195], v[0:3]
  ds_read_b64_tr_b16 a[148:149], v155 offset:36864
  ds_read_b64_tr_b16 a[150:151], v155 offset:38912
  v_mfma_f32_16x16x32_bf16 v[4:7], a[152:155], v[196:199], v[4:7]
  s_waitcnt lgkmcnt(8)
  buffer_load_dwordx4 v145, s[8:11], s20 offen offset:1024 lds
  v_mfma_f32_16x16x32_bf16 v[8:11], a[156:159], v[192:195], v[8:11]
  ds_read_b64_tr_b16 a[152:153], v158 offset:36864
  ds_read_b64_tr_b16 a[154:155], v158 offset:38912
  v_mfma_f32_16x16x32_bf16 v[12:15], a[156:159], v[196:199], v[12:15]
  s_waitcnt lgkmcnt(8)
  v_mfma_f32_16x16x32_bf16 v[16:19], a[160:163], v[192:195], v[16:19]
  ds_read_b64_tr_b16 a[156:157], v161 offset:36864
  ds_read_b64_tr_b16 a[158:159], v161 offset:38912
  v_mfma_f32_16x16x32_bf16 v[20:23], a[160:163], v[196:199], v[20:23]
  s_waitcnt lgkmcnt(8)
  buffer_load_dwordx4 a[220:223], v164, s[92:95], s38 offen offset:3072 sc1
  v_mfma_f32_16x16x32_bf16 v[24:27], a[164:167], v[192:195], v[24:27]
  ds_read_b64_tr_b16 a[160:161], v152 offset:40960
  ds_read_b64_tr_b16 a[162:163], v152 offset:43008
  v_mfma_f32_16x16x32_bf16 v[28:31], a[164:167], v[196:199], v[28:31]
  s_waitcnt lgkmcnt(8)
  s_waitcnt vmcnt(45)
  s_add_u32 s38, s38, 16384
  v_min3_u32 v172, v172, v173, v174
  v_mfma_f32_16x16x32_bf16 v[32:35], a[144:147], v[192:195], v[32:35]
  ds_read_b64_tr_b16 a[164:165], v155 offset:40960
  ds_read_b64_tr_b16 a[166:167], v155 offset:43008
  v_mfma_f32_16x16x32_bf16 v[36:39], a[144:147], v[196:199], v[36:39]
  s_waitcnt lgkmcnt(8)
  buffer_load_dwordx4 v146, s[8:11], s20 offen offset:2048 lds
  v_mfma_f32_16x16x32_bf16 v[40:43], a[148:151], v[192:195], v[40:43]
  ds_read_b64_tr_b16 a[144:145], v158 offset:40960
  ds_read_b64_tr_b16 a[146:147], v158 offset:43008
  v_mfma_f32_16x16x32_bf16 v[44:47], a[148:151], v[196:199], v[44:47]
  s_waitcnt lgkmcnt(8)
  v_min_u32 v172, v172, v175
  v_lshlrev_b32 v173, 16, v172
  v_mfma_f32_16x16x32_bf16 v[48:51], a[152:155], v[192:195], v[48:51]
  ds_read_b64_tr_b16 a[148:149], v161 offset:40960
  ds_read_b64_tr_b16 a[150:151], v161 offset:43008
  v_mfma_f32_16x16x32_bf16 v[52:55], a[152:155], v[196:199], v[52:55]
  s_waitcnt lgkmcnt(8)
  s_nop 0
  v_readfirstlane_b32 s36, v173
  v_mfma_f32_16x16x32_bf16 v[56:59], a[156:159], v[192:195], v[56:59]
  ds_read_b64_tr_b16 a[152:153], v152 offset:45056
  ds_read_b64_tr_b16 a[154:155], v152 offset:47104
  v_mfma_f32_16x16x32_bf16 v[60:63], a[156:159], v[196:199], v[60:63]
  s_waitcnt lgkmcnt(8)
  v_mfma_f32_16x16x32_bf16 v[0:3], a[160:163], v[200:203], v[0:3]
  ds_read_b64_tr_b16 a[156:157], v155 offset:45056
  ds_read_b64_tr_b16 a[158:159], v155 offset:47104
  v_mfma_f32_16x16x32_bf16 v[4:7], a[160:163], v[204:207], v[4:7]
  s_waitcnt lgkmcnt(8)
  buffer_load_dwordx4 v147, s[8:11], s20 offen offset:3072 lds
  v_mfma_f32_16x16x32_bf16 v[8:11], a[164:167], v[200:203], v[8:11]
  ds_read_b64_tr_b16 a[160:161], v158 offset:45056
  ds_read_b64_tr_b16 a[162:163], v158 offset:47104
  v_mfma_f32_16x16x32_bf16 v[12:15], a[164:167], v[204:207], v[12:15]
  s_waitcnt lgkmcnt(8)
  s_add_u32 s20, s20, s27
  s_add_u32 m0, s21, 131072
  v_mfma_f32_16x16x32_bf16 v[16:19], a[144:147], v[200:203], v[16:19]
  ds_read_b64_tr_b16 a[164:165], v161 offset:45056
  ds_read_b64_tr_b16 a[166:167], v161 offset:47104
  v_mfma_f32_16x16x32_bf16 v[20:23], a[144:147], v[204:207], v[20:23]
  s_waitcnt vmcnt(14) lgkmcnt(8)
  s_barrier
  v_mfma_f32_16x16x32_bf16 v[24:27], a[148:151], v[200:203], v[24:27]
  ds_read_b64_tr_b16 a[144:145], v153 offset:0
  ds_read_b64_tr_b16 a[146:147], v153 offset:2048
  v_mfma_f32_16x16x32_bf16 v[28:31], a[148:151], v[204:207], v[28:31]
  s_waitcnt lgkmcnt(8)
  s_cmp_lt_u32 s38, s36
  s_cbranch_scc0 K3_slow_four12
K3_back_four12:
  v_mfma_f32_16x16x32_bf16 v[32:35], a[152:155], v[200:203], v[32:35]
  ds_read_b64_tr_b16 a[148:149], v156 offset:0
  ds_read_b64_tr_b16 a[150:151], v156 offset:2048
  v_mfma_f32_16x16x32_bf16 v[36:39], a[152:155], v[204:207], v[36:39]
  s_waitcnt lgkmcnt(8)
  buffer_load_dwordx4 v144, s[8:11], s20 offen offset:0 lds
  v_mfma_f32_16x16x32_bf16 v[40:43], a[156:159], v[200:203], v[40:43]
  ds_read_b64_tr_b16 a[152:153], v159 offset:0
  ds_read_b64_tr_b16 a[154:155], v159 offset:2048
  v_mfma_f32_16x16x32_bf16 v[44:47], a[156:159], v[204:207], v[44:47]
  s_waitcnt lgkmcnt(8)
  v_mfma_f32_16x16x32_bf16 v[48:51], a[160:163], v[200:203], v[48:51]
  ds_read_b64_tr_b16 a[156:157], v162 offset:0
  ds_read_b64_tr_b16 a[158:159], v162 offset:2048
  v_mfma_f32_16x16x32_bf16 v[52:55], a[160:163], v[204:207], v[52:55]
  s_waitcnt lgkmcnt(8)
  buffer_load_dwordx4 a[224:227], v164, s[92:95], s38 offen offset:0 sc1
  v_mfma_f32_16x16x32_bf16 v[56:59], a[164:167], v[200:203], v[56:59]
  ds_read_b64_tr_b16 a[160:161], v153 offset:4096
  ds_read_b64_tr_b16 a[162:163], v153 offset:6144
  v_mfma_f32_16x16x32_bf16 v[60:63], a[164:167], v[204:207], v[60:63]
  s_waitcnt vmcnt(62) lgkmcnt(8)
  v_mfma_f32_16x16x32_bf16 v[0:3], a[144:147], v[208:211], v[0:3]
  ds_read_b64_tr_b16 a[164:165], v156 offset:4096
  ds_read_b64_tr_b16 a[166:167], v156 offset:6144
  v_mfma_f32_16x16x32_bf16 v[4:7], a[144:147], v[212:215], v[4:7]
  s_waitcnt lgkmcnt(8)
  buffer_load_dwordx4 v145, s[8:11], s20 offen offset:1024 lds
  v_mfma_f32_16x16x32_bf16 v[8:11], a[148:151], v[208:211], v[8:11]
  ds_read_b64_tr_b16 a[144:145], v159 offset:4096
  ds_read_b64_tr_b16 a[146:147], v159 offset:6144
  v_mfma_f32_16x16x32_bf16 v[12:15], a[148:151], v[212:215], v[12:15]
  s_waitcnt lgkmcnt(8)
  v_mfma_f32_16x16x32_bf16 v[16:19], a[152:155], v[208:211], v[16:19]
  ds_read_b64_tr_b16 a[148:149], v162 offset:4096
  ds_read_b64_tr_b16 a[150:151], v162 offset:6144
  v_mfma_f32_16x16x32_bf16 v[20:23], a[152:155], v[212:215], v[20:23]
  s_waitcnt lgkmcnt(8)
  buffer_load_dwordx4 a[228:231], v164, s[92:95], s38 offen offset:1024 sc1
  v_mfma_f32_16x16x32_bf16 v[24:27], a[156:159], v[208:211], v[24:27]
  ds_read_b64_tr_b16 a[152:153], v153 offset:8192
  ds_read_b64_tr_b16 a[154:155], v153 offset:10240
  v_mfma_f32_16x16x32_bf16 v[28:31], a[156:159], v[212:215], v[28:31]
  s_waitcnt lgkmcnt(8)
  v_mfma_f32_16x16x32_bf16 v[32:35], a[160:163], v[208:211], v[32:35]
  ds_read_b64_tr_b16 a[156:157], v156 offset:8192
  ds_read_b64_tr_b16 a[158:159], v156 offset:10240
  v_mfma_f32_16x16x32_bf16 v[36:39], a[160:163], v[212:215], v[36:39]
  s_waitcnt lgkmcnt(8)
  buffer_load_dwordx4 v146, s[8:11], s20 offen offset:2048 lds
  v_mfma_f32_16x16x32_bf16 v[40:43], a[164:167], v[208:211], v[40:43]
  ds_read_b64_tr_b16 a[160:161], v159 offset:8192
  ds_read_b64_tr_b16 a[162:163], v159 offset:10240
  v_mfma_f32_16x16x32_bf16 v[44:47], a[164:167], v[212:215], v[44:47]
  s_waitcnt lgkmcnt(8)
  v_mfma_f32_16x16x32_bf16 v[48:51], a[144:147], v[208:211], v[48:51]
  ds_read_b64_tr_b16 a[164:165], v162 offset:8192
  ds_read_b64_tr_b16 a[166:167], v162 offset:10240
  v_mfma_f32_16x16x32_bf16 v[52:55], a[144:147], v[212:215], v[52:55]
  s_waitcnt lgkmcnt(8)
  buffer_load_dwordx4 a[232:235], v164, s[92:95], s38 offen offset:2048 sc1
  v_mfma_f32_16x16x32_bf16 v[56:59], a[148:151], v[208:211], v[56:59]
  ds_read_b64_tr_b16 a[144:145], v153 offset:12288
  ds_read_b64_tr_b16 a[146:147], v153 offset:14336
  v_mfma_f32_16x16x32_bf16 v[60:63], a[148:151], v[212:215], v[60:63]
  s_waitcnt lgkmcnt(8)
  v_mfma_f32_16x16x32_bf16 v[0:3], a[152:155], v[216:219], v[0:3]
  ds_read_b64_tr_b16 a[148:149], v156 offset:12288
  ds_read_b64_tr_b16 a[150:151], v156 offset:14336
  v_mfma_f32_16x16x32_bf16 v[4:7], a[152:155], v[220:223], v[4:7]
  s_waitcnt lgkmcnt(8)
  buffer_load_dwordx4 v147, s[8:11], s20 offen offset:3072 lds
  v_mfma_f32_16x16x32_bf16 v[8:11], a[156:159], v[216:219], v[8:11]
  ds_read_b64_tr_b16 a[152:153], v159 offset:12288
  ds_read_b64_tr_b16 a[154:155], v159 offset:14336
  v_mfma_f32_16x16x32_bf16 v[12:15], a[156:159], v[220:223], v[12:15]
  s_waitcnt lgkmcnt(8)
  s_add_u32 s20, s20, s27
  s_add_u32 m0, s21, 0
  v_mfma_f32_16x16x32_bf16 v[16:19], a[160:163], v[216:219], v[16:19]
  ds_read_b64_tr_b16 a[156:157], v162 offset:12288
  ds_read_b64_tr_b16 a[158:159], v162 offset:14336
  v_mfma_f32_16x16x32_bf16 v[20:23], a[160:163], v[220:223], v[20:23]
  s_waitcnt lgkmcnt(8)
  buffer_load_dwordx4 a[236:239], v164, s[92:95], s38 offen offset:3072 sc1
  v_mfma_f32_16x16x32_bf16 v[24:27], a[164:167], v[216:219], v[24:27]
  ds_read_b64_tr_b16 a[160:161], v153 offset:16384
  ds_read_b64_tr_b16 a[162:163], v153 offset:18432
  v_mfma_f32_16x16x32_bf16 v[28:31], a[164:167], v[220:223], v[28:31]
  s_waitcnt lgkmcnt(8)
  s_add_u32 s38, s38, 16384
  v_mfma_f32_16x16x32_bf16 v[32:35], a[144:147], v[216:219], v[32:35]
  ds_read_b64_tr_b16 a[164:165], v156 offset:16384
  ds_read_b64_tr_b16 a[166:167], v156 offset:18432
  v_mfma_f32_16x16x32_bf16 v[36:39], a[144:147], v[220:223], v[36:39]
  s_waitcnt lgkmcnt(8)
  buffer_load_dwordx4 v144, s[8:11], s20 offen offset:0 lds
  v_mfma_f32_16x16x32_bf16 v[40:43], a[148:151], v[216:219], v[40:43]
  ds_read_b64_tr_b16 a[144:145], v159 offset:16384
  ds_read_b64_tr_b16 a[146:147], v159 offset:18432
  v_mfma_f32_16x16x32_bf16 v[44:47], a[148:151], v[220:223], v[44:47]
  s_waitcnt lgkmcnt(8)
  v_mfma_f32_16x16x32_bf16 v[48:51], a[152:155], v[216:219], v[48:51]
  ds_read_b64_tr_b16 a[148:149], v162 offset:16384
  ds_read_b64_tr_b16 a[150:151], v162 offset:18432
  v_mfma_f32_16x16x32_bf16 v[52:55], a[152:155], v[220:223], v[52:55]
  s_waitcnt lgkmcnt(8)
  v_mfma_f32_16x16x32_bf16 v[56:59], a[156:159], v[216:219], v[56:59]
  ds_read_b64_tr_b16 a[152:153], v153 offset:20480
  ds_read_b64_tr_b16 a[154:155], v153 offset:22528
  v_mfma_f32_16x16x32_bf16 v[60:63], a[156:159], v[220:223], v[60:63]
  s_waitcnt vmcnt(55) lgkmcnt(8)
  v_mfma_f32_16x16x32_bf16 v[0:3], a[160:163], v[224:227], v[0:3]
  ds_read_b64_tr_b16 a[156:157], v156 offset:20480
  ds_read_b64_tr_b16 a[158:159], v156 offset:22528
  v_mfma_f32_16x16x32_bf16 v[4:7], a[160:163], v[228:231], v[4:7]
  s_waitcnt lgkmcnt(8)
  buffer_load_dwordx4 v145, s[8:11], s20 offen offset:1024 lds
  v_mfma_f32_16x16x32_bf16 v[8:11], a[164:167], v[224:227], v[8:11]
  ds_read_b64_tr_b16 a[160:161], v159 offset:20480
  ds_read_b64_tr_b16 a[162:163], v159 offset:22528
  v_mfma_f32_16x16x32_bf16 v[12:15], a[164:167], v[228:231], v[12:15]
  s_waitcnt lgkmcnt(8)
  v_mfma_f32_16x16x32_bf16 v[16:19], a[144:147], v[224:227], v[16:19]
  ds_read_b64_tr_b16 a[164:165], v162 offset:20480
  ds_read_b64_tr_b16 a[166:167], v162 offset:22528
  v_mfma_f32_16x16x32_bf16 v[20:23], a[144:147], v[228:231], v[20:23]
  s_waitcnt lgkmcnt(8)
  buffer_load_dwordx4 a[240:243], v164, s[92:95], s38 offen offset:0 sc1
  v_mfma_f32_16x16x32_bf16 v[24:27], a[148:151], v[224:227], v[24:27]
  ds_read_b64_tr_b16 a[144:145], v153 offset:24576
  ds_read_b64_tr_b16 a[146:147], v153 offset:26624
  v_mfma_f32_16x16x32_bf16 v[28:31], a[148:151], v[228:231], v[28:31]
  s_waitcnt lgkmcnt(8)
  v_mfma_f32_16x16x32_bf16 v[32:35], a[152:155], v[224:227], v[32:35]
  ds_read_b64_tr_b16 a[148:149], v156 offset:24576
  ds_read_b64_tr_b16 a[150:151], v156 offset:26624
  v_mfma_f32_16x16x32_bf16 v[36:39], a[152:155], v[228:231], v[36:39]
  s_waitcnt lgkmcnt(8)
  buffer_load_dwordx4 v146, s[8:11], s20 offen offset:2048 lds
  v_mfma_f32_16x16x32_bf16 v[40:43], a[156:159], v[224:227], v[40:43]
  ds_read_b64_tr_b16 a[152:153], v159 offset:24576
  ds_read_b64_tr_b16 a[154:155], v159 offset:26624
  v_mfma_f32_16x16x32_bf16 v[44:47], a[156:159], v[228:231], v[44:47]
  s_waitcnt lgkmcnt(8)
  v_mfma_f32_16x16x32_bf16 v[48:51], a[160:163], v[224:227], v[48:51]
  ds_read_b64_tr_b16 a[156:157], v162 offset:24576
  ds_read_b64_tr_b16 a[158:159], v162 offset:26624
  v_mfma_f32_16x16x32_bf16 v[52:55], a[160:163], v[228:231], v[52:55]
  s_waitcnt lgkmcnt(8)
  buffer_load_dwordx4 a[244:247], v164, s[92:95], s38 offen offset:1024 sc1
  v_mfma_f32_16x16x32_bf16 v[56:59], a[164:167], v[224:227], v[56:59]
  ds_read_b64_tr_b16 a[160:161], v153 offset:28672
  ds_read_b64_tr_b16 a[162:163], v153 offset:30720
  v_mfma_f32_16x16x32_bf16 v[60:63], a[164:167], v[228:231], v[60:63]
  s_waitcnt lgkmcnt(8)
  v_mfma_f32_16x16x32_bf16 v[0:3], a[144:147], v[232:235], v[0:3]
  ds_read_b64_tr_b16 a[164:165], v156 offset:28672
  ds_read_b64_tr_b16 a[166:167], v156 offset:30720
  v_mfma_f32_16x16x32_bf16 v[4:7], a[144:147], v[236:239], v[4:7]
  s_waitcnt lgkmcnt(8)
  buffer_load_dwordx4 v147, s[8:11], s20 offen offset:3072 lds
  v_mfma_f32_16x16x32_bf16 v[8:11], a[148:151], v[232:235], v[8:11]
  ds_read_b64_tr_b16 a[144:145], v159 offset:28672
  ds_read_b64_tr_b16 a[146:147], v159 offset:30720
  v_mfma_f32_16x16x32_bf16 v[12:15], a[148:151], v[236:239], v[12:15]
  s_waitcnt lgkmcnt(8)
  s_add_u32 s20, s20, s27
  s_add_u32 m0, s21, 16384
  v_mfma_f32_16x16x32_bf16 v[16:19], a[152:155], v[232:235], v[16:19]
  ds_read_b64_tr_b16 a[148:149], v162 offset:28672
  ds_read_b64_tr_b16 a[150:151], v162 offset:30720
  v_mfma_f32_16x16x32_bf16 v[20:23], a[152:155], v[236:239], v[20:23]
  s_waitcnt lgkmcnt(8)
  buffer_load_dwordx4 a[248:251], v164, s[92:95], s38 offen offset:2048 sc1
  v_mfma_f32_16x16x32_bf16 v[24:27], a[156:159], v[232:235], v[24:27]
  ds_read_b64_tr_b16 a[152:153], v153 offset:32768
  ds_read_b64_tr_b16 a[154:155], v153 offset:34816
  v_mfma_f32_16x16x32_bf16 v[28:31], a[156:159], v[236:239], v[28:31]
  s_waitcnt lgkmcnt(8)
  v_mfma_f32_16x16x32_bf16 v[32:35], a[160:163], v[232:235], v[32:35]
  ds_read_b64_tr_b16 a[156:157], v156 offset:32768
  ds_read_b64_tr_b16 a[158:159], v156 offset:34816
  v_mfma_f32_16x16x32_bf16 v[36:39], a[160:163], v[236:239], v[36:39]
  s_waitcnt lgkmcnt(8)
  buffer_load_dwordx4 v144, s[8:11], s20 offen offset:0 lds
  v_mfma_f32_16x16x32_bf16 v[40:43], a[164:167], v[232:235], v[40:43]
  ds_read_b64_tr_b16 a[160:161], v159 offset:32768
  ds_read_b64_tr_b16 a[162:163], v159 offset:34816
  v_mfma_f32_16x16x32_bf16 v[44:47], a[164:167], v[236:239], v[44:47]
  s_waitcnt lgkmcnt(8)
  v_mfma_f32_16x16x32_bf16 v[48:51], a[144:147], v[232:235], v[48:51]
  ds_read_b64_tr_b16 a[164:165], v162 offset:32768
  ds_read_b64_tr_b16 a[166:167], v162 offset:34816
  v_mfma_f32_16x16x32_bf16 v[52:55], a[144:147], v[236:239], v[52:55]
  s_waitcnt lgkmcnt(8)
  buffer_load_dwordx4 a[252:255], v164, s[92:95], s38 offen offset:3072 sc1
  v_mfma_f32_16x16x32_bf16 v[56:59], a[148:151], v[232:235], v[56:59]
  ds_read_b64_tr_b16 a[144:145], v153 offset:36864
  ds_read_b64_tr_b16 a[146:147], v153 offset:38912
  v_mfma_f32_16x16x32_bf16 v[60:63], a[148:151], v[236:239], v[60:63]
  s_waitcnt vmcnt(49) lgkmcnt(8)
  s_add_u32 s38, s38, 16384
  v_mfma_f32_16x16x32_bf16 v[0:3], a[152:155], v[240:243], v[0:3]
  ds_read_b64_tr_b16 a[148:149], v156 offset:36864
  ds_read_b64_tr_b16 a[150:151], v156 offset:38912
  v_mfma_f32_16x16x32_bf16 v[4:7], a[152:155], v[244:247], v[4:7]
  s_waitcnt lgkmcnt(8)
  buffer_load_dwordx4 v145, s[8:11], s20 offen offset:1024 lds
  v_mfma_f32_16x16x32_bf16 v[8:11], a[156:159], v[240:243], v[8:11]
  ds_read_b64_tr_b16 a[152:153], v159 offset:36864
  ds_read_b64_tr_b16 a[154:155], v159 offset:38912
  v_mfma_f32_16x16x32_bf16 v[12:15], a[156:159], v[244:247], v[12:15]
  s_waitcnt lgkmcnt(8)
  v_mfma_f32_16x16x32_bf16 v[16:19], a[160:163], v[240:243], v[16:19]
  ds_read_b64_tr_b16 a[156:157], v162 offset:36864
  ds_read_b64_tr_b16 a[158:159], v162 offset:38912
  v_mfma_f32_16x16x32_bf16 v[20:23], a[160:163], v[244:247], v[20:23]
  s_waitcnt lgkmcnt(8)
  v_mfma_f32_16x16x32_bf16 v[24:27], a[164:167], v[240:243], v[24:27]
  ds_read_b64_tr_b16 a[160:161], v153 offset:40960
  ds_read_b64_tr_b16 a[162:163], v153 offset:43008
  v_mfma_f32_16x16x32_bf16 v[28:31], a[164:167], v[244:247], v[28:31]
  s_waitcnt lgkmcnt(8)
  v_mfma_f32_16x16x32_bf16 v[32:35], a[144:147], v[240:243], v[32:35]
  ds_read_b64_tr_b16 a[164:165], v156 offset:40960
  ds_read_b64_tr_b16 a[166:167], v156 offset:43008
  v_mfma_f32_16x16x32_bf16 v[36:39], a[144:147], v[244:247], v[36:39]
  s_waitcnt lgkmcnt(8)
  buffer_load_dwordx4 v146, s[8:11], s20 offen offset:2048 lds
  v_mfma_f32_16x16x32_bf16 v[40:43], a[148:151], v[240:243], v[40:43]
  ds_read_b64_tr_b16 a[144:145], v159 offset:40960
  ds_read_b64_tr_b16 a[146:147], v159 offset:43008
  v_mfma_f32_16x16x32_bf16 v[44:47], a[148:151], v[244:247], v[44:47]
  s_waitcnt lgkmcnt(8)
  buffer_load_dwordx4 v[172:175], off, s[12:15], s33 sc1
  v_mfma_f32_16x16x32_bf16 v[48:51], a[152:155], v[240:243], v[48:51]
  ds_read_b64_tr_b16 a[148:149], v162 offset:40960
  ds_read_b64_tr_b16 a[150:151], v162 offset:43008
  v_mfma_f32_16x16x32_bf16 v[52:55], a[152:155], v[244:247], v[52:55]
  s_waitcnt lgkmcnt(8)
  buffer_load_dwordx4 v[192:195], v164, s[92:95], s38 offen offset:0 sc1
  v_mfma_f32_16x16x32_bf16 v[56:59], a[156:159], v[240:243], v[56:59]
  ds_read_b64_tr_b16 a[152:153], v153 offset:45056
  ds_read_b64_tr_b16 a[154:155], v153 offset:47104
  v_mfma_f32_16x16x32_bf16 v[60:63], a[156:159], v[244:247], v[60:63]
  s_waitcnt lgkmcnt(8)
  v_mfma_f32_16x16x32_bf16 v[0:3], a[160:163], v[248:251], v[0:3]
  ds_read_b64_tr_b16 a[156:157], v156 offset:45056
  ds_read_b64_tr_b16 a[158:159], v156 offset:47104
  v_mfma_f32_16x16x32_bf16 v[4:7], a[160:163], v[252:255], v[4:7]
  s_waitcnt lgkmcnt(8)
  buffer_load_dwordx4 v147, s[8:11], s20 offen offset:3072 lds
  v_mfma_f32_16x16x32_bf16 v[8:11], a[164:167], v[248:251], v[8:11]
  ds_read_b64_tr_b16 a[160:161], v159 offset:45056
  ds_read_b64_tr_b16 a[162:163], v159 offset:47104
  v_mfma_f32_16x16x32_bf16 v[12:15], a[164:167], v[252:255], v[12:15]
  s_waitcnt lgkmcnt(8)
  s_add_u32 s20, s20, s27
  s_add_u32 m0, s21, 32768
  v_mfma_f32_16x16x32_bf16 v[16:19], a[144:147], v[248:251], v[16:19]
  ds_read_b64_tr_b16 a[164:165], v162 offset:45056
  ds_read_b64_tr_b16 a[166:167], v162 offset:47104
  v_mfma_f32_16x16x32_bf16 v[20:23], a[144:147], v[252:255], v[20:23]
  s_waitcnt vmcnt(15) lgkmcnt(8)
  s_barrier
  v_mfma_f32_16x16x32_bf16 v[24:27], a[148:151], v[248:251], v[24:27]
  ds_read_b64_tr_b16 a[144:145], v154 offset:0
  ds_read_b64_tr_b16 a[146:147], v154 offset:2048
  v_mfma_f32_16x16x32_bf16 v[28:31], a[148:151], v[252:255], v[28:31]
  s_waitcnt lgkmcnt(8)
  v_mfma_f32_16x16x32_bf16 v[32:35], a[152:155], v[248:251], v[32:35]
  ds_read_b64_tr_b16 a[148:149], v157 offset:0
  ds_read_b64_tr_b16 a[150:151], v157 offset:2048
  v_mfma_f32_16x16x32_bf16 v[36:39], a[152:155], v[252:255], v[36:39]
  s_waitcnt lgkmcnt(8)
  buffer_load_dwordx4 v144, s[8:11], s20 offen offset:0 lds
  v_mfma_f32_16x16x32_bf16 v[40:43], a[156:159], v[248:251], v[40:43]
  ds_read_b64_tr_b16 a[152:153], v160 offset:0
  ds_read_b64_tr_b16 a[154:155], v160 offset:2048
  v_mfma_f32_16x16x32_bf16 v[44:47], a[156:159], v[252:255], v[44:47]
  s_waitcnt lgkmcnt(8)
  v_mfma_f32_16x16x32_bf16 v[48:51], a[160:163], v[248:251], v[48:51]
  ds_read_b64_tr_b16 a[156:157], v163 offset:0
  ds_read_b64_tr_b16 a[158:159], v163 offset:2048
  v_mfma_f32_16x16x32_bf16 v[52:55], a[160:163], v[252:255], v[52:55]
  s_waitcnt lgkmcnt(8)
  buffer_load_dwordx4 v[196:199], v164, s[92:95], s38 offen offset:1024 sc1
  v_mfma_f32_16x16x32_bf16 v[56:59], a[164:167], v[248:251], v[56:59]
  ds_read_b64_tr_b16 a[160:161], v154 offset:4096
  ds_read_b64_tr_b16 a[162:163], v154 offset:6144
  v_mfma_f32_16x16x32_bf16 v[60:63], a[164:167], v[252:255], v[60:63]
  s_waitcnt vmcnt(46) lgkmcnt(8)
  v_mfma_f32_16x16x32_bf16 v[0:3], a[144:147], a[176:179], v[0:3]
  ds_read_b64_tr_b16 a[164:165], v157 offset:4096
  ds_read_b64_tr_b16 a[166:167], v157 offset:6144
  v_mfma_f32_16x16x32_bf16 v[4:7], a[144:147], a[180:183], v[4:7]
  s_waitcnt lgkmcnt(8)
  buffer_load_dwordx4 v145, s[8:11], s20 offen offset:1024 lds
  v_mfma_f32_16x16x32_bf16 v[8:11], a[148:151], a[176:179], v[8:11]
  ds_read_b64_tr_b16 a[144:145], v160 offset:4096
  ds_read_b64_tr_b16 a[146:147], v160 offset:6144
  v_mfma_f32_16x16x32_bf16 v[12:15], a[148:151], a[180:183], v[12:15]
  s_waitcnt lgkmcnt(8)
  v_mfma_f32_16x16x32_bf16 v[16:19], a[152:155], a[176:179], v[16:19]
  ds_read_b64_tr_b16 a[148:149], v163 offset:4096
  ds_read_b64_tr_b16 a[150:151], v163 offset:6144
  v_mfma_f32_16x16x32_bf16 v[20:23], a[152:155], a[180:183], v[20:23]
  s_waitcnt lgkmcnt(8)
  buffer_load_dwordx4 v[200:203], v164, s[92:95], s38 offen offset:2048 sc1
  v_mfma_f32_16x16x32_bf16 v[24:27], a[156:159], a[176:179], v[24:27]
  ds_read_b64_tr_b16 a[152:153], v154 offset:8192
  ds_read_b64_tr_b16 a[154:155], v154 offset:10240
  v_mfma_f32_16x16x32_bf16 v[28:31], a[156:159], a[180:183], v[28:31]
  s_waitcnt lgkmcnt(8)
  v_mfma_f32_16x16x32_bf16 v[32:35], a[160:163], a[176:179], v[32:35]
  ds_read_b64_tr_b16 a[156:157], v157 offset:8192
  ds_read_b64_tr_b16 a[158:159], v157 offset:10240
  v_mfma_f32_16x16x32_bf16 v[36:39], a[160:163], a[180:183], v[36:39]
  s_waitcnt lgkmcnt(8)
  buffer_load_dwordx4 v146, s[8:11], s20 offen offset:2048 lds
  v_mfma_f32_16x16x32_bf16 v[40:43], a[164:167], a[176:179], v[40:43]
  ds_read_b64_tr_b16 a[160:161], v160 offset:8192
  ds_read_b64_tr_b16 a[162:163], v160 offset:10240
  v_mfma_f32_16x16x32_bf16 v[44:47], a[164:167], a[180:183], v[44:47]
  s_waitcnt lgkmcnt(8)
  v_mfma_f32_16x16x32_bf16 v[48:51], a[144:147], a[176:179], v[48:51]
  ds_read_b64_tr_b16 a[164:165], v163 offset:8192
  ds_read_b64_tr_b16 a[166:167], v163 offset:10240
  v_mfma_f32_16x16x32_bf16 v[52:55], a[144:147], a[180:183], v[52:55]
  s_waitcnt lgkmcnt(8)
  buffer_load_dwordx4 v[204:207], v164, s[92:95], s38 offen offset:3072 sc1
  v_mfma_f32_16x16x32_bf16 v[56:59], a[148:151], a[176:179], v[56:59]
  ds_read_b64_tr_b16 a[144:145], v154 offset:12288
  ds_read_b64_tr_b16 a[146:147], v154 offset:14336
  v_mfma_f32_16x16x32_bf16 v[60:63], a[148:151], a[180:183], v[60:63]
  s_waitcnt lgkmcnt(8)
  s_add_u32 s38, s38, 16384
  v_mfma_f32_16x16x32_bf16 v[0:3], a[152:155], a[184:187], v[0:3]
  ds_read_b64_tr_b16 a[148:149], v157 offset:12288
  ds_read_b64_tr_b16 a[150:151], v157 offset:14336
  v_mfma_f32_16x16x32_bf16 v[4:7], a[152:155], a[188:191], v[4:7]
  s_waitcnt lgkmcnt(8)
  buffer_load_dwordx4 v147, s[8:11], s20 offen offset:3072 lds
  v_mfma_f32_16x16x32_bf16 v[8:11], a[156:159], a[184:187], v[8:11]
  ds_read_b64_tr_b16 a[152:153], v160 offset:12288
  ds_read_b64_tr_b16 a[154:155], v160 offset:14336
  v_mfma_f32_16x16x32_bf16 v[12:15], a[156:159], a[188:191], v[12:15]
  s_waitcnt lgkmcnt(8)
  s_add_u32 s20, s20, s27
  s_add_u32 m0, s21, 49152
  v_mfma_f32_16x16x32_bf16 v[16:19], a[160:163], a[184:187], v[16:19]
  ds_read_b64_tr_b16 a[156:157], v163 offset:12288
  ds_read_b64_tr_b16 a[158:159], v163 offset:14336
  v_mfma_f32_16x16x32_bf16 v[20:23], a[160:163], a[188:191], v[20:23]
  s_waitcnt lgkmcnt(8)
  v_mfma_f32_16x16x32_bf16 v[24:27], a[164:167], a[184:187], v[24:27]
  ds_read_b64_tr_b16 a[160:161], v154 offset:16384
  ds_read_b64_tr_b16 a[162:163], v154 offset:18432
  v_mfma_f32_16x16x32_bf16 v[28:31], a[164:167], a[188:191], v[28:31]
  s_waitcnt lgkmcnt(8)
  v_mfma_f32_16x16x32_bf16 v[32:35], a[144:147], a[184:187], v[32:35]
  ds_read_b64_tr_b16 a[164:165], v157 offset:16384
  ds_read_b64_tr_b16 a[166:167], v157 offset:18432
  v_mfma_f32_16x16x32_bf16 v[36:39], a[144:147], a[188:191], v[36:39]
  s_waitcnt lgkmcnt(8)
  buffer_load_dwordx4 v144, s[8:11], s20 offen offset:0 lds
  v_mfma_f32_16x16x32_bf16 v[40:43], a[148:151], a[184:187], v[40:43]
  ds_read_b64_tr_b16 a[144:145], v160 offset:16384
  ds_read_b64_tr_b16 a[146:147], v160 offset:18432
  v_mfma_f32_16x16x32_bf16 v[44:47], a[148:151], a[188:191], v[44:47]
  s_waitcnt lgkmcnt(8)
  v_mfma_f32_16x16x32_bf16 v[48:51], a[152:155], a[184:187], v[48:51]
  ds_read_b64_tr_b16 a[148:149], v163 offset:16384
  ds_read_b64_tr_b16 a[150:151], v163 offset:18432
  v_mfma_f32_16x16x32_bf16 v[52:55], a[152:155], a[188:191], v[52:55]
  s_waitcnt lgkmcnt(8)
  buffer_load_dwordx4 v[208:211], v164, s[92:95], s38 offen offset:0 sc1
  v_mfma_f32_16x16x32_bf16 v[56:59], a[156:159], a[184:187], v[56:59]
  ds_read_b64_tr_b16 a[152:153], v154 offset:20480
  ds_read_b64_tr_b16 a[154:155], v154 offset:22528
  v_mfma_f32_16x16x32_bf16 v[60:63], a[156:159], a[188:191], v[60:63]
  s_waitcnt vmcnt(42) lgkmcnt(8)
  v_mfma_f32_16x16x32_bf16 v[0:3], a[160:163], a[192:195], v[0:3]
  ds_read_b64_tr_b16 a[156:157], v157 offset:20480
  ds_read_b64_tr_b16 a[158:159], v157 offset:22528
  v_mfma_f32_16x16x32_bf16 v[4:7], a[160:163], a[196:199], v[4:7]
  s_waitcnt lgkmcnt(8)
  buffer_load_dwordx4 v145, s[8:11], s20 offen offset:1024 lds
  v_mfma_f32_16x16x32_bf16 v[8:11], a[164:167], a[192:195], v[8:11]
  ds_read_b64_tr_b16 a[160:161], v160 offset:20480
  ds_read_b64_tr_b16 a[162:163], v160 offset:22528
  v_mfma_f32_16x16x32_bf16 v[12:15], a[164:167], a[196:199], v[12:15]
  s_waitcnt lgkmcnt(8)
  v_mfma_f32_16x16x32_bf16 v[16:19], a[144:147], a[192:195], v[16:19]
  ds_read_b64_tr_b16 a[164:165], v163 offset:20480
  ds_read_b64_tr_b16 a[166:167], v163 offset:22528
  v_mfma_f32_16x16x32_bf16 v[20:23], a[144:147], a[196:199], v[20:23]
  s_waitcnt lgkmcnt(8)
  buffer_load_dwordx4 v[212:215], v164, s[92:95], s38 offen offset:1024 sc1
  v_mfma_f32_16x16x32_bf16 v[24:27], a[148:151], a[192:195], v[24:27]
  ds_read_b64_tr_b16 a[144:145], v154 offset:24576
  ds_read_b64_tr_b16 a[146:147], v154 offset:26624
  v_mfma_f32_16x16x32_bf16 v[28:31], a[148:151], a[196:199], v[28:31]
  s_waitcnt lgkmcnt(8)
  v_mfma_f32_16x16x32_bf16 v[32:35], a[152:155], a[192:195], v[32:35]
  ds_read_b64_tr_b16 a[148:149], v157 offset:24576
  ds_read_b64_tr_b16 a[150:151], v157 offset:26624
  v_mfma_f32_16x16x32_bf16 v[36:39], a[152:155], a[196:199], v[36:39]
  s_waitcnt lgkmcnt(8)
  buffer_load_dwordx4 v146, s[8:11], s20 offen offset:2048 lds
  v_mfma_f32_16x16x32_bf16 v[40:43], a[156:159], a[192:195], v[40:43]
  ds_read_b64_tr_b16 a[152:153], v160 offset:24576
  ds_read_b64_tr_b16 a[154:155], v160 offset:26624
  v_mfma_f32_16x16x32_bf16 v[44:47], a[156:159], a[196:199], v[44:47]
  s_waitcnt lgkmcnt(8)
  v_mfma_f32_16x16x32_bf16 v[48:51], a[160:163], a[192:195], v[48:51]
  ds_read_b64_tr_b16 a[156:157], v163 offset:24576
  ds_read_b64_tr_b16 a[158:159], v163 offset:26624
  v_mfma_f32_16x16x32_bf16 v[52:55], a[160:163], a[196:199], v[52:55]
  s_waitcnt lgkmcnt(8)
  buffer_load_dwordx4 v[216:219], v164, s[92:95], s38 offen offset:2048 sc1
  v_mfma_f32_16x16x32_bf16 v[56:59], a[164:167], a[192:195], v[56:59]
  ds_read_b64_tr_b16 a[160:161], v154 offset:28672
  ds_read_b64_tr_b16 a[162:163], v154 offset:30720
  v_mfma_f32_16x16x32_bf16 v[60:63], a[164:167], a[196:199], v[60:63]
  s_waitcnt lgkmcnt(8)
  v_mfma_f32_16x16x32_bf16 v[0:3], a[144:147], a[200:203], v[0:3]
  ds_read_b64_tr_b16 a[164:165], v157 offset:28672
  ds_read_b64_tr_b16 a[166:167], v157 offset:30720
  v_mfma_f32_16x16x32_bf16 v[4:7], a[144:147], a[204:207], v[4:7]
  s_waitcnt lgkmcnt(8)
  buffer_load_dwordx4 v147, s[8:11], s20 offen offset:3072 lds
  v_mfma_f32_16x16x32_bf16 v[8:11], a[148:151], a[200:203], v[8:11]
  ds_read_b64_tr_b16 a[144:145], v160 offset:28672
  ds_read_b64_tr_b16 a[146:147], v160 offset:30720
  v_mfma_f32_16x16x32_bf16 v[12:15], a[148:151], a[204:207], v[12:15]
  s_waitcnt lgkmcnt(8)
  s_waitcnt vmcnt(16)
  s_add_u32 s20, s20, s27
  s_add_u32 m0, s21, 65536
  v_mfma_f32_16x16x32_bf16 v[16:19], a[152:155], a[200:203], v[16:19]
  ds_read_b64_tr_b16 a[148:149], v163 offset:28672
  ds_read_b64_tr_b16 a[150:151], v163 offset:30720
  v_mfma_f32_16x16x32_bf16 v[20:23], a[152:155], a[204:207], v[20:23]
  s_waitcnt lgkmcnt(8)
  buffer_load_dwordx4 v[220:223], v164, s[92:95], s38 offen offset:3072 sc1
  v_mfma_f32_16x16x32_bf16 v[24:27], a[156:159], a[200:203], v[24:27]
  ds_read_b64_tr_b16 a[152:153], v154 offset:32768
  ds_read_b64_tr_b16 a[154:155], v154 offset:34816
  v_mfma_f32_16x16x32_bf16 v[28:31], a[156:159], a[204:207], v[28:31]
  s_waitcnt lgkmcnt(8)
  s_add_u32 s38, s38, 16384
  v_min3_u32 v172, v172, v173, v174
  v_mfma_f32_16x16x32_bf16 v[32:35], a[160:163], a[200:203], v[32:35]
  ds_read_b64_tr_b16 a[156:157], v157 offset:32768
  ds_read_b64_tr_b16 a[158:159], v157 offset:34816
  v_mfma_f32_16x16x32_bf16 v[36:39], a[160:163], a[204:207], v[36:39]
  s_waitcnt lgkmcnt(8)
  buffer_load_dwordx4 v144, s[8:11], s20 offen offset:0 lds
  v_mfma_f32_16x16x32_bf16 v[40:43], a[164:167], a[200:203], v[40:43]
  ds_read_b64_tr_b16 a[160:161], v160 offset:32768
  ds_read_b64_tr_b16 a[162:163], v160 offset:34816
  v_mfma_f32_16x16x32_bf16 v[44:47], a[164:167], a[204:207], v[44:47]
  s_waitcnt lgkmcnt(8)
  v_min_u32 v172, v172, v175
  v_lshlrev_b32 v173, 16, v172
  v_mfma_f32_16x16x32_bf16 v[48:51], a[144:147], a[200:203], v[48:51]
  ds_read_b64_tr_b16 a[164:165], v163 offset:32768
  ds_read_b64_tr_b16 a[166:167], v163 offset:34816
  v_mfma_f32_16x16x32_bf16 v[52:55], a[144:147], a[204:207], v[52:55]
  s_waitcnt lgkmcnt(8)
  s_nop 0
  v_readfirstlane_b32 s36, v173
  v_mfma_f32_16x16x32_bf16 v[56:59], a[148:151], a[200:203], v[56:59]
  ds_read_b64_tr_b16 a[144:145], v154 offset:36864
  ds_read_b64_tr_b16 a[146:147], v154 offset:38912
  v_mfma_f32_16x16x32_bf16 v[60:63], a[148:151], a[204:207], v[60:63]
  s_waitcnt vmcnt(40) lgkmcnt(8)
  v_mfma_f32_16x16x32_bf16 v[0:3], a[152:155], a[208:211], v[0:3]
  ds_read_b64_tr_b16 a[148:149], v157 offset:36864
  ds_read_b64_tr_b16 a[150:151], v157 offset:38912
  v_mfma_f32_16x16x32_bf16 v[4:7], a[152:155], a[212:215], v[4:7]
  s_waitcnt lgkmcnt(8)
  buffer_load_dwordx4 v145, s[8:11], s20 offen offset:1024 lds
  v_mfma_f32_16x16x32_bf16 v[8:11], a[156:159], a[208:211], v[8:11]
  ds_read_b64_tr_b16 a[152:153], v160 offset:36864
  ds_read_b64_tr_b16 a[154:155], v160 offset:38912
  v_mfma_f32_16x16x32_bf16 v[12:15], a[156:159], a[212:215], v[12:15]
  s_waitcnt lgkmcnt(8)
  s_cmp_lt_u32 s38, s36
  s_cbranch_scc0 K3_slow_four16
K3_back_four16:
  v_mfma_f32_16x16x32_bf16 v[16:19], a[160:163], a[208:211], v[16:19]
  ds_read_b64_tr_b16 a[156:157], v163 offset:36864
  ds_read_b64_tr_b16 a[158:159], v163 offset:38912
  v_mfma_f32_16x16x32_bf16 v[20:23], a[160:163], a[212:215], v[20:23]
  s_waitcnt lgkmcnt(8)
  buffer_load_dwordx4 v[224:227], v164, s[92:95], s38 offen offset:0 sc1
  v_mfma_f32_16x16x32_bf16 v[24:27], a[164:167], a[208:211], v[24:27]
  ds_read_b64_tr_b16 a[160:161], v154 offset:40960
  ds_read_b64_tr_b16 a[162:163], v154 offset:43008
  v_mfma_f32_16x16x32_bf16 v[28:31], a[164:167], a[212:215], v[28:31]
  s_waitcnt lgkmcnt(8)
  v_mfma_f32_16x16x32_bf16 v[32:35], a[144:147], a[208:211], v[32:35]
  ds_read_b64_tr_b16 a[164:165], v157 offset:40960
  ds_read_b64_tr_b16 a[166:167], v157 offset:43008
  v_mfma_f32_16x16x32_bf16 v[36:39], a[144:147], a[212:215], v[36:39]
  s_waitcnt lgkmcnt(8)
  buffer_load_dwordx4 v146, s[8:11], s20 offen offset:2048 lds
  v_mfma_f32_16x16x32_bf16 v[40:43], a[148:151], a[208:211], v[40:43]
  ds_read_b64_tr_b16 a[144:145], v160 offset:40960
  ds_read_b64_tr_b16 a[146:147], v160 offset:43008
  v_mfma_f32_16x16x32_bf16 v[44:47], a[148:151], a[212:215], v[44:47]
  s_waitcnt lgkmcnt(8)
  v_mfma_f32_16x16x32_bf16 v[48:51], a[152:155], a[208:211], v[48:51]
  ds_read_b64_tr_b16 a[148:149], v163 offset:40960
  ds_read_b64_tr_b16 a[150:151], v163 offset:43008
  v_mfma_f32_16x16x32_bf16 v[52:55], a[152:155], a[212:215], v[52:55]
  s_waitcnt lgkmcnt(8)
  buffer_load_dwordx4 v[228:231], v164, s[92:95], s38 offen offset:1024 sc1
  v_mfma_f32_16x16x32_bf16 v[56:59], a[156:159], a[208:211], v[56:59]
  ds_read_b64_tr_b16 a[152:153], v154 offset:45056
  ds_read_b64_tr_b16 a[154:155], v154 offset:47104
  v_mfma_f32_16x16x32_bf16 v[60:63], a[156:159], a[212:215], v[60:63]
  s_waitcnt lgkmcnt(8)
  v_mfma_f32_16x16x32_bf16 v[0:3], a[160:163], a[216:219], v[0:3]
  ds_read_b64_tr_b16 a[156:157], v157 offset:45056
  ds_read_b64_tr_b16 a[158:159], v157 offset:47104
  v_mfma_f32_16x16x32_bf16 v[4:7], a[160:163], a[220:223], v[4:7]
  s_waitcnt lgkmcnt(8)
  buffer_load_dwordx4 v147, s[8:11], s20 offen offset:3072 lds
  v_mfma_f32_16x16x32_bf16 v[8:11], a[164:167], a[216:219], v[8:11]
  ds_read_b64_tr_b16 a[160:161], v160 offset:45056
  ds_read_b64_tr_b16 a[162:163], v160 offset:47104
  v_mfma_f32_16x16x32_bf16 v[12:15], a[164:167], a[220:223], v[12:15]
  s_waitcnt lgkmcnt(8)
  s_add_u32 s20, s20, s27
  s_add_u32 m0, s21, 81920
  v_mfma_f32_16x16x32_bf16 v[16:19], a[144:147], a[216:219], v[16:19]
  ds_read_b64_tr_b16 a[164:165], v163 offset:45056
  ds_read_b64_tr_b16 a[166:167], v163 offset:47104
  v_mfma_f32_16x16x32_bf16 v[20:23], a[144:147], a[220:223], v[20:23]
  s_waitcnt vmcnt(14) lgkmcnt(8)
  s_barrier
  v_mfma_f32_16x16x32_bf16 v[24:27], a[148:151], a[216:219], v[24:27]
  ds_read_b64_tr_b16 a[144:145], v152 offset:0
  ds_read_b64_tr_b16 a[146:147], v152 offset:2048
  v_mfma_f32_16x16x32_bf16 v[28:31], a[148:151], a[220:223], v[28:31]
  s_waitcnt lgkmcnt(8)
  v_mfma_f32_16x16x32_bf16 v[32:35], a[152:155], a[216:219], v[32:35]
  ds_read_b64_tr_b16 a[148:149], v155 offset:0
  ds_read_b64_tr_b16 a[150:151], v155 offset:2048
  v_mfma_f32_16x16x32_bf16 v[36:39], a[152:155], a[220:223], v[36:39]
  s_waitcnt lgkmcnt(8)
  buffer_load_dwordx4 v144, s[8:11], s20 offen offset:0 lds
  v_mfma_f32_16x16x32_bf16 v[40:43], a[156:159], a[216:219], v[40:43]
  ds_read_b64_tr_b16 a[152:153], v158 offset:0
  ds_read_b64_tr_b16 a[154:155], v158 offset:2048
  v_mfma_f32_16x16x32_bf16 v[44:47], a[156:159], a[220:223], v[44:47]
  s_waitcnt lgkmcnt(8)
  v_mfma_f32_16x16x32_bf16 v[48:51], a[160:163], a[216:219], v[48:51]
  ds_read_b64_tr_b16 a[156:157], v161 offset:0
  ds_read_b64_tr_b16 a[158:159], v161 offset:2048
  v_mfma_f32_16x16x32_bf16 v[52:55], a[160:163], a[220:223], v[52:55]
  s_waitcnt lgkmcnt(8)
  buffer_load_dwordx4 v[232:235], v164, s[92:95], s38 offen offset:2048 sc1
  v_mfma_f32_16x16x32_bf16 v[56:59], a[164:167], a[216:219], v[56:59]
  ds_read_b64_tr_b16 a[160:161], v152 offset:4096
  ds_read_b64_tr_b16 a[162:163], v152 offset:6144
  v_mfma_f32_16x16x32_bf16 v[60:63], a[164:167], a[220:223], v[60:63]
  s_waitcnt vmcnt(37) lgkmcnt(8)
  v_mfma_f32_16x16x32_bf16 v[0:3], a[144:147], a[224:227], v[0:3]
  ds_read_b64_tr_b16 a[164:165], v155 offset:4096
  ds_read_b64_tr_b16 a[166:167], v155 offset:6144
  v_mfma_f32_16x16x32_bf16 v[4:7], a[144:147], a[228:231], v[4:7]
  s_waitcnt lgkmcnt(8)
  buffer_load_dwordx4 v145, s[8:11], s20 offen offset:1024 lds
  v_mfma_f32_16x16x32_bf16 v[8:11], a[148:151], a[224:227], v[8:11]
  ds_read_b64_tr_b16 a[144:145], v158 offset:4096
  ds_read_b64_tr_b16 a[146:147], v158 offset:6144
  v_mfma_f32_16x16x32_bf16 v[12:15], a[148:151], a[228:231], v[12:15]
  s_waitcnt lgkmcnt(8)
  v_mfma_f32_16x16x32_bf16 v[16:19], a[152:155], a[224:227], v[16:19]
  ds_read_b64_tr_b16 a[148:149], v161 offset:4096
  ds_read_b64_tr_b16 a[150:151], v161 offset:6144
  v_mfma_f32_16x16x32_bf16 v[20:23], a[152:155], a[228:231], v[20:23]
  s_waitcnt lgkmcnt(8)
  buffer_load_dwordx4 v[236:239], v164, s[92:95], s38 offen offset:3072 sc1
  v_mfma_f32_16x16x32_bf16 v[24:27], a[156:159], a[224:227], v[24:27]
  ds_read_b64_tr_b16 a[152:153], v152 offset:8192
  ds_read_b64_tr_b16 a[154:155], v152 offset:10240
  v_mfma_f32_16x16x32_bf16 v[28:31], a[156:159], a[228:231], v[28:31]
  s_waitcnt lgkmcnt(8)
  s_add_u32 s38, s38, 16384
  v_mfma_f32_16x16x32_bf16 v[32:35], a[160:163], a[224:227], v[32:35]
  ds_read_b64_tr_b16 a[156:157], v155 offset:8192
  ds_read_b64_tr_b16 a[158:159], v155 offset:10240
  v_mfma_f32_16x16x32_bf16 v[36:39], a[160:163], a[228:231], v[36:39]
  s_waitcnt lgkmcnt(8)
  buffer_load_dwordx4 v146, s[8:11], s20 offen offset:2048 lds
  v_mfma_f32_16x16x32_bf16 v[40:43], a[164:167], a[224:227], v[40:43]
  ds_read_b64_tr_b16 a[160:161], v158 offset:8192
  ds_read_b64_tr_b16 a[162:163], v158 offset:10240
  v_mfma_f32_16x16x32_bf16 v[44:47], a[164:167], a[228:231], v[44:47]
  s_waitcnt lgkmcnt(8)
  v_mfma_f32_16x16x32_bf16 v[48:51], a[144:147], a[224:227], v[48:51]
  ds_read_b64_tr_b16 a[164:165], v161 offset:8192
  ds_read_b64_tr_b16 a[166:167], v161 offset:10240
  v_mfma_f32_16x16x32_bf16 v[52:55], a[144:147], a[228:231], v[52:55]
  s_waitcnt lgkmcnt(8)
  v_mfma_f32_16x16x32_bf16 v[56:59], a[148:151], a[224:227], v[56:59]
  ds_read_b64_tr_b16 a[144:145], v152 offset:12288
  ds_read_b64_tr_b16 a[146:147], v152 offset:14336
  v_mfma_f32_16x16x32_bf16 v[60:63], a[148:151], a[228:231], v[60:63]
  s_waitcnt lgkmcnt(8)
  v_mfma_f32_16x16x32_bf16 v[0:3], a[152:155], a[232:235], v[0:3]
  ds_read_b64_tr_b16 a[148:149], v155 offset:12288
  ds_read_b64_tr_b16 a[150:151], v155 offset:14336
  v_mfma_f32_16x16x32_bf16 v[4:7], a[152:155], a[236:239], v[4:7]
  s_waitcnt lgkmcnt(8)
  buffer_load_dwordx4 v147, s[8:11], s20 offen offset:3072 lds
  v_mfma_f32_16x16x32_bf16 v[8:11], a[156:159], a[232:235], v[8:11]
  ds_read_b64_tr_b16 a[152:153], v158 offset:12288
  ds_read_b64_tr_b16 a[154:155], v158 offset:14336
  v_mfma_f32_16x16x32_bf16 v[12:15], a[156:159], a[236:239], v[12:15]
  s_waitcnt lgkmcnt(8)
  s_add_u32 s20, s20, s27
  s_add_u32 m0, s21, 98304
  v_mfma_f32_16x16x32_bf16 v[16:19], a[160:163], a[232:235], v[16:19]
  ds_read_b64_tr_b16 a[156:157], v161 offset:12288
  ds_read_b64_tr_b16 a[158:159], v161 offset:14336
  v_mfma_f32_16x16x32_bf16 v[20:23], a[160:163], a[236:239], v[20:23]
  s_waitcnt lgkmcnt(8)
  buffer_load_dwordx4 v[240:243], v164, s[92:95], s38 offen offset:0 sc1
  v_mfma_f32_16x16x32_bf16 v[24:27], a[164:167], a[232:235], v[24:27]
  ds_read_b64_tr_b16 a[160:161], v152 offset:16384
  ds_read_b64_tr_b16 a[162:163], v152 offset:18432
  v_mfma_f32_16x16x32_bf16 v[28:31], a[164:167], a[236:239], v[28:31]
  s_waitcnt lgkmcnt(8)
  v_mfma_f32_16x16x32_bf16 v[32:35], a[144:147], a[232:235], v[32:35]
  ds_read_b64_tr_b16 a[164:165], v155 offset:16384
  ds_read_b64_tr_b16 a[166:167], v155 offset:18432
  v_mfma_f32_16x16x32_bf16 v[36:39], a[144:147], a[236:239], v[36:39]
  s_waitcnt lgkmcnt(8)
  v_mfma_f32_16x16x32_bf16 v[40:43], a[148:151], a[232:235], v[40:43]
  ds_read_b64_tr_b16 a[144:145], v158 offset:16384
  ds_read_b64_tr_b16 a[146:147], v158 offset:18432
  v_mfma_f32_16x16x32_bf16 v[44:47], a[148:151], a[236:239], v[44:47]
  s_waitcnt lgkmcnt(8)
  v_mfma_f32_16x16x32_bf16 v[48:51], a[152:155], a[232:235], v[48:51]
  ds_read_b64_tr_b16 a[148:149], v161 offset:16384
  ds_read_b64_tr_b16 a[150:151], v161 offset:18432
  v_mfma_f32_16x16x32_bf16 v[52:55], a[152:155], a[236:239], v[52:55]
  s_waitcnt lgkmcnt(8)
  buffer_load_dwordx4 v[244:247], v164, s[92:95], s38 offen offset:1024 sc1
  v_mfma_f32_16x16x32_bf16 v[56:59], a[156:159], a[232:235], v[56:59]
  ds_read_b64_tr_b16 a[152:153], v152 offset:20480
  ds_read_b64_tr_b16 a[154:155], v152 offset:22528
  v_mfma_f32_16x16x32_bf16 v[60:63], a[156:159], a[236:239], v[60:63]
  s_waitcnt vmcnt(34) lgkmcnt(8)
  v_mfma_f32_16x16x32_bf16 v[0:3], a[160:163], a[240:243], v[0:3]
  ds_read_b64_tr_b16 a[156:157], v155 offset:20480
  ds_read_b64_tr_b16 a[158:159], v155 offset:22528
  v_mfma_f32_16x16x32_bf16 v[4:7], a[160:163], a[244:247], v[4:7]
  s_waitcnt lgkmcnt(8)
  v_mfma_f32_16x16x32_bf16 v[8:11], a[164:167], a[240:243], v[8:11]
  ds_read_b64_tr_b16 a[160:161], v158 offset:20480
  ds_read_b64_tr_b16 a[162:163], v158 offset:22528
  v_mfma_f32_16x16x32_bf16 v[12:15], a[164:167], a[244:247], v[12:15]
  s_waitcnt lgkmcnt(8)
  v_mfma_f32_16x16x32_bf16 v[16:19], a[144:147], a[240:243], v[16:19]
  ds_read_b64_tr_b16 a[164:165], v161 offset:20480
  ds_read_b64_tr_b16 a[166:167], v161 offset:22528
  v_mfma_f32_16x16x32_bf16 v[20:23], a[144:147], a[244:247], v[20:23]
  s_waitcnt lgkmcnt(8)
  buffer_load_dwordx4 v[248:251], v164, s[92:95], s38 offen offset:2048 sc1
  v_mfma_f32_16x16x32_bf16 v[24:27], a[148:151], a[240:243], v[24:27]
  ds_read_b64_tr_b16 a[144:145], v152 offset:24576
  ds_read_b64_tr_b16 a[146:147], v152 offset:26624
  v_mfma_f32_16x16x32_bf16 v[28:31], a[148:151], a[244:247], v[28:31]
  s_waitcnt lgkmcnt(8)
  v_mfma_f32_16x16x32_bf16 v[32:35], a[152:155], a[240:243], v[32:35]
  ds_read_b64_tr_b16 a[148:149], v155 offset:24576
  ds_read_b64_tr_b16 a[150:151], v155 offset:26624
  v_mfma_f32_16x16x32_bf16 v[36:39], a[152:155], a[244:247], v[36:39]
  s_waitcnt lgkmcnt(8)
  v_mfma_f32_16x16x32_bf16 v[40:43], a[156:159], a[240:243], v[40:43]
  ds_read_b64_tr_b16 a[152:153], v158 offset:24576
  ds_read_b64_tr_b16 a[154:155], v158 offset:26624
  v_mfma_f32_16x16x32_bf16 v[44:47], a[156:159], a[244:247], v[44:47]
  s_waitcnt lgkmcnt(8)
  v_mfma_f32_16x16x32_bf16 v[48:51], a[160:163], a[240:243], v[48:51]
  ds_read_b64_tr_b16 a[156:157], v161 offset:24576
  ds_read_b64_tr_b16 a[158:159], v161 offset:26624
  v_mfma_f32_16x16x32_bf16 v[52:55], a[160:163], a[244:247], v[52:55]
  s_waitcnt lgkmcnt(8)
  buffer_load_dwordx4 v[252:255], v164, s[92:95], s38 offen offset:3072 sc1
  v_mfma_f32_16x16x32_bf16 v[56:59], a[164:167], a[240:243], v[56:59]
  ds_read_b64_tr_b16 a[160:161], v152 offset:28672
  ds_read_b64_tr_b16 a[162:163], v152 offset:30720
  v_mfma_f32_16x16x32_bf16 v[60:63], a[164:167], a[244:247], v[60:63]
  s_waitcnt lgkmcnt(8)
  s_add_u32 s38, s38, 16384
  v_mfma_f32_16x16x32_bf16 v[0:3], a[144:147], a[248:251], v[0:3]
  ds_read_b64_tr_b16 a[164:165], v155 offset:28672
  ds_read_b64_tr_b16 a[166:167], v155 offset:30720
  v_mfma_f32_16x16x32_bf16 v[4:7], a[144:147], a[252:255], v[4:7]
  s_waitcnt lgkmcnt(8)
  v_mfma_f32_16x16x32_bf16 v[8:11], a[148:151], a[248:251], v[8:11]
  ds_read_b64_tr_b16 a[144:145], v158 offset:28672
  ds_read_b64_tr_b16 a[146:147], v158 offset:30720
  v_mfma_f32_16x16x32_bf16 v[12:15], a[148:151], a[252:255], v[12:15]
  s_waitcnt lgkmcnt(8)
  v_mfma_f32_16x16x32_bf16 v[16:19], a[152:155], a[248:251], v[16:19]
  ds_read_b64_tr_b16 a[148:149], v161 offset:28672
  ds_read_b64_tr_b16 a[150:151], v161 offset:30720
  v_mfma_f32_16x16x32_bf16 v[20:23], a[152:155], a[252:255], v[20:23]
  s_waitcnt lgkmcnt(8)
  v_mfma_f32_16x16x32_bf16 v[24:27], a[156:159], a[248:251], v[24:27]
  ds_read_b64_tr_b16 a[152:153], v152 offset:32768
  ds_read_b64_tr_b16 a[154:155], v152 offset:34816
  v_mfma_f32_16x16x32_bf16 v[28:31], a[156:159], a[252:255], v[28:31]
  s_waitcnt lgkmcnt(8)
  v_mfma_f32_16x16x32_bf16 v[32:35], a[160:163], a[248:251], v[32:35]
  ds_read_b64_tr_b16 a[156:157], v155 offset:32768
  ds_read_b64_tr_b16 a[158:159], v155 offset:34816
  v_mfma_f32_16x16x32_bf16 v[36:39], a[160:163], a[252:255], v[36:39]
  s_waitcnt lgkmcnt(8)
  v_mfma_f32_16x16x32_bf16 v[40:43], a[164:167], a[248:251], v[40:43]
  ds_read_b64_tr_b16 a[160:161], v158 offset:32768
  ds_read_b64_tr_b16 a[162:163], v158 offset:34816
  v_mfma_f32_16x16x32_bf16 v[44:47], a[164:167], a[252:255], v[44:47]
  s_waitcnt lgkmcnt(8)
  v_mfma_f32_16x16x32_bf16 v[48:51], a[144:147], a[248:251], v[48:51]
  ds_read_b64_tr_b16 a[164:165], v161 offset:32768
  ds_read_b64_tr_b16 a[166:167], v161 offset:34816
  v_mfma_f32_16x16x32_bf16 v[52:55], a[144:147], a[252:255], v[52:55]
  s_waitcnt lgkmcnt(8)
  v_mfma_f32_16x16x32_bf16 v[56:59], a[148:151], a[248:251], v[56:59]
  ds_read_b64_tr_b16 a[144:145], v152 offset:36864
  ds_read_b64_tr_b16 a[146:147], v152 offset:38912
  v_mfma_f32_16x16x32_bf16 v[60:63], a[148:151], a[252:255], v[60:63]
  s_waitcnt vmcnt(25) lgkmcnt(8)
  v_mfma_f32_16x16x32_bf16 v[0:3], a[152:155], v[192:195], v[0:3]
  ds_read_b64_tr_b16 a[148:149], v155 offset:36864
  ds_read_b64_tr_b16 a[150:151], v155 offset:38912
  v_mfma_f32_16x16x32_bf16 v[4:7], a[152:155], v[196:199], v[4:7]
  s_waitcnt lgkmcnt(8)
  v_mfma_f32_16x16x32_bf16 v[8:11], a[156:159], v[192:195], v[8:11]
  ds_read_b64_tr_b16 a[152:153], v158 offset:36864
  ds_read_b64_tr_b16 a[154:155], v158 offset:38912
  v_mfma_f32_16x16x32_bf16 v[12:15], a[156:159], v[196:199], v[12:15]
  s_waitcnt lgkmcnt(8)
  v_mfma_f32_16x16x32_bf16 v[16:19], a[160:163], v[192:195], v[16:19]
  ds_read_b64_tr_b16 a[156:157], v161 offset:36864
  ds_read_b64_tr_b16 a[158:159], v161 offset:38912
  v_mfma_f32_16x16x32_bf16 v[20:23], a[160:163], v[196:199], v[20:23]
  s_waitcnt lgkmcnt(8)
  v_mfma_f32_16x16x32_bf16 v[24:27], a[164:167], v[192:195], v[24:27]
  ds_read_b64_tr_b16 a[160:161], v152 offset:40960
  ds_read_b64_tr_b16 a[162:163], v152 offset:43008
  v_mfma_f32_16x16x32_bf16 v[28:31], a[164:167], v[196:199], v[28:31]
  s_waitcnt lgkmcnt(8)
  v_mfma_f32_16x16x32_bf16 v[32:35], a[144:147], v[192:195], v[32:35]
  ds_read_b64_tr_b16 a[164:165], v155 offset:40960
  ds_read_b64_tr_b16 a[166:167], v155 offset:43008
  v_mfma_f32_16x16x32_bf16 v[36:39], a[144:147], v[196:199], v[36:39]
  s_waitcnt lgkmcnt(8)
  v_mfma_f32_16x16x32_bf16 v[40:43], a[148:151], v[192:195], v[40:43]
  ds_read_b64_tr_b16 a[144:145], v158 offset:40960
  ds_read_b64_tr_b16 a[146:147], v158 offset:43008
  v_mfma_f32_16x16x32_bf16 v[44:47], a[148:151], v[196:199], v[44:47]
  s_waitcnt lgkmcnt(8)
  v_mfma_f32_16x16x32_bf16 v[48:51], a[152:155], v[192:195], v[48:51]
  ds_read_b64_tr_b16 a[148:149], v161 offset:40960
  ds_read_b64_tr_b16 a[150:151], v161 offset:43008
  v_mfma_f32_16x16x32_bf16 v[52:55], a[152:155], v[196:199], v[52:55]
  s_waitcnt lgkmcnt(8)
  v_mfma_f32_16x16x32_bf16 v[56:59], a[156:159], v[192:195], v[56:59]
  ds_read_b64_tr_b16 a[152:153], v152 offset:45056
  ds_read_b64_tr_b16 a[154:155], v152 offset:47104
  v_mfma_f32_16x16x32_bf16 v[60:63], a[156:159], v[196:199], v[60:63]
  s_waitcnt lgkmcnt(8)
  v_mfma_f32_16x16x32_bf16 v[0:3], a[160:163], v[200:203], v[0:3]
  ds_read_b64_tr_b16 a[156:157], v155 offset:45056
  ds_read_b64_tr_b16 a[158:159], v155 offset:47104
  v_mfma_f32_16x16x32_bf16 v[4:7], a[160:163], v[204:207], v[4:7]
  s_waitcnt lgkmcnt(8)
  v_mfma_f32_16x16x32_bf16 v[8:11], a[164:167], v[200:203], v[8:11]
  ds_read_b64_tr_b16 a[160:161], v158 offset:45056
  ds_read_b64_tr_b16 a[162:163], v158 offset:47104
  v_mfma_f32_16x16x32_bf16 v[12:15], a[164:167], v[204:207], v[12:15]
  s_waitcnt lgkmcnt(8)
  v_mfma_f32_16x16x32_bf16 v[16:19], a[144:147], v[200:203], v[16:19]
  ds_read_b64_tr_b16 a[164:165], v161 offset:45056
  ds_read_b64_tr_b16 a[166:167], v161 offset:47104
  v_mfma_f32_16x16x32_bf16 v[20:23], a[144:147], v[204:207], v[20:23]
  s_waitcnt vmcnt(4) lgkmcnt(8)
  s_barrier
  v_mfma_f32_16x16x32_bf16 v[24:27], a[148:151], v[200:203], v[24:27]
  ds_read_b64_tr_b16 a[144:145], v153 offset:0
  ds_read_b64_tr_b16 a[146:147], v153 offset:2048
  v_mfma_f32_16x16x32_bf16 v[28:31], a[148:151], v[204:207], v[28:31]
  s_waitcnt lgkmcnt(8)
  v_mfma_f32_16x16x32_bf16 v[32:35], a[152:155], v[200:203], v[32:35]
  ds_read_b64_tr_b16 a[148:149], v156 offset:0
  ds_read_b64_tr_b16 a[150:151], v156 offset:2048
  v_mfma_f32_16x16x32_bf16 v[36:39], a[152:155], v[204:207], v[36:39]
  s_waitcnt lgkmcnt(8)
  v_mfma_f32_16x16x32_bf16 v[40:43], a[156:159], v[200:203], v[40:43]
  ds_read_b64_tr_b16 a[152:153], v159 offset:0
  ds_read_b64_tr_b16 a[154:155], v159 offset:2048
  v_mfma_f32_16x16x32_bf16 v[44:47], a[156:159], v[204:207], v[44:47]
  s_waitcnt lgkmcnt(8)
  v_mfma_f32_16x16x32_bf16 v[48:51], a[160:163], v[200:203], v[48:51]
  ds_read_b64_tr_b16 a[156:157], v162 offset:0
  ds_read_b64_tr_b16 a[158:159], v162 offset:2048
  v_mfma_f32_16x16x32_bf16 v[52:55], a[160:163], v[204:207], v[52:55]
  s_waitcnt lgkmcnt(8)
  v_mfma_f32_16x16x32_bf16 v[56:59], a[164:167], v[200:203], v[56:59]
  ds_read_b64_tr_b16 a[160:161], v153 offset:4096
  ds_read_b64_tr_b16 a[162:163], v153 offset:6144
  v_mfma_f32_16x16x32_bf16 v[60:63], a[164:167], v[204:207], v[60:63]
  s_waitcnt vmcnt(16) lgkmcnt(8)
  v_mfma_f32_16x16x32_bf16 v[0:3], a[144:147], v[208:211], v[0:3]
  ds_read_b64_tr_b16 a[164:165], v156 offset:4096
  ds_read_b64_tr_b16 a[166:167], v156 offset:6144
  v_mfma_f32_16x16x32_bf16 v[4:7], a[144:147], v[212:215], v[4:7]
  s_waitcnt lgkmcnt(8)
  v_mfma_f32_16x16x32_bf16 v[8:11], a[148:151], v[208:211], v[8:11]
  ds_read_b64_tr_b16 a[144:145], v159 offset:4096
  ds_read_b64_tr_b16 a[146:147], v159 offset:6144
  v_mfma_f32_16x16x32_bf16 v[12:15], a[148:151], v[212:215], v[12:15]
  s_waitcnt lgkmcnt(8)
  v_mfma_f32_16x16x32_bf16 v[16:19], a[152:155], v[208:211], v[16:19]
  ds_read_b64_tr_b16 a[148:149], v162 offset:4096
  ds_read_b64_tr_b16 a[150:151], v162 offset:6144
  v_mfma_f32_16x16x32_bf16 v[20:23], a[152:155], v[212:215], v[20:23]
  s_waitcnt lgkmcnt(8)
  v_mfma_f32_16x16x32_bf16 v[24:27], a[156:159], v[208:211], v[24:27]
  ds_read_b64_tr_b16 a[152:153], v153 offset:8192
  ds_read_b64_tr_b16 a[154:155], v153 offset:10240
  v_mfma_f32_16x16x32_bf16 v[28:31], a[156:159], v[212:215], v[28:31]
  s_waitcnt lgkmcnt(8)
  v_mfma_f32_16x16x32_bf16 v[32:35], a[160:163], v[208:211], v[32:35]
  ds_read_b64_tr_b16 a[156:157], v156 offset:8192
  ds_read_b64_tr_b16 a[158:159], v156 offset:10240
  v_mfma_f32_16x16x32_bf16 v[36:39], a[160:163], v[212:215], v[36:39]
  s_waitcnt lgkmcnt(8)
  v_mfma_f32_16x16x32_bf16 v[40:43], a[164:167], v[208:211], v[40:43]
  ds_read_b64_tr_b16 a[160:161], v159 offset:8192
  ds_read_b64_tr_b16 a[162:163], v159 offset:10240
  v_mfma_f32_16x16x32_bf16 v[44:47], a[164:167], v[212:215], v[44:47]
  s_waitcnt lgkmcnt(8)
  v_mfma_f32_16x16x32_bf16 v[48:51], a[144:147], v[208:211], v[48:51]
  ds_read_b64_tr_b16 a[164:165], v162 offset:8192
  ds_read_b64_tr_b16 a[166:167], v162 offset:10240
  v_mfma_f32_16x16x32_bf16 v[52:55], a[144:147], v[212:215], v[52:55]
  s_waitcnt lgkmcnt(8)
  v_mfma_f32_16x16x32_bf16 v[56:59], a[148:151], v[208:211], v[56:59]
  ds_read_b64_tr_b16 a[144:145], v153 offset:12288
  ds_read_b64_tr_b16 a[146:147], v153 offset:14336
  v_mfma_f32_16x16x32_bf16 v[60:63], a[148:151], v[212:215], v[60:63]
  s_waitcnt lgkmcnt(8)
  v_mfma_f32_16x16x32_bf16 v[0:3], a[152:155], v[216:219], v[0:3]
  ds_read_b64_tr_b16 a[148:149], v156 offset:12288
  ds_read_b64_tr_b16 a[150:151], v156 offset:14336
  v_mfma_f32_16x16x32_bf16 v[4:7], a[152:155], v[220:223], v[4:7]
  s_waitcnt lgkmcnt(8)
  v_mfma_f32_16x16x32_bf16 v[8:11], a[156:159], v[216:219], v[8:11]
  ds_read_b64_tr_b16 a[152:153], v159 offset:12288
  ds_read_b64_tr_b16 a[154:155], v159 offset:14336
  v_mfma_f32_16x16x32_bf16 v[12:15], a[156:159], v[220:223], v[12:15]
  s_waitcnt lgkmcnt(8)
  v_mfma_f32_16x16x32_bf16 v[16:19], a[160:163], v[216:219], v[16:19]
  ds_read_b64_tr_b16 a[156:157], v162 offset:12288
  ds_read_b64_tr_b16 a[158:159], v162 offset:14336
  v_mfma_f32_16x16x32_bf16 v[20:23], a[160:163], v[220:223], v[20:23]
  s_waitcnt lgkmcnt(8)
  v_mfma_f32_16x16x32_bf16 v[24:27], a[164:167], v[216:219], v[24:27]
  ds_read_b64_tr_b16 a[160:161], v153 offset:16384
  ds_read_b64_tr_b16 a[162:163], v153 offset:18432
  v_mfma_f32_16x16x32_bf16 v[28:31], a[164:167], v[220:223], v[28:31]
  s_waitcnt lgkmcnt(8)
  v_mfma_f32_16x16x32_bf16 v[32:35], a[144:147], v[216:219], v[32:35]
  ds_read_b64_tr_b16 a[164:165], v156 offset:16384
  ds_read_b64_tr_b16 a[166:167], v156 offset:18432
  v_mfma_f32_16x16x32_bf16 v[36:39], a[144:147], v[220:223], v[36:39]
  s_waitcnt lgkmcnt(8)
  v_mfma_f32_16x16x32_bf16 v[40:43], a[148:151], v[216:219], v[40:43]
  ds_read_b64_tr_b16 a[144:145], v159 offset:16384
  ds_read_b64_tr_b16 a[146:147], v159 offset:18432
  v_mfma_f32_16x16x32_bf16 v[44:47], a[148:151], v[220:223], v[44:47]
  s_waitcnt lgkmcnt(8)
  v_mfma_f32_16x16x32_bf16 v[48:51], a[152:155], v[216:219], v[48:51]
  ds_read_b64_tr_b16 a[148:149], v162 offset:16384
  ds_read_b64_tr_b16 a[150:151], v162 offset:18432
  v_mfma_f32_16x16x32_bf16 v[52:55], a[152:155], v[220:223], v[52:55]
  s_waitcnt lgkmcnt(8)
  v_mfma_f32_16x16x32_bf16 v[56:59], a[156:159], v[216:219], v[56:59]
  ds_read_b64_tr_b16 a[152:153], v153 offset:20480
  ds_read_b64_tr_b16 a[154:155], v153 offset:22528
  v_mfma_f32_16x16x32_bf16 v[60:63], a[156:159], v[220:223], v[60:63]
  s_waitcnt vmcnt(6) lgkmcnt(8)
  v_mfma_f32_16x16x32_bf16 v[0:3], a[160:163], v[224:227], v[0:3]
  ds_read_b64_tr_b16 a[156:157], v156 offset:20480
  ds_read_b64_tr_b16 a[158:159], v156 offset:22528
  v_mfma_f32_16x16x32_bf16 v[4:7], a[160:163], v[228:231], v[4:7]
  s_waitcnt lgkmcnt(8)
  v_mfma_f32_16x16x32_bf16 v[8:11], a[164:167], v[224:227], v[8:11]
  ds_read_b64_tr_b16 a[160:161], v159 offset:20480
  ds_read_b64_tr_b16 a[162:163], v159 offset:22528
  v_mfma_f32_16x16x32_bf16 v[12:15], a[164:167], v[228:231], v[12:15]
  s_waitcnt lgkmcnt(8)
  v_mfma_f32_16x16x32_bf16 v[16:19], a[144:147], v[224:227], v[16:19]
  ds_read_b64_tr_b16 a[164:165], v162 offset:20480
  ds_read_b64_tr_b16 a[166:167], v162 offset:22528
  v_mfma_f32_16x16x32_bf16 v[20:23], a[144:147], v[228:231], v[20:23]
  s_waitcnt lgkmcnt(8)
  v_mfma_f32_16x16x32_bf16 v[24:27], a[148:151], v[224:227], v[24:27]
  ds_read_b64_tr_b16 a[144:145], v153 offset:24576
  ds_read_b64_tr_b16 a[146:147], v153 offset:26624
  v_mfma_f32_16x16x32_bf16 v[28:31], a[148:151], v[228:231], v[28:31]
  s_waitcnt lgkmcnt(8)
  v_mfma_f32_16x16x32_bf16 v[32:35], a[152:155], v[224:227], v[32:35]
  ds_read_b64_tr_b16 a[148:149], v156 offset:24576
  ds_read_b64_tr_b16 a[150:151], v156 offset:26624
  v_mfma_f32_16x16x32_bf16 v[36:39], a[152:155], v[228:231], v[36:39]
  s_waitcnt lgkmcnt(8)
  v_mfma_f32_16x16x32_bf16 v[40:43], a[156:159], v[224:227], v[40:43]
  ds_read_b64_tr_b16 a[152:153], v159 offset:24576
  ds_read_b64_tr_b16 a[154:155], v159 offset:26624
  v_mfma_f32_16x16x32_bf16 v[44:47], a[156:159], v[228:231], v[44:47]
  s_waitcnt lgkmcnt(8)
  v_mfma_f32_16x16x32_bf16 v[48:51], a[160:163], v[224:227], v[48:51]
  ds_read_b64_tr_b16 a[156:157], v162 offset:24576
  ds_read_b64_tr_b16 a[158:159], v162 offset:26624
  v_mfma_f32_16x16x32_bf16 v[52:55], a[160:163], v[228:231], v[52:55]
  s_waitcnt lgkmcnt(8)
  v_mfma_f32_16x16x32_bf16 v[56:59], a[164:167], v[224:227], v[56:59]
  ds_read_b64_tr_b16 a[160:161], v153 offset:28672
  ds_read_b64_tr_b16 a[162:163], v153 offset:30720
  v_mfma_f32_16x16x32_bf16 v[60:63], a[164:167], v[228:231], v[60:63]
  s_waitcnt lgkmcnt(8)
  v_mfma_f32_16x16x32_bf16 v[0:3], a[144:147], v[232:235], v[0:3]
  ds_read_b64_tr_b16 a[164:165], v156 offset:28672
  ds_read_b64_tr_b16 a[166:167], v156 offset:30720
  v_mfma_f32_16x16x32_bf16 v[4:7], a[144:147], v[236:239], v[4:7]
  s_waitcnt lgkmcnt(8)
  v_mfma_f32_16x16x32_bf16 v[8:11], a[148:151], v[232:235], v[8:11]
  ds_read_b64_tr_b16 a[144:145], v159 offset:28672
  ds_read_b64_tr_b16 a[146:147], v159 offset:30720
  v_mfma_f32_16x16x32_bf16 v[12:15], a[148:151], v[236:239], v[12:15]
  s_waitcnt lgkmcnt(8)
  v_mfma_f32_16x16x32_bf16 v[16:19], a[152:155], v[232:235], v[16:19]
  ds_read_b64_tr_b16 a[148:149], v162 offset:28672
  ds_read_b64_tr_b16 a[150:151], v162 offset:30720
  v_mfma_f32_16x16x32_bf16 v[20:23], a[152:155], v[236:239], v[20:23]
  s_waitcnt lgkmcnt(8)
  v_mfma_f32_16x16x32_bf16 v[24:27], a[156:159], v[232:235], v[24:27]
  ds_read_b64_tr_b16 a[152:153], v153 offset:32768
  ds_read_b64_tr_b16 a[154:155], v153 offset:34816
  v_mfma_f32_16x16x32_bf16 v[28:31], a[156:159], v[236:239], v[28:31]
  s_waitcnt lgkmcnt(8)
  v_mfma_f32_16x16x32_bf16 v[32:35], a[160:163], v[232:235], v[32:35]
  ds_read_b64_tr_b16 a[156:157], v156 offset:32768
  ds_read_b64_tr_b16 a[158:159], v156 offset:34816
  v_mfma_f32_16x16x32_bf16 v[36:39], a[160:163], v[236:239], v[36:39]
  s_waitcnt lgkmcnt(8)
  v_mfma_f32_16x16x32_bf16 v[40:43], a[164:167], v[232:235], v[40:43]
  ds_read_b64_tr_b16 a[160:161], v159 offset:32768
  ds_read_b64_tr_b16 a[162:163], v159 offset:34816
  v_mfma_f32_16x16x32_bf16 v[44:47], a[164:167], v[236:239], v[44:47]
  s_waitcnt lgkmcnt(8)
  v_mfma_f32_16x16x32_bf16 v[48:51], a[144:147], v[232:235], v[48:51]
  ds_read_b64_tr_b16 a[164:165], v162 offset:32768
  ds_read_b64_tr_b16 a[166:167], v162 offset:34816
  v_mfma_f32_16x16x32_bf16 v[52:55], a[144:147], v[236:239], v[52:55]
  s_waitcnt lgkmcnt(8)
  v_mfma_f32_16x16x32_bf16 v[56:59], a[148:151], v[232:235], v[56:59]
  ds_read_b64_tr_b16 a[144:145], v153 offset:36864
  ds_read_b64_tr_b16 a[146:147], v153 offset:38912
  v_mfma_f32_16x16x32_bf16 v[60:63], a[148:151], v[236:239], v[60:63]
  s_waitcnt vmcnt(0) lgkmcnt(8)
  v_mfma_f32_16x16x32_bf16 v[0:3], a[152:155], v[240:243], v[0:3]
  ds_read_b64_tr_b16 a[148:149], v156 offset:36864
  ds_read_b64_tr_b16 a[150:151], v156 offset:38912
  v_mfma_f32_16x16x32_bf16 v[4:7], a[152:155], v[244:247], v[4:7]
  s_waitcnt lgkmcnt(8)
  v_mfma_f32_16x16x32_bf16 v[8:11], a[156:159], v[240:243], v[8:11]
  ds_read_b64_tr_b16 a[152:153], v159 offset:36864
  ds_read_b64_tr_b16 a[154:155], v159 offset:38912
  v_mfma_f32_16x16x32_bf16 v[12:15], a[156:159], v[244:247], v[12:15]
  s_waitcnt lgkmcnt(8)
  v_mfma_f32_16x16x32_bf16 v[16:19], a[160:163], v[240:243], v[16:19]
  ds_read_b64_tr_b16 a[156:157], v162 offset:36864
  ds_read_b64_tr_b16 a[158:159], v162 offset:38912
  v_mfma_f32_16x16x32_bf16 v[20:23], a[160:163], v[244:247], v[20:23]
  s_waitcnt lgkmcnt(8)
  v_mfma_f32_16x16x32_bf16 v[24:27], a[164:167], v[240:243], v[24:27]
  ds_read_b64_tr_b16 a[160:161], v153 offset:40960
  ds_read_b64_tr_b16 a[162:163], v153 offset:43008
  v_mfma_f32_16x16x32_bf16 v[28:31], a[164:167], v[244:247], v[28:31]
  s_waitcnt lgkmcnt(8)
  v_mfma_f32_16x16x32_bf16 v[32:35], a[144:147], v[240:243], v[32:35]
  ds_read_b64_tr_b16 a[164:165], v156 offset:40960
  ds_read_b64_tr_b16 a[166:167], v156 offset:43008
  v_mfma_f32_16x16x32_bf16 v[36:39], a[144:147], v[244:247], v[36:39]
  s_waitcnt lgkmcnt(8)
  v_mfma_f32_16x16x32_bf16 v[40:43], a[148:151], v[240:243], v[40:43]
  ds_read_b64_tr_b16 a[144:145], v159 offset:40960
  ds_read_b64_tr_b16 a[146:147], v159 offset:43008
  v_mfma_f32_16x16x32_bf16 v[44:47], a[148:151], v[244:247], v[44:47]
  s_waitcnt lgkmcnt(8)
  v_mfma_f32_16x16x32_bf16 v[48:51], a[152:155], v[240:243], v[48:51]
  ds_read_b64_tr_b16 a[148:149], v162 offset:40960
  ds_read_b64_tr_b16 a[150:151], v162 offset:43008
  v_mfma_f32_16x16x32_bf16 v[52:55], a[152:155], v[244:247], v[52:55]
  s_waitcnt lgkmcnt(8)
  v_mfma_f32_16x16x32_bf16 v[56:59], a[156:159], v[240:243], v[56:59]
  ds_read_b64_tr_b16 a[152:153], v153 offset:45056
  ds_read_b64_tr_b16 a[154:155], v153 offset:47104
  v_mfma_f32_16x16x32_bf16 v[60:63], a[156:159], v[244:247], v[60:63]
  s_waitcnt lgkmcnt(8)
  v_mfma_f32_16x16x32_bf16 v[0:3], a[160:163], v[248:251], v[0:3]
  ds_read_b64_tr_b16 a[156:157], v156 offset:45056
  ds_read_b64_tr_b16 a[158:159], v156 offset:47104
  v_mfma_f32_16x16x32_bf16 v[4:7], a[160:163], v[252:255], v[4:7]
  s_waitcnt lgkmcnt(8)
  v_mfma_f32_16x16x32_bf16 v[8:11], a[164:167], v[248:251], v[8:11]
  ds_read_b64_tr_b16 a[160:161], v159 offset:45056
  ds_read_b64_tr_b16 a[162:163], v159 offset:47104
  v_mfma_f32_16x16x32_bf16 v[12:15], a[164:167], v[252:255], v[12:15]
  s_waitcnt lgkmcnt(8)
  v_mfma_f32_16x16x32_bf16 v[16:19], a[144:147], v[248:251], v[16:19]
  ds_read_b64_tr_b16 a[164:165], v162 offset:45056
  ds_read_b64_tr_b16 a[166:167], v162 offset:47104
  v_mfma_f32_16x16x32_bf16 v[20:23], a[144:147], v[252:255], v[20:23]
  s_waitcnt lgkmcnt(8)
  v_mfma_f32_16x16x32_bf16 v[24:27], a[148:151], v[248:251], v[24:27]
  v_mfma_f32_16x16x32_bf16 v[28:31], a[148:151], v[252:255], v[28:31]
  s_waitcnt lgkmcnt(6)
  v_mfma_f32_16x16x32_bf16 v[32:35], a[152:155], v[248:251], v[32:35]
  v_mfma_f32_16x16x32_bf16 v[36:39], a[152:155], v[252:255], v[36:39]
  s_waitcnt lgkmcnt(4)
  v_mfma_f32_16x16x32_bf16 v[40:43], a[156:159], v[248:251], v[40:43]
  v_mfma_f32_16x16x32_bf16 v[44:47], a[156:159], v[252:255], v[44:47]
  s_waitcnt lgkmcnt(2)
  v_mfma_f32_16x16x32_bf16 v[48:51], a[160:163], v[248:251], v[48:51]
  v_mfma_f32_16x16x32_bf16 v[52:55], a[160:163], v[252:255], v[52:55]
  s_waitcnt lgkmcnt(0)
  v_mfma_f32_16x16x32_bf16 v[56:59], a[164:167], v[248:251], v[56:59]
  v_mfma_f32_16x16x32_bf16 v[60:63], a[164:167], v[252:255], v[60:63]
  s_branch K3_final
  .p2align 6
K3_G2six:
  v_mfma_f32_16x16x32_bf16 v[0:3], a[144:147], a[176:179], v[0:3]
  ds_read_b64_tr_b16 a[164:165], v157 offset:4096
  ds_read_b64_tr_b16 a[166:167], v157 offset:6144
  v_mfma_f32_16x16x32_bf16 v[4:7], a[144:147], a[180:183], v[4:7]
  s_waitcnt lgkmcnt(8)
  buffer_load_dwordx4 v145, s[8:11], s20 offen offset:1024 lds
  v_mfma_f32_16x16x32_bf16 v[8:11], a[148:151], a[176:179], v[8:11]
  ds_read_b64_tr_b16 a[144:145], v160 offset:4096
  ds_read_b64_tr_b16 a[146:147], v160 offset:6144
  v_mfma_f32_16x16x32_bf16 v[12:15], a[148:151], a[180:183], v[12:15]
  s_waitcnt lgkmcnt(8)
  s_cmp_lt_u32 s38, s36
  s_cbranch_scc0 K3_slow_G2six0
K3_back_G2six0:
  v_mfma_f32_16x16x32_bf16 v[16:19], a[152:155], a[176:179], v[16:19]
  ds_read_b64_tr_b16 a[148:149], v163 offset:4096
  ds_read_b64_tr_b16 a[150:151], v163 offset:6144
  v_mfma_f32_16x16x32_bf16 v[20:23], a[152:155], a[180:183], v[20:23]
  s_waitcnt lgkmcnt(8)
  buffer_load_dwordx4 a[240:243], v164, s[92:95], s38 offen offset:0 sc1
  v_mfma_f32_16x16x32_bf16 v[24:27], a[156:159], a[176:179], v[24:27]
  ds_read_b64_tr_b16 a[152:153], v154 offset:8192
  ds_read_b64_tr_b16 a[154:155], v154 offset:10240
  v_mfma_f32_16x16x32_bf16 v[28:31], a[156:159], a[180:183], v[28:31]
  s_waitcnt lgkmcnt(8)
  v_mfma_f32_16x16x32_bf16 v[32:35], a[160:163], a[176:179], v[32:35]
  ds_read_b64_tr_b16 a[156:157], v157 offset:8192
  ds_read_b64_tr_b16 a[158:159], v157 offset:10240
  v_mfma_f32_16x16x32_bf16 v[36:39], a[160:163], a[180:183], v[36:39]
  s_waitcnt lgkmcnt(8)
  buffer_load_dwordx4 v146, s[8:11], s20 offen offset:2048 lds
  v_mfma_f32_16x16x32_bf16 v[40:43], a[164:167], a[176:179], v[40:43]
  ds_read_b64_tr_b16 a[160:161], v160 offset:8192
  ds_read_b64_tr_b16 a[162:163], v160 offset:10240
  v_mfma_f32_16x16x32_bf16 v[44:47], a[164:167], a[180:183], v[44:47]
  s_waitcnt lgkmcnt(8)
  buffer_load_dwordx4 a[244:247], v164, s[92:95], s38 offen offset:1024 sc1
  v_mfma_f32_16x16x32_bf16 v[48:51], a[144:147], a[176:179], v[48:51]
  ds_read_b64_tr_b16 a[164:165], v163 offset:8192
  ds_read_b64_tr_b16 a[166:167], v163 offset:10240
  v_mfma_f32_16x16x32_bf16 v[52:55], a[144:147], a[180:183], v[52:55]
  s_waitcnt lgkmcnt(8)
  v_mfma_f32_16x16x32_bf16 v[56:59], a[148:151], a[176:179], v[56:59]
  ds_read_b64_tr_b16 a[144:145], v154 offset:12288
  ds_read_b64_tr_b16 a[146:147], v154 offset:14336
  v_mfma_f32_16x16x32_bf16 v[60:63], a[148:151], a[180:183], v[60:63]
  s_waitcnt lgkmcnt(8)
  buffer_load_dwordx4 a[248:251], v164, s[92:95], s38 offen offset:2048 sc1
  v_mfma_f32_16x16x32_bf16 v[0:3], a[152:155], a[184:187], v[0:3]
  ds_read_b64_tr_b16 a[148:149], v157 offset:12288
  ds_read_b64_tr_b16 a[150:151], v157 offset:14336
  v_mfma_f32_16x16x32_bf16 v[4:7], a[152:155], a[188:191], v[4:7]
  s_waitcnt lgkmcnt(8)
  buffer_load_dwordx4 v147, s[8:11], s20 offen offset:3072 lds
  v_mfma_f32_16x16x32_bf16 v[8:11], a[156:159], a[184:187], v[8:11]
  ds_read_b64_tr_b16 a[152:153], v160 offset:12288
  ds_read_b64_tr_b16 a[154:155], v160 offset:14336
  v_mfma_f32_16x16x32_bf16 v[12:15], a[156:159], a[188:191], v[12:15]
  s_waitcnt lgkmcnt(8)
  s_add_u32 s20, s20, s29
  s_add_u32 m0, s21, 49152
  v_mfma_f32_16x16x32_bf16 v[16:19], a[160:163], a[184:187], v[16:19]
  ds_read_b64_tr_b16 a[156:157], v163 offset:12288
  ds_read_b64_tr_b16 a[158:159], v163 offset:14336
  v_mfma_f32_16x16x32_bf16 v[20:23], a[160:163], a[188:191], v[20:23]
  s_waitcnt lgkmcnt(8)
  v_mfma_f32_16x16x32_bf16 v[24:27], a[164:167], a[184:187], v[24:27]
  ds_read_b64_tr_b16 a[160:161], v154 offset:16384
  ds_read_b64_tr_b16 a[162:163], v154 offset:18432
  v_mfma_f32_16x16x32_bf16 v[28:31], a[164:167], a[188:191], v[28:31]
  s_waitcnt lgkmcnt(8)
  buffer_load_dwordx4 a[252:255], v164, s[92:95], s38 offen offset:3072 sc1
  v_mfma_f32_16x16x32_bf16 v[32:35], a[144:147], a[184:187], v[32:35]
  ds_read_b64_tr_b16 a[164:165], v157 offset:16384
  ds_read_b64_tr_b16 a[166:167], v157 offset:18432
  v_mfma_f32_16x16x32_bf16 v[36:39], a[144:147], a[188:191], v[36:39]
  s_waitcnt lgkmcnt(8)
  buffer_load_dwordx4 v144, s[8:11], s20 offen offset:0 lds
  v_mfma_f32_16x16x32_bf16 v[40:43], a[148:151], a[184:187], v[40:43]
  ds_read_b64_tr_b16 a[144:145], v160 offset:16384
  ds_read_b64_tr_b16 a[146:147], v160 offset:18432
  v_mfma_f32_16x16x32_bf16 v[44:47], a[148:151], a[188:191], v[44:47]
  s_waitcnt lgkmcnt(8)
  s_add_u32 s38, s38, 16384
  v_mfma_f32_16x16x32_bf16 v[48:51], a[152:155], a[184:187], v[48:51]
  ds_read_b64_tr_b16 a[148:149], v163 offset:16384
  ds_read_b64_tr_b16 a[150:151], v163 offset:18432
  v_mfma_f32_16x16x32_bf16 v[52:55], a[152:155], a[188:191], v[52:55]
  s_waitcnt lgkmcnt(8)
  v_mfma_f32_16x16x32_bf16 v[56:59], a[156:159], a[184:187], v[56:59]
  ds_read_b64_tr_b16 a[152:153], v154 offset:20480
  ds_read_b64_tr_b16 a[154:155], v154 offset:22528
  v_mfma_f32_16x16x32_bf16 v[60:63], a[156:159], a[188:191], v[60:63]
  s_waitcnt vmcnt(35) lgkmcnt(8)
  v_mfma_f32_16x16x32_bf16 v[0:3], a[160:163], a[192:195], v[0:3]
  ds_read_b64_tr_b16 a[156:157], v157 offset:20480
  ds_read_b64_tr_b16 a[158:159], v157 offset:22528
  v_mfma_f32_16x16x32_bf16 v[4:7], a[160:163], a[196:199], v[4:7]
  s_waitcnt lgkmcnt(8)
  buffer_load_dwordx4 v145, s[8:11], s20 offen offset:1024 lds
  v_mfma_f32_16x16x32_bf16 v[8:11], a[164:167], a[192:195], v[8:11]
  ds_read_b64_tr_b16 a[160:161], v160 offset:20480
  ds_read_b64_tr_b16 a[162:163], v160 offset:22528
  v_mfma_f32_16x16x32_bf16 v[12:15], a[164:167], a[196:199], v[12:15]
  s_waitcnt lgkmcnt(8)
  s_cmp_lt_u32 s38, s36
  s_cbranch_scc0 K3_slow_G2six1
K3_back_G2six1:
  v_mfma_f32_16x16x32_bf16 v[16:19], a[144:147], a[192:195], v[16:19]
  ds_read_b64_tr_b16 a[164:165], v163 offset:20480
  ds_read_b64_tr_b16 a[166:167], v163 offset:22528
  v_mfma_f32_16x16x32_bf16 v[20:23], a[144:147], a[196:199], v[20:23]
  s_waitcnt lgkmcnt(8)
  buffer_load_dwordx4 v[192:195], v164, s[92:95], s38 offen offset:0 sc1
  v_mfma_f32_16x16x32_bf16 v[24:27], a[148:151], a[192:195], v[24:27]
  ds_read_b64_tr_b16 a[144:145], v154 offset:24576
  ds_read_b64_tr_b16 a[146:147], v154 offset:26624
  v_mfma_f32_16x16x32_bf16 v[28:31], a[148:151], a[196:199], v[28:31]
  s_waitcnt lgkmcnt(8)
  v_mfma_f32_16x16x32_bf16 v[32:35], a[152:155], a[192:195], v[32:35]
  ds_read_b64_tr_b16 a[148:149], v157 offset:24576
  ds_read_b64_tr_b16 a[150:151], v157 offset:26624
  v_mfma_f32_16x16x32_bf16 v[36:39], a[152:155], a[196:199], v[36:39]
  s_waitcnt vmcnt(14) lgkmcnt(8)
  buffer_load_dwordx4 v146, s[8:11], s20 offen offset:2048 lds
  v_mfma_f32_16x16x32_bf16 v[40:43], a[156:159], a[192:195], v[40:43]
  ds_read_b64_tr_b16 a[152:153], v160 offset:24576
  ds_read_b64_tr_b16 a[154:155], v160 offset:26624
  v_mfma_f32_16x16x32_bf16 v[44:47], a[156:159], a[196:199], v[44:47]
  s_waitcnt lgkmcnt(8)
  buffer_load_dwordx4 v[196:199], v164, s[92:95], s38 offen offset:1024 sc1
  v_mfma_f32_16x16x32_bf16 v[48:51], a[160:163], a[192:195], v[48:51]
  ds_read_b64_tr_b16 a[156:157], v163 offset:24576
  ds_read_b64_tr_b16 a[158:159], v163 offset:26624
  v_mfma_f32_16x16x32_bf16 v[52:55], a[160:163], a[196:199], v[52:55]
  s_waitcnt lgkmcnt(8)
  v_min3_u32 v172, v172, v173, v174
  v_mfma_f32_16x16x32_bf16 v[56:59], a[164:167], a[192:195], v[56:59]
  ds_read_b64_tr_b16 a[160:161], v154 offset:28672
  ds_read_b64_tr_b16 a[162:163], v154 offset:30720
  v_mfma_f32_16x16x32_bf16 v[60:63], a[164:167], a[196:199], v[60:63]
  s_waitcnt lgkmcnt(8)
  buffer_load_dwordx4 v[200:203], v164, s[92:95], s38 offen offset:2048 sc1
  v_mfma_f32_16x16x32_bf16 v[0:3], a[144:147], a[200:203], v[0:3]
  ds_read_b64_tr_b16 a[164:165], v157 offset:28672
  ds_read_b64_tr_b16 a[166:167], v157 offset:30720
  v_mfma_f32_16x16x32_bf16 v[4:7], a[144:147], a[204:207], v[4:7]
  s_waitcnt lgkmcnt(8)
  buffer_load_dwordx4 v147, s[8:11], s20 offen offset:3072 lds
  v_mfma_f32_16x16x32_bf16 v[8:11], a[148:151], a[200:203], v[8:11]
  ds_read_b64_tr_b16 a[144:145], v160 offset:28672
  ds_read_b64_tr_b16 a[146:147], v160 offset:30720
  v_mfma_f32_16x16x32_bf16 v[12:15], a[148:151], a[204:207], v[12:15]
  s_waitcnt lgkmcnt(8)
  s_add_u32 s20, s20, s27
  s_add_u32 m0, s21, 65536
  v_mfma_f32_16x16x32_bf16 v[16:19], a[152:155], a[200:203], v[16:19]
  ds_read_b64_tr_b16 a[148:149], v163 offset:28672
  ds_read_b64_tr_b16 a[150:151], v163 offset:30720
  v_mfma_f32_16x16x32_bf16 v[20:23], a[152:155], a[204:207], v[20:23]
  s_waitcnt lgkmcnt(8)
  v_min_u32 v172, v172, v175
  v_lshlrev_b32 v173, 16, v172
  v_mfma_f32_16x16x32_bf16 v[24:27], a[156:159], a[200:203], v[24:27]
  ds_read_b64_tr_b16 a[152:153], v154 offset:32768
  ds_read_b64_tr_b16 a[154:155], v154 offset:34816
  v_mfma_f32_16x16x32_bf16 v[28:31], a[156:159], a[204:207], v[28:31]
  s_waitcnt lgkmcnt(8)
  buffer_load_dwordx4 v[204:207], v164, s[92:95], s38 offen offset:3072 sc1
  v_mfma_f32_16x16x32_bf16 v[32:35], a[160:163], a[200:203], v[32:35]
  ds_read_b64_tr_b16 a[156:157], v157 offset:32768
  ds_read_b64_tr_b16 a[158:159], v157 offset:34816
  v_mfma_f32_16x16x32_bf16 v[36:39], a[160:163], a[204:207], v[36:39]
  s_waitcnt lgkmcnt(8)
  buffer_load_dwordx4 v144, s[8:11], s20 offen offset:0 lds
  v_mfma_f32_16x16x32_bf16 v[40:43], a[164:167], a[200:203], v[40:43]
  ds_read_b64_tr_b16 a[160:161], v160 offset:32768
  ds_read_b64_tr_b16 a[162:163], v160 offset:34816
  v_mfma_f32_16x16x32_bf16 v[44:47], a[164:167], a[204:207], v[44:47]
  s_waitcnt lgkmcnt(8)
  s_add_u32 s38, s38, 16384
  v_mfma_f32_16x16x32_bf16 v[48:51], a[144:147], a[200:203], v[48:51]
  ds_read_b64_tr_b16 a[164:165], v163 offset:32768
  ds_read_b64_tr_b16 a[166:167], v163 offset:34816
  v_mfma_f32_16x16x32_bf16 v[52:55], a[144:147], a[204:207], v[52:55]
  s_waitcnt lgkmcnt(8)
  s_nop 0
  v_readfirstlane_b32 s36, v173
  v_mfma_f32_16x16x32_bf16 v[56:59], a[148:151], a[200:203], v[56:59]
  ds_read_b64_tr_b16 a[144:145], v154 offset:36864
  ds_read_b64_tr_b16 a[146:147], v154 offset:38912
  v_mfma_f32_16x16x32_bf16 v[60:63], a[148:151], a[204:207], v[60:63]
  s_waitcnt vmcnt(22) lgkmcnt(8)
  buffer_load_dwordx4 v[172:175], off, s[12:15], s33 sc1
  v_mfma_f32_16x16x32_bf16 v[224:227], a[152:155], a[176:179], v[224:227]
  ds_read_b64_tr_b16 a[148:149], v157 offset:36864
  ds_read_b64_tr_b16 a[150:151], v157 offset:38912
  v_mfma_f32_16x16x32_bf16 v[228:231], a[152:155], a[180:183], v[228:231]
  s_waitcnt lgkmcnt(8)
  buffer_load_dwordx4 v145, s[8:11], s20 offen offset:1024 lds
  v_mfma_f32_16x16x32_bf16 v[232:235], a[156:159], a[176:179], v[232:235]
  ds_read_b64_tr_b16 a[152:153], v160 offset:36864
  ds_read_b64_tr_b16 a[154:155], v160 offset:38912
  v_mfma_f32_16x16x32_bf16 v[236:239], a[156:159], a[180:183], v[236:239]
  s_waitcnt lgkmcnt(8)
  v_mfma_f32_16x16x32_bf16 v[240:243], a[160:163], a[176:179], v[240:243]
  ds_read_b64_tr_b16 a[156:157], v163 offset:36864
  ds_read_b64_tr_b16 a[158:159], v163 offset:38912
  v_mfma_f32_16x16x32_bf16 v[244:247], a[160:163], a[180:183], v[244:247]
  s_waitcnt lgkmcnt(8)
  v_mfma_f32_16x16x32_bf16 v[248:251], a[164:167], a[176:179], v[248:251]
  ds_read_b64_tr_b16 a[160:161], v154 offset:40960
  ds_read_b64_tr_b16 a[162:163], v154 offset:43008
  v_mfma_f32_16x16x32_bf16 v[252:255], a[164:167], a[180:183], v[252:255]
  s_waitcnt lgkmcnt(8)
  v_mfma_f32_16x16x32_bf16 v[224:227], a[144:147], a[184:187], v[224:227]
  ds_read_b64_tr_b16 a[164:165], v157 offset:40960
  ds_read_b64_tr_b16 a[166:167], v157 offset:43008
  v_mfma_f32_16x16x32_bf16 v[228:231], a[144:147], a[188:191], v[228:231]
  s_waitcnt lgkmcnt(8)
  buffer_load_dwordx4 v146, s[8:11], s20 offen offset:2048 lds
  v_mfma_f32_16x16x32_bf16 v[232:235], a[148:151], a[184:187], v[232:235]
  ds_read_b64_tr_b16 a[144:145], v160 offset:40960
  ds_read_b64_tr_b16 a[146:147], v160 offset:43008
  v_mfma_f32_16x16x32_bf16 v[236:239], a[148:151], a[188:191], v[236:239]
  s_waitcnt lgkmcnt(8)
  v_mfma_f32_16x16x32_bf16 v[240:243], a[152:155], a[184:187], v[240:243]
  ds_read_b64_tr_b16 a[148:149], v163 offset:40960
  ds_read_b64_tr_b16 a[150:151], v163 offset:43008
  v_mfma_f32_16x16x32_bf16 v[244:247], a[152:155], a[188:191], v[244:247]
  s_waitcnt lgkmcnt(8)
  v_mfma_f32_16x16x32_bf16 v[248:251], a[156:159], a[184:187], v[248:251]
  ds_read_b64_tr_b16 a[152:153], v154 offset:45056
  ds_read_b64_tr_b16 a[154:155], v154 offset:47104
  v_mfma_f32_16x16x32_bf16 v[252:255], a[156:159], a[188:191], v[252:255]
  s_waitcnt lgkmcnt(8)
  v_mfma_f32_16x16x32_bf16 v[224:227], a[160:163], a[192:195], v[224:227]
  ds_read_b64_tr_b16 a[156:157], v157 offset:45056
  ds_read_b64_tr_b16 a[158:159], v157 offset:47104
  v_mfma_f32_16x16x32_bf16 v[228:231], a[160:163], a[196:199], v[228:231]
  s_waitcnt lgkmcnt(8)
  buffer_load_dwordx4 v147, s[8:11], s20 offen offset:3072 lds
  v_mfma_f32_16x16x32_bf16 v[232:235], a[164:167], a[192:195], v[232:235]
  ds_read_b64_tr_b16 a[160:161], v160 offset:45056
  ds_read_b64_tr_b16 a[162:163], v160 offset:47104
  v_mfma_f32_16x16x32_bf16 v[236:239], a[164:167], a[196:199], v[236:239]
  s_waitcnt lgkmcnt(8)
  s_add_u32 s20, s20, s28
  s_add_u32 m0, s21, 81920
  v_mfma_f32_16x16x32_bf16 v[240:243], a[144:147], a[192:195], v[240:243]
  ds_read_b64_tr_b16 a[164:165], v163 offset:45056
  ds_read_b64_tr_b16 a[166:167], v163 offset:47104
  v_mfma_f32_16x16x32_bf16 v[244:247], a[144:147], a[196:199], v[244:247]
  s_waitcnt vmcnt(14) lgkmcnt(8)
  s_barrier
  v_mfma_f32_16x16x32_bf16 v[248:251], a[148:151], a[192:195], v[248:251]
  ds_read_b64_tr_b16 a[144:145], v152 offset:0
  ds_read_b64_tr_b16 a[146:147], v152 offset:2048
  v_mfma_f32_16x16x32_bf16 v[252:255], a[148:151], a[196:199], v[252:255]
  s_waitcnt lgkmcnt(8)
  v_mov_b32 v176, 15
  v_mfma_f32_16x16x32_bf16 v[224:227], a[152:155], a[200:203], v[224:227]
  ds_read_b64_tr_b16 a[148:149], v155 offset:0
  ds_read_b64_tr_b16 a[150:151], v155 offset:2048
  v_mfma_f32_16x16x32_bf16 v[228:231], a[152:155], a[204:207], v[228:231]
  s_waitcnt lgkmcnt(8)
  buffer_load_dwordx4 v144, s[8:11], s20 offen offset:0 lds
  v_mfma_f32_16x16x32_bf16 v[232:235], a[156:159], a[200:203], v[232:235]
  ds_read_b64_tr_b16 a[152:153], v158 offset:0
  ds_read_b64_tr_b16 a[154:155], v158 offset:2048
  v_mfma_f32_16x16x32_bf16 v[236:239], a[156:159], a[204:207], v[236:239]
  s_waitcnt lgkmcnt(8)
  buffer_store_dword v176, v165, s[12:15], s34 offen sc1
  v_mfma_f32_16x16x32_bf16 v[240:243], a[160:163], a[200:203], v[240:243]
  ds_read_b64_tr_b16 a[156:157], v161 offset:0
  ds_read_b64_tr_b16 a[158:159], v161 offset:2048
  v_mfma_f32_16x16x32_bf16 v[244:247], a[160:163], a[204:207], v[244:247]
  s_waitcnt lgkmcnt(8)
  v_mfma_f32_16x16x32_bf16 v[248:251], a[164:167], a[200:203], v[248:251]
  ds_read_b64_tr_b16 a[160:161], v152 offset:4096
  ds_read_b64_tr_b16 a[162:163], v152 offset:6144
  v_mfma_f32_16x16x32_bf16 v[252:255], a[164:167], a[204:207], v[252:255]
  s_waitcnt vmcnt(36) lgkmcnt(8)
  v_mfma_f32_16x16x32_bf16 v[0:3], a[144:147], a[208:211], v[0:3]
  ds_read_b64_tr_b16 a[164:165], v155 offset:4096
  ds_read_b64_tr_b16 a[166:167], v155 offset:6144
  v_mfma_f32_16x16x32_bf16 v[4:7], a[144:147], a[212:215], v[4:7]
  s_waitcnt lgkmcnt(8)
  buffer_load_dwordx4 v145, s[8:11], s20 offen offset:1024 lds
  v_mfma_f32_16x16x32_bf16 v[8:11], a[148:151], a[208:211], v[8:11]
  ds_read_b64_tr_b16 a[144:145], v158 offset:4096
  ds_read_b64_tr_b16 a[146:147], v158 offset:6144
  v_mfma_f32_16x16x32_bf16 v[12:15], a[148:151], a[212:215], v[12:15]
  s_waitcnt lgkmcnt(8)
  s_cmp_lt_u32 s38, s36
  s_cbranch_scc0 K3_slow_G2six3
K3_back_G2six3:
  v_mfma_f32_16x16x32_bf16 v[16:19], a[152:155], a[208:211], v[16:19]
  ds_read_b64_tr_b16 a[148:149], v161 offset:4096
  ds_read_b64_tr_b16 a[150:151], v161 offset:6144
  v_mfma_f32_16x16x32_bf16 v[20:23], a[152:155], a[212:215], v[20:23]
  s_waitcnt lgkmcnt(8)
  buffer_load_dwordx4 a[176:179], v164, s[92:95], s38 offen offset:0 sc1
  v_mfma_f32_16x16x32_bf16 v[24:27], a[156:159], a[208:211], v[24:27]
  ds_read_b64_tr_b16 a[152:153], v152 offset:8192
  ds_read_b64_tr_b16 a[154:155], v152 offset:10240
  v_mfma_f32_16x16x32_bf16 v[28:31], a[156:159], a[212:215], v[28:31]
  s_waitcnt lgkmcnt(8)
  v_mfma_f32_16x16x32_bf16 v[32:35], a[160:163], a[208:211], v[32:35]
  ds_read_b64_tr_b16 a[156:157], v155 offset:8192
  ds_read_b64_tr_b16 a[158:159], v155 offset:10240
  v_mfma_f32_16x16x32_bf16 v[36:39], a[160:163], a[212:215], v[36:39]
  s_waitcnt lgkmcnt(8)
  buffer_load_dwordx4 v146, s[8:11], s20 offen offset:2048 lds
  v_mfma_f32_16x16x32_bf16 v[40:43], a[164:167], a[208:211], v[40:43]
  ds_read_b64_tr_b16 a[160:161], v158 offset:8192
  ds_read_b64_tr_b16 a[162:163], v158 offset:10240
  v_mfma_f32_16x16x32_bf16 v[44:47], a[164:167], a[212:215], v[44:47]
  s_waitcnt lgkmcnt(8)
  buffer_load_dwordx4 a[180:183], v164, s[92:95], s38 offen offset:1024 sc1
  v_mfma_f32_16x16x32_bf16 v[48:51], a[144:147], a[208:211], v[48:51]
  ds_read_b64_tr_b16 a[164:165], v161 offset:8192
  ds_read_b64_tr_b16 a[166:167], v161 offset:10240
  v_mfma_f32_16x16x32_bf16 v[52:55], a[144:147], a[212:215], v[52:55]
  s_waitcnt lgkmcnt(8)
  v_mfma_f32_16x16x32_bf16 v[56:59], a[148:151], a[208:211], v[56:59]
  ds_read_b64_tr_b16 a[144:145], v152 offset:12288
  ds_read_b64_tr_b16 a[146:147], v152 offset:14336
  v_mfma_f32_16x16x32_bf16 v[60:63], a[148:151], a[212:215], v[60:63]
  s_waitcnt lgkmcnt(8)
  buffer_load_dwordx4 a[184:187], v164, s[92:95], s38 offen offset:2048 sc1
  v_mfma_f32_16x16x32_bf16 v[0:3], a[152:155], a[216:219], v[0:3]
  ds_read_b64_tr_b16 a[148:149], v155 offset:12288
  ds_read_b64_tr_b16 a[150:151], v155 offset:14336
  v_mfma_f32_16x16x32_bf16 v[4:7], a[152:155], a[220:223], v[4:7]
  s_waitcnt lgkmcnt(8)
  buffer_load_dwordx4 v147, s[8:11], s20 offen offset:3072 lds
  v_mfma_f32_16x16x32_bf16 v[8:11], a[156:159], a[216:219], v[8:11]
  ds_read_b64_tr_b16 a[152:153], v158 offset:12288
  ds_read_b64_tr_b16 a[154:155], v158 offset:14336
  v_mfma_f32_16x16x32_bf16 v[12:15], a[156:159], a[220:223], v[12:15]
  s_waitcnt lgkmcnt(8)
  s_add_u32 s20, s20, s29
  s_add_u32 m0, s21, 98304
  v_mfma_f32_16x16x32_bf16 v[16:19], a[160:163], a[216:219], v[16:19]
  ds_read_b64_tr_b16 a[156:157], v161 offset:12288
  ds_read_b64_tr_b16 a[158:159], v161 offset:14336
  v_mfma_f32_16x16x32_bf16 v[20:23], a[160:163], a[220:223], v[20:23]
  s_waitcnt lgkmcnt(8)
  v_mfma_f32_16x16x32_bf16 v[24:27], a[164:167], a[216:219], v[24:27]
  ds_read_b64_tr_b16 a[160:161], v152 offset:16384
  ds_read_b64_tr_b16 a[162:163], v152 offset:18432
  v_mfma_f32_16x16x32_bf16 v[28:31], a[164:167], a[220:223], v[28:31]
  s_waitcnt lgkmcnt(8)
  buffer_load_dwordx4 a[188:191], v164, s[92:95], s38 offen offset:3072 sc1
  v_mfma_f32_16x16x32_bf16 v[32:35], a[144:147], a[216:219], v[32:35]
  ds_read_b64_tr_b16 a[164:165], v155 offset:16384
  ds_read_b64_tr_b16 a[166:167], v155 offset:18432
  v_mfma_f32_16x16x32_bf16 v[36:39], a[144:147], a[220:223], v[36:39]
  s_waitcnt lgkmcnt(8)
  buffer_load_dwordx4 v144, s[8:11], s20 offen offset:0 lds
  v_mfma_f32_16x16x32_bf16 v[40:43], a[148:151], a[216:219], v[40:43]
  ds_read_b64_tr_b16 a[144:145], v158 offset:16384
  ds_read_b64_tr_b16 a[146:147], v158 offset:18432
  v_mfma_f32_16x16x32_bf16 v[44:47], a[148:151], a[220:223], v[44:47]
  s_waitcnt lgkmcnt(8)
  s_add_u32 s38, s38, 16384
  v_mfma_f32_16x16x32_bf16 v[48:51], a[152:155], a[216:219], v[48:51]
  ds_read_b64_tr_b16 a[148:149], v161 offset:16384
  ds_read_b64_tr_b16 a[150:151], v161 offset:18432
  v_mfma_f32_16x16x32_bf16 v[52:55], a[152:155], a[220:223], v[52:55]
  s_waitcnt lgkmcnt(8)
  v_mfma_f32_16x16x32_bf16 v[56:59], a[156:159], a[216:219], v[56:59]
  ds_read_b64_tr_b16 a[152:153], v152 offset:20480
  ds_read_b64_tr_b16 a[154:155], v152 offset:22528
  v_mfma_f32_16x16x32_bf16 v[60:63], a[156:159], a[220:223], v[60:63]
  s_waitcnt vmcnt(36) lgkmcnt(8)
  v_mfma_f32_16x16x32_bf16 v[0:3], a[160:163], a[224:227], v[0:3]
  ds_read_b64_tr_b16 a[156:157], v155 offset:20480
  ds_read_b64_tr_b16 a[158:159], v155 offset:22528
  v_mfma_f32_16x16x32_bf16 v[4:7], a[160:163], a[228:231], v[4:7]
  s_waitcnt lgkmcnt(8)
  buffer_load_dwordx4 v145, s[8:11], s20 offen offset:1024 lds
  v_mfma_f32_16x16x32_bf16 v[8:11], a[164:167], a[224:227], v[8:11]
  ds_read_b64_tr_b16 a[160:161], v158 offset:20480
  ds_read_b64_tr_b16 a[162:163], v158 offset:22528
  v_mfma_f32_16x16x32_bf16 v[12:15], a[164:167], a[228:231], v[12:15]
  s_waitcnt lgkmcnt(8)
  s_cmp_lt_u32 s38, s36
  s_cbranch_scc0 K3_slow_G2six4
K3_back_G2six4:
  v_mfma_f32_16x16x32_bf16 v[16:19], a[144:147], a[224:227], v[16:19]
  ds_read_b64_tr_b16 a[164:165], v161 offset:20480
  ds_read_b64_tr_b16 a[166:167], v161 offset:22528
  v_mfma_f32_16x16x32_bf16 v[20:23], a[144:147], a[228:231], v[20:23]
  s_waitcnt lgkmcnt(8)
  buffer_load_dwordx4 a[192:195], v164, s[92:95], s38 offen offset:0 sc1
  v_mfma_f32_16x16x32_bf16 v[24:27], a[148:151], a[224:227], v[24:27]
  ds_read_b64_tr_b16 a[144:145], v152 offset:24576
  ds_read_b64_tr_b16 a[146:147], v152 offset:26624
  v_mfma_f32_16x16x32_bf16 v[28:31], a[148:151], a[228:231], v[28:31]
  s_waitcnt lgkmcnt(8)
  v_mfma_f32_16x16x32_bf16 v[32:35], a[152:155], a[224:227], v[32:35]
  ds_read_b64_tr_b16 a[148:149], v155 offset:24576
  ds_read_b64_tr_b16 a[150:151], v155 offset:26624
  v_mfma_f32_16x16x32_bf16 v[36:39], a[152:155], a[228:231], v[36:39]
  s_waitcnt vmcnt(15) lgkmcnt(8)
  buffer_load_dwordx4 v146, s[8:11], s20 offen offset:2048 lds
  v_mfma_f32_16x16x32_bf16 v[40:43], a[156:159], a[224:227], v[40:43]
  ds_read_b64_tr_b16 a[152:153], v158 offset:24576
  ds_read_b64_tr_b16 a[154:155], v158 offset:26624
  v_mfma_f32_16x16x32_bf16 v[44:47], a[156:159], a[228:231], v[44:47]
  s_waitcnt lgkmcnt(8)
  buffer_load_dwordx4 a[196:199], v164, s[92:95], s38 offen offset:1024 sc1
  v_mfma_f32_16x16x32_bf16 v[48:51], a[160:163], a[224:227], v[48:51]
  ds_read_b64_tr_b16 a[156:157], v161 offset:24576
  ds_read_b64_tr_b16 a[158:159], v161 offset:26624
  v_mfma_f32_16x16x32_bf16 v[52:55], a[160:163], a[228:231], v[52:55]
  s_waitcnt lgkmcnt(8)
  v_min3_u32 v172, v172, v173, v174
  v_mfma_f32_16x16x32_bf16 v[56:59], a[164:167], a[224:227], v[56:59]
  ds_read_b64_tr_b16 a[160:161], v152 offset:28672
  ds_read_b64_tr_b16 a[162:163], v152 offset:30720
  v_mfma_f32_16x16x32_bf16 v[60:63], a[164:167], a[228:231], v[60:63]
  s_waitcnt lgkmcnt(8)
  buffer_load_dwordx4 a[200:203], v164, s[92:95], s38 offen offset:2048 sc1
  v_mfma_f32_16x16x32_bf16 v[0:3], a[144:147], a[232:235], v[0:3]
  ds_read_b64_tr_b16 a[164:165], v155 offset:28672
  ds_read_b64_tr_b16 a[166:167], v155 offset:30720
  v_mfma_f32_16x16x32_bf16 v[4:7], a[144:147], a[236:239], v[4:7]
  s_waitcnt lgkmcnt(8)
  buffer_load_dwordx4 v147, s[8:11], s20 offen offset:3072 lds
  v_mfma_f32_16x16x32_bf16 v[8:11], a[148:151], a[232:235], v[8:11]
  ds_read_b64_tr_b16 a[144:145], v158 offset:28672
  ds_read_b64_tr_b16 a[146:147], v158 offset:30720
  v_mfma_f32_16x16x32_bf16 v[12:15], a[148:151], a[236:239], v[12:15]
  s_waitcnt lgkmcnt(8)
  s_add_u32 s20, s20, s27
  s_add_u32 m0, s21, 114688
  v_mfma_f32_16x16x32_bf16 v[16:19], a[152:155], a[232:235], v[16:19]
  ds_read_b64_tr_b16 a[148:149], v161 offset:28672
  ds_read_b64_tr_b16 a[150:151], v161 offset:30720
  v_mfma_f32_16x16x32_bf16 v[20:23], a[152:155], a[236:239], v[20:23]
  s_waitcnt lgkmcnt(8)
  v_min_u32 v172, v172, v175
  v_lshlrev_b32 v173, 16, v172
  v_mfma_f32_16x16x32_bf16 v[24:27], a[156:159], a[232:235], v[24:27]
  ds_read_b64_tr_b16 a[152:153], v152 offset:32768
  ds_read_b64_tr_b16 a[154:155], v152 offset:34816
  v_mfma_f32_16x16x32_bf16 v[28:31], a[156:159], a[236:239], v[28:31]
  s_waitcnt lgkmcnt(8)
  buffer_load_dwordx4 a[204:207], v164, s[92:95], s38 offen offset:3072 sc1
  v_mfma_f32_16x16x32_bf16 v[32:35], a[160:163], a[232:235], v[32:35]
  ds_read_b64_tr_b16 a[156:157], v155 offset:32768
  ds_read_b64_tr_b16 a[158:159], v155 offset:34816
  v_mfma_f32_16x16x32_bf16 v[36:39], a[160:163], a[236:239], v[36:39]
  s_waitcnt lgkmcnt(8)
  buffer_load_dwordx4 v144, s[8:11], s20 offen offset:0 lds
  v_mfma_f32_16x16x32_bf16 v[40:43], a[164:167], a[232:235], v[40:43]
  ds_read_b64_tr_b16 a[160:161], v158 offset:32768
  ds_read_b64_tr_b16 a[162:163], v158 offset:34816
  v_mfma_f32_16x16x32_bf16 v[44:47], a[164:167], a[236:239], v[44:47]
  s_waitcnt lgkmcnt(8)
  s_add_u32 s38, s38, 16384
  v_mfma_f32_16x16x32_bf16 v[48:51], a[144:147], a[232:235], v[48:51]
  ds_read_b64_tr_b16 a[164:165], v161 offset:32768
  ds_read_b64_tr_b16 a[166:167], v161 offset:34816
  v_mfma_f32_16x16x32_bf16 v[52:55], a[144:147], a[236:239], v[52:55]
  s_waitcnt lgkmcnt(8)
  s_nop 0
  v_readfirstlane_b32 s36, v173
  v_mfma_f32_16x16x32_bf16 v[56:59], a[148:151], a[232:235], v[56:59]
  ds_read_b64_tr_b16 a[144:145], v152 offset:36864
  ds_read_b64_tr_b16 a[146:147], v152 offset:38912
  v_mfma_f32_16x16x32_bf16 v[60:63], a[148:151], a[236:239], v[60:63]
  s_waitcnt lgkmcnt(8)
  buffer_load_dwordx4 v[172:175], off, s[12:15], s33 sc1
  v_mfma_f32_16x16x32_bf16 v[224:227], a[152:155], a[208:211], v[224:227]
  ds_read_b64_tr_b16 a[148:149], v155 offset:36864
  ds_read_b64_tr_b16 a[150:151], v155 offset:38912
  v_mfma_f32_16x16x32_bf16 v[228:231], a[152:155], a[212:215], v[228:231]
  s_waitcnt lgkmcnt(8)
  buffer_load_dwordx4 v145, s[8:11], s20 offen offset:1024 lds
  v_mfma_f32_16x16x32_bf16 v[232:235], a[156:159], a[208:211], v[232:235]
  ds_read_b64_tr_b16 a[152:153], v158 offset:36864
  ds_read_b64_tr_b16 a[154:155], v158 offset:38912
  v_mfma_f32_16x16x32_bf16 v[236:239], a[156:159], a[212:215], v[236:239]
  s_waitcnt lgkmcnt(8)
  v_mfma_f32_16x16x32_bf16 v[240:243], a[160:163], a[208:211], v[240:243]
  ds_read_b64_tr_b16 a[156:157], v161 offset:36864
  ds_read_b64_tr_b16 a[158:159], v161 offset:38912
  v_mfma_f32_16x16x32_bf16 v[244:247], a[160:163], a[212:215], v[244:247]
  s_waitcnt lgkmcnt(8)
  v_mfma_f32_16x16x32_bf16 v[248:251], a[164:167], a[208:211], v[248:251]
  ds_read_b64_tr_b16 a[160:161], v152 offset:40960
  ds_read_b64_tr_b16 a[162:163], v152 offset:43008
  v_mfma_f32_16x16x32_bf16 v[252:255], a[164:167], a[212:215], v[252:255]
  s_waitcnt lgkmcnt(8)
  v_mfma_f32_16x16x32_bf16 v[224:227], a[144:147], a[216:219], v[224:227]
  ds_read_b64_tr_b16 a[164:165], v155 offset:40960
  ds_read_b64_tr_b16 a[166:167], v155 offset:43008
  v_mfma_f32_16x16x32_bf16 v[228:231], a[144:147], a[220:223], v[228:231]
  s_waitcnt lgkmcnt(8)
  buffer_load_dwordx4 v146, s[8:11], s20 offen offset:2048 lds
  v_mfma_f32_16x16x32_bf16 v[232:235], a[148:151], a[216:219], v[232:235]
  ds_read_b64_tr_b16 a[144:145], v158 offset:40960
  ds_read_b64_tr_b16 a[146:147], v158 offset:43008
  v_mfma_f32_16x16x32_bf16 v[236:239], a[148:151], a[220:223], v[236:239]
  s_waitcnt lgkmcnt(8)
  v_mfma_f32_16x16x32_bf16 v[240:243], a[152:155], a[216:219], v[240:243]
  ds_read_b64_tr_b16 a[148:149], v161 offset:40960
  ds_read_b64_tr_b16 a[150:151], v161 offset:43008
  v_mfma_f32_16x16x32_bf16 v[244:247], a[152:155], a[220:223], v[244:247]
  s_waitcnt lgkmcnt(8)
  v_mfma_f32_16x16x32_bf16 v[248:251], a[156:159], a[216:219], v[248:251]
  ds_read_b64_tr_b16 a[152:153], v152 offset:45056
  ds_read_b64_tr_b16 a[154:155], v152 offset:47104
  v_mfma_f32_16x16x32_bf16 v[252:255], a[156:159], a[220:223], v[252:255]
  s_waitcnt lgkmcnt(8)
  v_mfma_f32_16x16x32_bf16 v[224:227], a[160:163], a[224:227], v[224:227]
  ds_read_b64_tr_b16 a[156:157], v155 offset:45056
  ds_read_b64_tr_b16 a[158:159], v155 offset:47104
  v_mfma_f32_16x16x32_bf16 v[228:231], a[160:163], a[228:231], v[228:231]
  s_waitcnt lgkmcnt(8)
  buffer_load_dwordx4 v147, s[8:11], s20 offen offset:3072 lds
  v_mfma_f32_16x16x32_bf16 v[232:235], a[164:167], a[224:227], v[232:235]
  ds_read_b64_tr_b16 a[160:161], v158 offset:45056
  ds_read_b64_tr_b16 a[162:163], v158 offset:47104
  v_mfma_f32_16x16x32_bf16 v[236:239], a[164:167], a[228:231], v[236:239]
  s_waitcnt lgkmcnt(8)
  s_add_u32 s20, s20, s28
  s_add_u32 m0, s21, 131072
  v_mfma_f32_16x16x32_bf16 v[240:243], a[144:147], a[224:227], v[240:243]
  ds_read_b64_tr_b16 a[164:165], v161 offset:45056
  ds_read_b64_tr_b16 a[166:167], v161 offset:47104
  v_mfma_f32_16x16x32_bf16 v[244:247], a[144:147], a[228:231], v[244:247]
  s_waitcnt vmcnt(14) lgkmcnt(8)
  s_barrier
  v_mfma_f32_16x16x32_bf16 v[248:251], a[148:151], a[224:227], v[248:251]
  ds_read_b64_tr_b16 a[144:145], v153 offset:0
  ds_read_b64_tr_b16 a[146:147], v153 offset:2048
  v_mfma_f32_16x16x32_bf16 v[252:255], a[148:151], a[228:231], v[252:255]
  s_waitcnt lgkmcnt(8)
  v_mfma_f32_16x16x32_bf16 v[224:227], a[152:155], a[232:235], v[224:227]
  ds_read_b64_tr_b16 a[148:149], v156 offset:0
  ds_read_b64_tr_b16 a[150:151], v156 offset:2048
  v_mfma_f32_16x16x32_bf16 v[228:231], a[152:155], a[236:239], v[228:231]
  s_waitcnt lgkmcnt(8)
  buffer_load_dwordx4 v144, s[8:11], s20 offen offset:0 lds
  v_mfma_f32_16x16x32_bf16 v[232:235], a[156:159], a[232:235], v[232:235]
  ds_read_b64_tr_b16 a[152:153], v159 offset:0
  ds_read_b64_tr_b16 a[154:155], v159 offset:2048
  v_mfma_f32_16x16x32_bf16 v[236:239], a[156:159], a[236:239], v[236:239]
  s_waitcnt lgkmcnt(8)
  v_mfma_f32_16x16x32_bf16 v[240:243], a[160:163], a[232:235], v[240:243]
  ds_read_b64_tr_b16 a[156:157], v162 offset:0
  ds_read_b64_tr_b16 a[158:159], v162 offset:2048
  v_mfma_f32_16x16x32_bf16 v[244:247], a[160:163], a[236:239], v[244:247]
  s_waitcnt lgkmcnt(8)
  v_mfma_f32_16x16x32_bf16 v[248:251], a[164:167], a[232:235], v[248:251]
  ds_read_b64_tr_b16 a[160:161], v153 offset:4096
  ds_read_b64_tr_b16 a[162:163], v153 offset:6144
  v_mfma_f32_16x16x32_bf16 v[252:255], a[164:167], a[236:239], v[252:255]
  s_waitcnt vmcnt(36) lgkmcnt(8)
  v_mfma_f32_16x16x32_bf16 v[0:3], a[144:147], a[240:243], v[0:3]
  ds_read_b64_tr_b16 a[164:165], v156 offset:4096
  ds_read_b64_tr_b16 a[166:167], v156 offset:6144
  v_mfma_f32_16x16x32_bf16 v[4:7], a[144:147], a[244:247], v[4:7]
  s_waitcnt lgkmcnt(8)
  buffer_load_dwordx4 v145, s[8:11], s20 offen offset:1024 lds
  v_mfma_f32_16x16x32_bf16 v[8:11], a[148:151], a[240:243], v[8:11]
  ds_read_b64_tr_b16 a[144:145], v159 offset:4096
  ds_read_b64_tr_b16 a[146:147], v159 offset:6144
  v_mfma_f32_16x16x32_bf16 v[12:15], a[148:151], a[244:247], v[12:15]
  s_waitcnt lgkmcnt(8)
  s_cmp_lt_u32 s38, s36
  s_cbranch_scc0 K3_slow_G2six6
K3_back_G2six6:
  v_mfma_f32_16x16x32_bf16 v[16:19], a[152:155], a[240:243], v[16:19]
  ds_read_b64_tr_b16 a[148:149], v162 offset:4096
  ds_read_b64_tr_b16 a[150:151], v162 offset:6144
  v_mfma_f32_16x16x32_bf16 v[20:23], a[152:155], a[244:247], v[20:23]
  s_waitcnt lgkmcnt(8)
  buffer_load_dwordx4 a[208:211], v164, s[92:95], s38 offen offset:0 sc1
  v_mfma_f32_16x16x32_bf16 v[24:27], a[156:159], a[240:243], v[24:27]
  ds_read_b64_tr_b16 a[152:153], v153 offset:8192
  ds_read_b64_tr_b16 a[154:155], v153 offset:10240
  v_mfma_f32_16x16x32_bf16 v[28:31], a[156:159], a[244:247], v[28:31]
  s_waitcnt lgkmcnt(8)
  v_mfma_f32_16x16x32_bf16 v[32:35], a[160:163], a[240:243], v[32:35]
  ds_read_b64_tr_b16 a[156:157], v156 offset:8192
  ds_read_b64_tr_b16 a[158:159], v156 offset:10240
  v_mfma_f32_16x16x32_bf16 v[36:39], a[160:163], a[244:247], v[36:39]
  s_waitcnt lgkmcnt(8)
  buffer_load_dwordx4 v146, s[8:11], s20 offen offset:2048 lds
  v_mfma_f32_16x16x32_bf16 v[40:43], a[164:167], a[240:243], v[40:43]
  ds_read_b64_tr_b16 a[160:161], v159 offset:8192
  ds_read_b64_tr_b16 a[162:163], v159 offset:10240
  v_mfma_f32_16x16x32_bf16 v[44:47], a[164:167], a[244:247], v[44:47]
  s_waitcnt lgkmcnt(8)
  buffer_load_dwordx4 a[212:215], v164, s[92:95], s38 offen offset:1024 sc1
  v_mfma_f32_16x16x32_bf16 v[48:51], a[144:147], a[240:243], v[48:51]
  ds_read_b64_tr_b16 a[164:165], v162 offset:8192
  ds_read_b64_tr_b16 a[166:167], v162 offset:10240
  v_mfma_f32_16x16x32_bf16 v[52:55], a[144:147], a[244:247], v[52:55]
  s_waitcnt lgkmcnt(8)
  v_mfma_f32_16x16x32_bf16 v[56:59], a[148:151], a[240:243], v[56:59]
  ds_read_b64_tr_b16 a[144:145], v153 offset:12288
  ds_read_b64_tr_b16 a[146:147], v153 offset:14336
  v_mfma_f32_16x16x32_bf16 v[60:63], a[148:151], a[244:247], v[60:63]
  s_waitcnt lgkmcnt(8)
  buffer_load_dwordx4 a[216:219], v164, s[92:95], s38 offen offset:2048 sc1
  v_mfma_f32_16x16x32_bf16 v[0:3], a[152:155], a[248:251], v[0:3]
  ds_read_b64_tr_b16 a[148:149], v156 offset:12288
  ds_read_b64_tr_b16 a[150:151], v156 offset:14336
  v_mfma_f32_16x16x32_bf16 v[4:7], a[152:155], a[252:255], v[4:7]
  s_waitcnt lgkmcnt(8)
  buffer_load_dwordx4 v147, s[8:11], s20 offen offset:3072 lds
  v_mfma_f32_16x16x32_bf16 v[8:11], a[156:159], a[248:251], v[8:11]
  ds_read_b64_tr_b16 a[152:153], v159 offset:12288
  ds_read_b64_tr_b16 a[154:155], v159 offset:14336
  v_mfma_f32_16x16x32_bf16 v[12:15], a[156:159], a[252:255], v[12:15]
  s_waitcnt lgkmcnt(8)
  s_add_u32 s20, s20, s29
  s_add_u32 m0, s21, 0
  v_mfma_f32_16x16x32_bf16 v[16:19], a[160:163], a[248:251], v[16:19]
  ds_read_b64_tr_b16 a[156:157], v162 offset:12288
  ds_read_b64_tr_b16 a[158:159], v162 offset:14336
  v_mfma_f32_16x16x32_bf16 v[20:23], a[160:163], a[252:255], v[20:23]
  s_waitcnt lgkmcnt(8)
  v_mfma_f32_16x16x32_bf16 v[24:27], a[164:167], a[248:251], v[24:27]
  ds_read_b64_tr_b16 a[160:161], v153 offset:16384
  ds_read_b64_tr_b16 a[162:163], v153 offset:18432
  v_mfma_f32_16x16x32_bf16 v[28:31], a[164:167], a[252:255], v[28:31]
  s_waitcnt lgkmcnt(8)
  buffer_load_dwordx4 a[220:223], v164, s[92:95], s38 offen offset:3072 sc1
  v_mfma_f32_16x16x32_bf16 v[32:35], a[144:147], a[248:251], v[32:35]
  ds_read_b64_tr_b16 a[164:165], v156 offset:16384
  ds_read_b64_tr_b16 a[166:167], v156 offset:18432
  v_mfma_f32_16x16x32_bf16 v[36:39], a[144:147], a[252:255], v[36:39]
  s_waitcnt lgkmcnt(8)
  buffer_load_dwordx4 v144, s[8:11], s20 offen offset:0 lds
  v_mfma_f32_16x16x32_bf16 v[40:43], a[148:151], a[248:251], v[40:43]
  ds_read_b64_tr_b16 a[144:145], v159 offset:16384
  ds_read_b64_tr_b16 a[146:147], v159 offset:18432
  v_mfma_f32_16x16x32_bf16 v[44:47], a[148:151], a[252:255], v[44:47]
  s_waitcnt lgkmcnt(8)
  s_add_u32 s38, s38, 16384
  v_mfma_f32_16x16x32_bf16 v[48:51], a[152:155], a[248:251], v[48:51]
  ds_read_b64_tr_b16 a[148:149], v162 offset:16384
  ds_read_b64_tr_b16 a[150:151], v162 offset:18432
  v_mfma_f32_16x16x32_bf16 v[52:55], a[152:155], a[252:255], v[52:55]
  s_waitcnt lgkmcnt(8)
  v_mfma_f32_16x16x32_bf16 v[56:59], a[156:159], a[248:251], v[56:59]
  ds_read_b64_tr_b16 a[152:153], v153 offset:20480
  ds_read_b64_tr_b16 a[154:155], v153 offset:22528
  v_mfma_f32_16x16x32_bf16 v[60:63], a[156:159], a[252:255], v[60:63]
  s_waitcnt vmcnt(36) lgkmcnt(8)
  v_mfma_f32_16x16x32_bf16 v[0:3], a[160:163], v[192:195], v[0:3]
  ds_read_b64_tr_b16 a[156:157], v156 offset:20480
  ds_read_b64_tr_b16 a[158:159], v156 offset:22528
  v_mfma_f32_16x16x32_bf16 v[4:7], a[160:163], v[196:199], v[4:7]
  s_waitcnt lgkmcnt(8)
  buffer_load_dwordx4 v145, s[8:11], s20 offen offset:1024 lds
  v_mfma_f32_16x16x32_bf16 v[8:11], a[164:167], v[192:195], v[8:11]
  ds_read_b64_tr_b16 a[160:161], v159 offset:20480
  ds_read_b64_tr_b16 a[162:163], v159 offset:22528
  v_mfma_f32_16x16x32_bf16 v[12:15], a[164:167], v[196:199], v[12:15]
  s_waitcnt lgkmcnt(8)
  s_cmp_lt_u32 s38, s36
  s_cbranch_scc0 K3_slow_G2six7
K3_back_G2six7:
  v_mfma_f32_16x16x32_bf16 v[16:19], a[144:147], v[192:195], v[16:19]
  ds_read_b64_tr_b16 a[164:165], v162 offset:20480
  ds_read_b64_tr_b16 a[166:167], v162 offset:22528
  v_mfma_f32_16x16x32_bf16 v[20:23], a[144:147], v[196:199], v[20:23]
  s_waitcnt lgkmcnt(8)
  buffer_load_dwordx4 a[224:227], v164, s[92:95], s38 offen offset:0 sc1
  v_mfma_f32_16x16x32_bf16 v[24:27], a[148:151], v[192:195], v[24:27]
  ds_read_b64_tr_b16 a[144:145], v153 offset:24576
  ds_read_b64_tr_b16 a[146:147], v153 offset:26624
  v_mfma_f32_16x16x32_bf16 v[28:31], a[148:151], v[196:199], v[28:31]
  s_waitcnt lgkmcnt(8)
  v_mfma_f32_16x16x32_bf16 v[32:35], a[152:155], v[192:195], v[32:35]
  ds_read_b64_tr_b16 a[148:149], v156 offset:24576
  ds_read_b64_tr_b16 a[150:151], v156 offset:26624
  v_mfma_f32_16x16x32_bf16 v[36:39], a[152:155], v[196:199], v[36:39]
  s_waitcnt vmcnt(14) lgkmcnt(8)
  buffer_load_dwordx4 v146, s[8:11], s20 offen offset:2048 lds
  v_mfma_f32_16x16x32_bf16 v[40:43], a[156:159], v[192:195], v[40:43]
  ds_read_b64_tr_b16 a[152:153], v159 offset:24576
  ds_read_b64_tr_b16 a[154:155], v159 offset:26624
  v_mfma_f32_16x16x32_bf16 v[44:47], a[156:159], v[196:199], v[44:47]
  s_waitcnt lgkmcnt(8)
  buffer_load_dwordx4 a[228:231], v164, s[92:95], s38 offen offset:1024 sc1
  v_mfma_f32_16x16x32_bf16 v[48:51], a[160:163], v[192:195], v[48:51]
  ds_read_b64_tr_b16 a[156:157], v162 offset:24576
  ds_read_b64_tr_b16 a[158:159], v162 offset:26624
  v_mfma_f32_16x16x32_bf16 v[52:55], a[160:163], v[196:199], v[52:55]
  s_waitcnt lgkmcnt(8)
  v_min3_u32 v172, v172, v173, v174
  v_mfma_f32_16x16x32_bf16 v[56:59], a[164:167], v[192:195], v[56:59]
  ds_read_b64_tr_b16 a[160:161], v153 offset:28672
  ds_read_b64_tr_b16 a[162:163], v153 offset:30720
  v_mfma_f32_16x16x32_bf16 v[60:63], a[164:167], v[196:199], v[60:63]
  s_waitcnt lgkmcnt(8)
  buffer_load_dwordx4 a[232:235], v164, s[92:95], s38 offen offset:2048 sc1
  v_mfma_f32_16x16x32_bf16 v[0:3], a[144:147], v[200:203], v[0:3]
  ds_read_b64_tr_b16 a[164:165], v156 offset:28672
  ds_read_b64_tr_b16 a[166:167], v156 offset:30720
  v_mfma_f32_16x16x32_bf16 v[4:7], a[144:147], v[204:207], v[4:7]
  s_waitcnt lgkmcnt(8)
  buffer_load_dwordx4 v147, s[8:11], s20 offen offset:3072 lds
  v_mfma_f32_16x16x32_bf16 v[8:11], a[148:151], v[200:203], v[8:11]
  ds_read_b64_tr_b16 a[144:145], v159 offset:28672
  ds_read_b64_tr_b16 a[146:147], v159 offset:30720
  v_mfma_f32_16x16x32_bf16 v[12:15], a[148:151], v[204:207], v[12:15]
  s_waitcnt lgkmcnt(8)
  s_add_u32 s20, s20, s27
  s_add_u32 m0, s21, 16384
  v_mfma_f32_16x16x32_bf16 v[16:19], a[152:155], v[200:203], v[16:19]
  ds_read_b64_tr_b16 a[148:149], v162 offset:28672
  ds_read_b64_tr_b16 a[150:151], v162 offset:30720
  v_mfma_f32_16x16x32_bf16 v[20:23], a[152:155], v[204:207], v[20:23]
  s_waitcnt lgkmcnt(8)
  v_min_u32 v172, v172, v175
  v_lshlrev_b32 v173, 16, v172
  v_mfma_f32_16x16x32_bf16 v[24:27], a[156:159], v[200:203], v[24:27]
  ds_read_b64_tr_b16 a[152:153], v153 offset:32768
  ds_read_b64_tr_b16 a[154:155], v153 offset:34816
  v_mfma_f32_16x16x32_bf16 v[28:31], a[156:159], v[204:207], v[28:31]
  s_waitcnt lgkmcnt(8)
  buffer_load_dwordx4 a[236:239], v164, s[92:95], s38 offen offset:3072 sc1
  v_mfma_f32_16x16x32_bf16 v[32:35], a[160:163], v[200:203], v[32:35]
  ds_read_b64_tr_b16 a[156:157], v156 offset:32768
  ds_read_b64_tr_b16 a[158:159], v156 offset:34816
  v_mfma_f32_16x16x32_bf16 v[36:39], a[160:163], v[204:207], v[36:39]
  s_waitcnt lgkmcnt(8)
  buffer_load_dwordx4 v144, s[8:11], s20 offen offset:0 lds
  v_mfma_f32_16x16x32_bf16 v[40:43], a[164:167], v[200:203], v[40:43]
  ds_read_b64_tr_b16 a[160:161], v159 offset:32768
  ds_read_b64_tr_b16 a[162:163], v159 offset:34816
  v_mfma_f32_16x16x32_bf16 v[44:47], a[164:167], v[204:207], v[44:47]
  s_waitcnt lgkmcnt(8)
  s_add_u32 s38, s38, 16384
  v_mfma_f32_16x16x32_bf16 v[48:51], a[144:147], v[200:203], v[48:51]
  ds_read_b64_tr_b16 a[164:165], v162 offset:32768
  ds_read_b64_tr_b16 a[166:167], v162 offset:34816
  v_mfma_f32_16x16x32_bf16 v[52:55], a[144:147], v[204:207], v[52:55]
  s_waitcnt lgkmcnt(8)
  s_nop 0
  v_readfirstlane_b32 s36, v173
  v_mfma_f32_16x16x32_bf16 v[56:59], a[148:151], v[200:203], v[56:59]
  ds_read_b64_tr_b16 a[144:145], v153 offset:36864
  ds_read_b64_tr_b16 a[146:147], v153 offset:38912
  v_mfma_f32_16x16x32_bf16 v[60:63], a[148:151], v[204:207], v[60:63]
  s_waitcnt lgkmcnt(8)
  buffer_load_dwordx4 v[172:175], off, s[12:15], s33 sc1
  v_mfma_f32_16x16x32_bf16 v[224:227], a[152:155], a[240:243], v[224:227]
  ds_read_b64_tr_b16 a[148:149], v156 offset:36864
  ds_read_b64_tr_b16 a[150:151], v156 offset:38912
  v_mfma_f32_16x16x32_bf16 v[228:231], a[152:155], a[244:247], v[228:231]
  s_waitcnt lgkmcnt(8)
  buffer_load_dwordx4 v145, s[8:11], s20 offen offset:1024 lds
  v_mfma_f32_16x16x32_bf16 v[232:235], a[156:159], a[240:243], v[232:235]
  ds_read_b64_tr_b16 a[152:153], v159 offset:36864
  ds_read_b64_tr_b16 a[154:155], v159 offset:38912
  v_mfma_f32_16x16x32_bf16 v[236:239], a[156:159], a[244:247], v[236:239]
  s_waitcnt lgkmcnt(8)
  v_mfma_f32_16x16x32_bf16 v[240:243], a[160:163], a[240:243], v[240:243]
  ds_read_b64_tr_b16 a[156:157], v162 offset:36864
  ds_read_b64_tr_b16 a[158:159], v162 offset:38912
  v_mfma_f32_16x16x32_bf16 v[244:247], a[160:163], a[244:247], v[244:247]
  s_waitcnt lgkmcnt(8)
  v_mfma_f32_16x16x32_bf16 v[248:251], a[164:167], a[240:243], v[248:251]
  ds_read_b64_tr_b16 a[160:161], v153 offset:40960
  ds_read_b64_tr_b16 a[162:163], v153 offset:43008
  v_mfma_f32_16x16x32_bf16 v[252:255], a[164:167], a[244:247], v[252:255]
  s_waitcnt lgkmcnt(8)
  v_mfma_f32_16x16x32_bf16 v[224:227], a[144:147], a[248:251], v[224:227]
  ds_read_b64_tr_b16 a[164:165], v156 offset:40960
  ds_read_b64_tr_b16 a[166:167], v156 offset:43008
  v_mfma_f32_16x16x32_bf16 v[228:231], a[144:147], a[252:255], v[228:231]
  s_waitcnt lgkmcnt(8)
  buffer_load_dwordx4 v146, s[8:11], s20 offen offset:2048 lds
  v_mfma_f32_16x16x32_bf16 v[232:235], a[148:151], a[248:251], v[232:235]
  ds_read_b64_tr_b16 a[144:145], v159 offset:40960
  ds_read_b64_tr_b16 a[146:147], v159 offset:43008
  v_mfma_f32_16x16x32_bf16 v[236:239], a[148:151], a[252:255], v[236:239]
  s_waitcnt lgkmcnt(8)
  v_mfma_f32_16x16x32_bf16 v[240:243], a[152:155], a[248:251], v[240:243]
  ds_read_b64_tr_b16 a[148:149], v162 offset:40960
  ds_read_b64_tr_b16 a[150:151], v162 offset:43008
  v_mfma_f32_16x16x32_bf16 v[244:247], a[152:155], a[252:255], v[244:247]
  s_waitcnt lgkmcnt(8)
  v_mfma_f32_16x16x32_bf16 v[248:251], a[156:159], a[248:251], v[248:251]
  ds_read_b64_tr_b16 a[152:153], v153 offset:45056
  ds_read_b64_tr_b16 a[154:155], v153 offset:47104
  v_mfma_f32_16x16x32_bf16 v[252:255], a[156:159], a[252:255], v[252:255]
  s_waitcnt lgkmcnt(8)
  v_mfma_f32_16x16x32_bf16 v[224:227], a[160:163], v[192:195], v[224:227]
  ds_read_b64_tr_b16 a[156:157], v156 offset:45056
  ds_read_b64_tr_b16 a[158:159], v156 offset:47104
  v_mfma_f32_16x16x32_bf16 v[228:231], a[160:163], v[196:199], v[228:231]
  s_waitcnt lgkmcnt(8)
  buffer_load_dwordx4 v147, s[8:11], s20 offen offset:3072 lds
  v_mfma_f32_16x16x32_bf16 v[232:235], a[164:167], v[192:195], v[232:235]
  ds_read_b64_tr_b16 a[160:161], v159 offset:45056
  ds_read_b64_tr_b16 a[162:163], v159 offset:47104
  v_mfma_f32_16x16x32_bf16 v[236:239], a[164:167], v[196:199], v[236:239]
  s_waitcnt lgkmcnt(8)
  s_add_u32 s20, s20, s28
  s_add_u32 m0, s21, 32768
  v_mfma_f32_16x16x32_bf16 v[240:243], a[144:147], v[192:195], v[240:243]
  ds_read_b64_tr_b16 a[164:165], v162 offset:45056
  ds_read_b64_tr_b16 a[166:167], v162 offset:47104
  v_mfma_f32_16x16x32_bf16 v[244:247], a[144:147], v[196:199], v[244:247]
  s_waitcnt vmcnt(14) lgkmcnt(8)
  s_barrier
  v_mfma_f32_16x16x32_bf16 v[248:251], a[148:151], v[192:195], v[248:251]
  ds_read_b64_tr_b16 a[144:145], v154 offset:0
  ds_read_b64_tr_b16 a[146:147], v154 offset:2048
  v_mfma_f32_16x16x32_bf16 v[252:255], a[148:151], v[196:199], v[252:255]
  s_waitcnt lgkmcnt(8)
  v_mfma_f32_16x16x32_bf16 v[224:227], a[152:155], v[200:203], v[224:227]
  ds_read_b64_tr_b16 a[148:149], v157 offset:0
  ds_read_b64_tr_b16 a[150:151], v157 offset:2048
  v_mfma_f32_16x16x32_bf16 v[228:231], a[152:155], v[204:207], v[228:231]
  s_waitcnt lgkmcnt(8)
  buffer_load_dwordx4 v144, s[8:11], s20 offen offset:0 lds
  v_mfma_f32_16x16x32_bf16 v[232:235], a[156:159], v[200:203], v[232:235]
  ds_read_b64_tr_b16 a[152:153], v160 offset:0
  ds_read_b64_tr_b16 a[154:155], v160 offset:2048
  v_mfma_f32_16x16x32_bf16 v[236:239], a[156:159], v[204:207], v[236:239]
  s_waitcnt lgkmcnt(8)
  v_mfma_f32_16x16x32_bf16 v[240:243], a[160:163], v[200:203], v[240:243]
  ds_read_b64_tr_b16 a[156:157], v163 offset:0
  ds_read_b64_tr_b16 a[158:159], v163 offset:2048
  v_mfma_f32_16x16x32_bf16 v[244:247], a[160:163], v[204:207], v[244:247]
  s_waitcnt lgkmcnt(8)
  s_sub_u32 s60, s60, 1
  v_mfma_f32_16x16x32_bf16 v[248:251], a[164:167], v[200:203], v[248:251]
  ds_read_b64_tr_b16 a[160:161], v154 offset:4096
  ds_read_b64_tr_b16 a[162:163], v154 offset:6144
  v_mfma_f32_16x16x32_bf16 v[252:255], a[164:167], v[204:207], v[252:255]
  s_waitcnt vmcnt(35) lgkmcnt(8)
  s_cmp_eq_u32 s60, 0
  s_cbranch_scc0 K3_G2six
  s_branch K3_final
K3_r2A:
  v_add_f32 v238, v238, v240
  v_add_f32 v238, v238, v242
  v_add_f32 v238, v238, v244
  v_add_f32 v238, v238, v246
  v_add_f32 v238, v238, v248
  v_add_f32 v238, v238, v250
  v_add_f32 v238, v238, v252
  v_mov_b32 v166, 0x3727c5ac
  v_fmac_f32 v166, 0x3ae38e39, v238
  v_rcp_f32 v166, v166
  v_add_f32 v239, v239, v241
  v_add_f32 v239, v239, v243
  v_add_f32 v239, v239, v245
  v_add_f32 v239, v239, v247
  v_add_f32 v239, v239, v249
  v_add_f32 v239, v239, v251
  v_add_f32 v239, v239, v253
  v_mov_b32 v167, 0x3727c5ac
  v_fmac_f32 v167, 0x3ae38e39, v239
  v_rcp_f32 v167, v167
  v_mov_b64 v[224:225], 0
  v_mov_b64 v[226:227], 0
  v_mov_b64 v[228:229], 0
  v_mov_b64 v[230:231], 0
  v_mov_b64 v[232:233], 0
  v_mov_b64 v[234:235], 0
  v_mov_b64 v[236:237], 0
  v_mov_b64 v[238:239], 0
  v_mov_b64 v[240:241], 0
  v_mov_b64 v[242:243], 0
  v_mov_b64 v[244:245], 0
  v_mov_b64 v[246:247], 0
  v_mov_b64 v[248:249], 0
  v_mov_b64 v[250:251], 0
  v_mov_b64 v[252:253], 0
  v_mov_b64 v[254:255], 0
  s_branch K3_r2backA
K3_r2B:
  v_add_f32 v238, v238, v240
  v_add_f32 v238, v238, v242
  v_add_f32 v238, v238, v244
  v_add_f32 v238, v238, v246
  v_add_f32 v238, v238, v248
  v_add_f32 v238, v238, v250
  v_add_f32 v238, v238, v252
  v_mov_b32 v166, 0x3727c5ac
  v_fmac_f32 v166, 0x3ae38e39, v238
  v_rcp_f32 v166, v166
  v_add_f32 v239, v239, v241
  v_add_f32 v239, v239, v243
  v_add_f32 v239, v239, v245
  v_add_f32 v239, v239, v247
  v_add_f32 v239, v239, v249
  v_add_f32 v239, v239, v251
  v_add_f32 v239, v239, v253
  v_mov_b32 v167, 0x3727c5ac
  v_fmac_f32 v167, 0x3ae38e39, v239
  v_rcp_f32 v167, v167
  v_mov_b64 v[224:225], 0
  v_mov_b64 v[226:227], 0
  v_mov_b64 v[228:229], 0
  v_mov_b64 v[230:231], 0
  v_mov_b64 v[232:233], 0
  v_mov_b64 v[234:235], 0
  v_mov_b64 v[236:237], 0
  v_mov_b64 v[238:239], 0
  v_mov_b64 v[240:241], 0
  v_mov_b64 v[242:243], 0
  v_mov_b64 v[244:245], 0
  v_mov_b64 v[246:247], 0
  v_mov_b64 v[248:249], 0
  v_mov_b64 v[250:251], 0
  v_mov_b64 v[252:253], 0
  v_mov_b64 v[254:255], 0
  s_branch K3_r2backB
K3_switch:
  s_mov_b32 s8, s16
  s_mov_b32 s9, s17
  s_mov_b32 s10, s18
  s_mov_b32 s11, s19
  v_mov_b32 v144, v148
  v_mov_b32 v145, v149
  v_mov_b32 v146, v150
  v_mov_b32 v147, v151
  s_mov_b32 s20, s39
  s_mov_b32 s27, s40
  s_mov_b32 s28, s41
  s_mov_b32 s29, s42
  s_branch K3_switch_back
K3_hsA:
  s_waitcnt vmcnt(17)
  v_min3_u32 v172, v172, v173, v174
  v_min_u32 v172, v172, v175
  v_lshlrev_b32 v173, 16, v172
  s_nop 0
  v_readfirstlane_b32 s36, v173
  s_cmp_lt_u32 s38, s36
  s_cbranch_scc0 K3_slow_hs0
K3_back_hs0:
  s_mov_b32 s43, s38
  s_add_u32 s38, s38, 65536
  s_branch K3_hsbackA
K3_hsB:
  s_cmp_eq_u32 s32, 3
  s_cbranch_scc1 K3_hsbackB
  s_waitcnt vmcnt(17)
  v_min3_u32 v172, v172, v173, v174
  v_min_u32 v172, v172, v175
  v_lshlrev_b32 v173, 16, v172
  s_nop 0
  v_readfirstlane_b32 s36, v173
  s_cmp_lt_u32 s38, s36
  s_cbranch_scc0 K3_slow_hs1
K3_back_hs1:
  s_mov_b32 s43, s38
  s_add_u32 s38, s38, 65536
  s_branch K3_hsbackB
K3_slow_four8:
  buffer_load_dwordx4 v[172:175], off, s[12:15], s33 sc1
  s_waitcnt vmcnt(0)
  v_min3_u32 v172, v172, v173, v174
  v_min_u32 v172, v172, v175
  v_lshlrev_b32 v173, 16, v172
  s_nop 0
  v_readfirstlane_b32 s36, v173
  s_cmp_lt_u32 s38, s36
  s_cbranch_scc0 K3_slow_four8
  s_branch K3_back_four8
K3_slow_four12:
  buffer_load_dwordx4 v[172:175], off, s[12:15], s33 sc1
  s_waitcnt vmcnt(0)
  v_min3_u32 v172, v172, v173, v174
  v_min_u32 v172, v172, v175
  v_lshlrev_b32 v173, 16, v172
  s_nop 0
  v_readfirstlane_b32 s36, v173
  s_cmp_lt_u32 s38, s36
  s_cbranch_scc0 K3_slow_four12
  s_branch K3_back_four12
K3_slow_four16:
  buffer_load_dwordx4 v[172:175], off, s[12:15], s33 sc1
  s_waitcnt vmcnt(0)
  v_min3_u32 v172, v172, v173, v174
  v_min_u32 v172, v172, v175
  v_lshlrev_b32 v173, 16, v172
  s_nop 0
  v_readfirstlane_b32 s36, v173
  s_cmp_lt_u32 s38, s36
  s_cbranch_scc0 K3_slow_four16
  s_branch K3_back_four16
K3_slow_G2six0:
  buffer_load_dwordx4 v[172:175], off, s[12:15], s33 sc1
  s_waitcnt vmcnt(0)
  v_min3_u32 v172, v172, v173, v174
  v_min_u32 v172, v172, v175
  v_lshlrev_b32 v173, 16, v172
  s_nop 0
  v_readfirstlane_b32 s36, v173
  s_cmp_lt_u32 s38, s36
  s_cbranch_scc0 K3_slow_G2six0
  s_branch K3_back_G2six0
K3_slow_G2six1:
  buffer_load_dwordx4 v[172:175], off, s[12:15], s33 sc1
  s_waitcnt vmcnt(0)
  v_min3_u32 v172, v172, v173, v174
  v_min_u32 v172, v172, v175
  v_lshlrev_b32 v173, 16, v172
  s_nop 0
  v_readfirstlane_b32 s36, v173
  s_cmp_lt_u32 s38, s36
  s_cbranch_scc0 K3_slow_G2six1
  s_branch K3_back_G2six1
K3_slow_G2six3:
  buffer_load_dwordx4 v[172:175], off, s[12:15], s33 sc1
  s_waitcnt vmcnt(0)
  v_min3_u32 v172, v172, v173, v174
  v_min_u32 v172, v172, v175
  v_lshlrev_b32 v173, 16, v172
  s_nop 0
  v_readfirstlane_b32 s36, v173
  s_cmp_lt_u32 s38, s36
  s_cbranch_scc0 K3_slow_G2six3
  s_branch K3_back_G2six3
K3_slow_G2six4:
  buffer_load_dwordx4 v[172:175], off, s[12:15], s33 sc1
  s_waitcnt vmcnt(0)
  v_min3_u32 v172, v172, v173, v174
  v_min_u32 v172, v172, v175
  v_lshlrev_b32 v173, 16, v172
  s_nop 0
  v_readfirstlane_b32 s36, v173
  s_cmp_lt_u32 s38, s36
  s_cbranch_scc0 K3_slow_G2six4
  s_branch K3_back_G2six4
K3_slow_G2six6:
  buffer_load_dwordx4 v[172:175], off, s[12:15], s33 sc1
  s_waitcnt vmcnt(0)
  v_min3_u32 v172, v172, v173, v174
  v_min_u32 v172, v172, v175
  v_lshlrev_b32 v173, 16, v172
  s_nop 0
  v_readfirstlane_b32 s36, v173
  s_cmp_lt_u32 s38, s36
  s_cbranch_scc0 K3_slow_G2six6
  s_branch K3_back_G2six6
K3_slow_G2six7:
  buffer_load_dwordx4 v[172:175], off, s[12:15], s33 sc1
  s_waitcnt vmcnt(0)
  v_min3_u32 v172, v172, v173, v174
  v_min_u32 v172, v172, v175
  v_lshlrev_b32 v173, 16, v172
  s_nop 0
  v_readfirstlane_b32 s36, v173
  s_cmp_lt_u32 s38, s36
  s_cbranch_scc0 K3_slow_G2six7
  s_branch K3_back_G2six7
K3_slow_hs0:
  buffer_load_dwordx4 v[172:175], off, s[12:15], s33 sc1
  s_waitcnt vmcnt(0)
  v_min3_u32 v172, v172, v173, v174
  v_min_u32 v172, v172, v175
  v_lshlrev_b32 v173, 16, v172
  s_nop 0
  v_readfirstlane_b32 s36, v173
  s_cmp_lt_u32 s38, s36
  s_cbranch_scc0 K3_slow_hs0
  s_branch K3_back_hs0
K3_slow_hs1:
  buffer_load_dwordx4 v[172:175], off, s[12:15], s33 sc1
  s_waitcnt vmcnt(0)
  v_min3_u32 v172, v172, v173, v174
  v_min_u32 v172, v172, v175
  v_lshlrev_b32 v173, 16, v172
  s_nop 0
  v_readfirstlane_b32 s36, v173
  s_cmp_lt_u32 s38, s36
  s_cbranch_scc0 K3_slow_hs1
  s_branch K3_back_hs1
K3_final:
  s_mul_i32 s48, s31, 18
  s_lshl_b32 s49, s32, 2
  s_add_u32 s48, s48, s49
  s_lshl_b32 s48, s48, 15
  s_lshl_b32 s49, s25, 11
  s_add_u32 s48, s48, s49
  s_add_u32 s48, s48, 29360128
  s_lshl_b32 s50, s30, 13
  s_lshl_b32 s24, s31, 2
  s_add_u32 s24, s24, s25
  s_mul_i32 s52, s24, 36864
  s_lshl_b32 s53, s32, 2
  s_add_u32 s53, s53, s30
  s_lshl_b32 s54, s53, 11
  s_add_u32 s54, s54, s52
  buffer_load_dwordx4 v[96:99], v164, s[12:15], s54 offen offset:0 sc1
  buffer_load_dwordx4 v[100:103], v164, s[12:15], s54 offen offset:1024 sc1
  s_and_b32 s55, s30, 1
  s_add_u32 s55, s55, 16
  s_lshl_b32 s54, s55, 11
  s_add_u32 s54, s54, s52
  buffer_load_dwordx4 v[104:107], v164, s[12:15], s54 offen offset:0 sc1
  buffer_load_dwordx4 v[108:111], v164, s[12:15], s54 offen offset:1024 sc1
  s_xor_b32 s51, s30, 1
  s_lshl_b32 s51, s51, 15
  s_add_u32 s51, s51, s48
  s_add_u32 s51, s51, s50
  v_mul_f32 v16, v16, v166
  v_mul_f32 v17, v17, v166
  v_cvt_pk_bf16_f32 v136, v16, v17
  v_mul_f32 v18, v18, v166
  v_mul_f32 v19, v19, v166
  v_cvt_pk_bf16_f32 v137, v18, v19
  v_mul_f32 v24, v24, v166
  v_mul_f32 v25, v25, v166
  v_cvt_pk_bf16_f32 v138, v24, v25
  v_mul_f32 v26, v26, v166
  v_mul_f32 v27, v27, v166
  v_cvt_pk_bf16_f32 v139, v26, v27
  buffer_store_dwordx4 v[136:139], v164, s[12:15], s51 offen offset:0 sc1
  v_mul_f32 v20, v20, v167
  v_mul_f32 v21, v21, v167
  v_cvt_pk_bf16_f32 v140, v20, v21
  v_mul_f32 v22, v22, v167
  v_mul_f32 v23, v23, v167
  v_cvt_pk_bf16_f32 v141, v22, v23
  v_mul_f32 v28, v28, v167
  v_mul_f32 v29, v29, v167
  v_cvt_pk_bf16_f32 v142, v28, v29
  v_mul_f32 v30, v30, v167
  v_mul_f32 v31, v31, v167
  v_cvt_pk_bf16_f32 v143, v30, v31
  buffer_store_dwordx4 v[140:143], v164, s[12:15], s51 offen offset:1024 sc1
  s_xor_b32 s51, s30, 2
  s_lshl_b32 s51, s51, 15
  s_add_u32 s51, s51, s48
  s_add_u32 s51, s51, s50
  v_mul_f32 v32, v32, v166
  v_mul_f32 v33, v33, v166
  v_cvt_pk_bf16_f32 v128, v32, v33
  v_mul_f32 v34, v34, v166
  v_mul_f32 v35, v35, v166
  v_cvt_pk_bf16_f32 v129, v34, v35
  v_mul_f32 v40, v40, v166
  v_mul_f32 v41, v41, v166
  v_cvt_pk_bf16_f32 v130, v40, v41
  v_mul_f32 v42, v42, v166
  v_mul_f32 v43, v43, v166
  v_cvt_pk_bf16_f32 v131, v42, v43
  buffer_store_dwordx4 v[128:131], v164, s[12:15], s51 offen offset:0 sc1
  v_mul_f32 v36, v36, v167
  v_mul_f32 v37, v37, v167
  v_cvt_pk_bf16_f32 v132, v36, v37
  v_mul_f32 v38, v38, v167
  v_mul_f32 v39, v39, v167
  v_cvt_pk_bf16_f32 v133, v38, v39
  v_mul_f32 v44, v44, v167
  v_mul_f32 v45, v45, v167
  v_cvt_pk_bf16_f32 v134, v44, v45
  v_mul_f32 v46, v46, v167
  v_mul_f32 v47, v47, v167
  v_cvt_pk_bf16_f32 v135, v46, v47
  buffer_store_dwordx4 v[132:135], v164, s[12:15], s51 offen offset:1024 sc1
  s_xor_b32 s51, s30, 3
  s_lshl_b32 s51, s51, 15
  s_add_u32 s51, s51, s48
  s_add_u32 s51, s51, s50
  v_mul_f32 v48, v48, v166
  v_mul_f32 v49, v49, v166
  v_cvt_pk_bf16_f32 v136, v48, v49
  v_mul_f32 v50, v50, v166
  v_mul_f32 v51, v51, v166
  v_cvt_pk_bf16_f32 v137, v50, v51
  v_mul_f32 v56, v56, v166
  v_mul_f32 v57, v57, v166
  v_cvt_pk_bf16_f32 v138, v56, v57
  v_mul_f32 v58, v58, v166
  v_mul_f32 v59, v59, v166
  v_cvt_pk_bf16_f32 v139, v58, v59
  buffer_store_dwordx4 v[136:139], v164, s[12:15], s51 offen offset:0 sc1
  v_mul_f32 v52, v52, v167
  v_mul_f32 v53, v53, v167
  v_cvt_pk_bf16_f32 v140, v52, v53
  v_mul_f32 v54, v54, v167
  v_mul_f32 v55, v55, v167
  v_cvt_pk_bf16_f32 v141, v54, v55
  v_mul_f32 v60, v60, v167
  v_mul_f32 v61, v61, v167
  v_cvt_pk_bf16_f32 v142, v60, v61
  v_mul_f32 v62, v62, v167
  v_mul_f32 v63, v63, v167
  v_cvt_pk_bf16_f32 v143, v62, v63
  buffer_store_dwordx4 v[140:143], v164, s[12:15], s51 offen offset:1024 sc1
  s_cmp_eq_u32 s32, 3
  s_cbranch_scc0 K3_sent
  s_and_b32 s51, s30, 1
  s_xor_b32 s52, s51, 5
  s_lshl_b32 s52, s52, 15
  s_add_u32 s52, s52, s48
  s_add_u32 s52, s52, s50
  v_mul_f32 v240, v240, v166
  v_mul_f32 v241, v241, v166
  v_cvt_pk_bf16_f32 v136, v240, v241
  v_mul_f32 v242, v242, v166
  v_mul_f32 v243, v243, v166
  v_cvt_pk_bf16_f32 v137, v242, v243
  v_mul_f32 v248, v248, v166
  v_mul_f32 v249, v249, v166
  v_cvt_pk_bf16_f32 v138, v248, v249
  v_mul_f32 v250, v250, v166
  v_mul_f32 v251, v251, v166
  v_cvt_pk_bf16_f32 v139, v250, v251
  buffer_store_dwordx4 v[136:139], v164, s[12:15], s52 offen offset:0 sc1
  v_mul_f32 v244, v244, v167
  v_mul_f32 v245, v245, v167
  v_cvt_pk_bf16_f32 v140, v244, v245
  v_mul_f32 v246, v246, v167
  v_mul_f32 v247, v247, v167
  v_cvt_pk_bf16_f32 v141, v246, v247
  v_mul_f32 v252, v252, v167
  v_mul_f32 v253, v253, v167
  v_cvt_pk_bf16_f32 v142, v252, v253
  v_mul_f32 v254, v254, v167
  v_mul_f32 v255, v255, v167
  v_cvt_pk_bf16_f32 v143, v254, v255
  buffer_store_dwordx4 v[140:143], v164, s[12:15], s52 offen offset:1024 sc1
  s_cmp_lt_u32 s30, 2
  s_cbranch_scc0 K3_sent
  s_add_u32 s52, s51, 4
  s_lshl_b32 s52, s52, 15
  s_add_u32 s52, s52, s48
  s_add_u32 s52, s52, s50
  v_mul_f32 v224, v224, v166
  v_mul_f32 v225, v225, v166
  v_cvt_pk_bf16_f32 v128, v224, v225
  v_mul_f32 v226, v226, v166
  v_mul_f32 v227, v227, v166
  v_cvt_pk_bf16_f32 v129, v226, v227
  v_mul_f32 v232, v232, v166
  v_mul_f32 v233, v233, v166
  v_cvt_pk_bf16_f32 v130, v232, v233
  v_mul_f32 v234, v234, v166
  v_mul_f32 v235, v235, v166
  v_cvt_pk_bf16_f32 v131, v234, v235
  buffer_store_dwordx4 v[128:131], v164, s[12:15], s52 offen offset:0 sc1
  v_mul_f32 v228, v228, v167
  v_mul_f32 v229, v229, v167
  v_cvt_pk_bf16_f32 v132, v228, v229
  v_mul_f32 v230, v230, v167
  v_mul_f32 v231, v231, v167
  v_cvt_pk_bf16_f32 v133, v230, v231
  v_mul_f32 v236, v236, v167
  v_mul_f32 v237, v237, v167
  v_cvt_pk_bf16_f32 v134, v236, v237
  v_mul_f32 v238, v238, v167
  v_mul_f32 v239, v239, v167
  v_cvt_pk_bf16_f32 v135, v238, v239
  buffer_store_dwordx4 v[132:135], v164, s[12:15], s52 offen offset:1024 sc1
K3_sent:
  s_lshl_b32 s33, s31, 2
  s_add_u32 s33, s33, s32
  s_lshl_b32 s33, s33, 7
  s_add_u32 s33, s33, 6430720
  s_lshl_b32 s34, s30, 2
  s_add_u32 s34, s34, s33
  s_cmp_eq_u32 s25, 0
  s_cselect_b32 s34, s34, 268435456
  v_mov_b32 v178, 1
  s_waitcnt vmcnt(6)
  v_lshlrev_b32 v180, 16, v96
  v_and_b32 v181, 0xffff0000, v96
  v_add_f32 v180, v180, v168
  v_add_f32 v181, v181, v168
  v_fma_f32 v0, v0, v166, v180
  v_fma_f32 v1, v1, v166, v181
  v_lshlrev_b32 v180, 16, v97
  v_and_b32 v181, 0xffff0000, v97
  v_add_f32 v180, v180, v168
  v_add_f32 v181, v181, v168
  v_fma_f32 v2, v2, v166, v180
  v_fma_f32 v3, v3, v166, v181
  v_lshlrev_b32 v180, 16, v98
  v_and_b32 v181, 0xffff0000, v98
  v_add_f32 v180, v180, v168
  v_add_f32 v181, v181, v168
  v_fma_f32 v8, v8, v166, v180
  v_fma_f32 v9, v9, v166, v181
  v_lshlrev_b32 v180, 16, v99
  v_and_b32 v181, 0xffff0000, v99
  v_add_f32 v180, v180, v168
  v_add_f32 v181, v181, v168
  v_fma_f32 v10, v10, v166, v180
  v_fma_f32 v11, v11, v166, v181
  v_lshlrev_b32 v180, 16, v100
  v_and_b32 v181, 0xffff0000, v100
  v_add_f32 v180, v180, v169
  v_add_f32 v181, v181, v169
  v_fma_f32 v4, v4, v167, v180
  v_fma_f32 v5, v5, v167, v181
  v_lshlrev_b32 v180, 16, v101
  v_and_b32 v181, 0xffff0000, v101
  v_add_f32 v180, v180, v169
  v_add_f32 v181, v181, v169
  v_fma_f32 v6, v6, v167, v180
  v_fma_f32 v7, v7, v167, v181
  v_lshlrev_b32 v180, 16, v102
  v_and_b32 v181, 0xffff0000, v102
  v_add_f32 v180, v180, v169
  v_add_f32 v181, v181, v169
  v_fma_f32 v12, v12, v167, v180
  v_fma_f32 v13, v13, v167, v181
  v_lshlrev_b32 v180, 16, v103
  v_and_b32 v181, 0xffff0000, v103
  v_add_f32 v180, v180, v169
  v_add_f32 v181, v181, v169
  v_fma_f32 v14, v14, v167, v180
  v_fma_f32 v15, v15, v167, v181
  s_waitcnt vmcnt(0)
  s_barrier
  buffer_store_dword v178, v165, s[12:15], s34 offen sc1
  v_lshlrev_b32 v180, 16, v104
  v_and_b32 v181, 0xffff0000, v104
  v_add_f32 v180, v180, v168
  v_add_f32 v181, v181, v168
  v_fma_f32 v224, v224, v166, v180
  v_fma_f32 v225, v225, v166, v181
  v_lshlrev_b32 v180, 16, v105
  v_and_b32 v181, 0xffff0000, v105
  v_add_f32 v180, v180, v168
  v_add_f32 v181, v181, v168
  v_fma_f32 v226, v226, v166, v180
  v_fma_f32 v227, v227, v166, v181
  v_lshlrev_b32 v180, 16, v106
  v_and_b32 v181, 0xffff0000, v106
  v_add_f32 v180, v180, v168
  v_add_f32 v181, v181, v168
  v_fma_f32 v232, v232, v166, v180
  v_fma_f32 v233, v233, v166, v181
  v_lshlrev_b32 v180, 16, v107
  v_and_b32 v181, 0xffff0000, v107
  v_add_f32 v180, v180, v168
  v_add_f32 v181, v181, v168
  v_fma_f32 v234, v234, v166, v180
  v_fma_f32 v235, v235, v166, v181
  v_lshlrev_b32 v180, 16, v108
  v_and_b32 v181, 0xffff0000, v108
  v_add_f32 v180, v180, v169
  v_add_f32 v181, v181, v169
  v_fma_f32 v228, v228, v167, v180
  v_fma_f32 v229, v229, v167, v181
  v_lshlrev_b32 v180, 16, v109
  v_and_b32 v181, 0xffff0000, v109
  v_add_f32 v180, v180, v169
  v_add_f32 v181, v181, v169
  v_fma_f32 v230, v230, v167, v180
  v_fma_f32 v231, v231, v167, v181
  v_lshlrev_b32 v180, 16, v110
  v_and_b32 v181, 0xffff0000, v110
  v_add_f32 v180, v180, v169
  v_add_f32 v181, v181, v169
  v_fma_f32 v236, v236, v167, v180
  v_fma_f32 v237, v237, v167, v181
  v_lshlrev_b32 v180, 16, v111
  v_and_b32 v181, 0xffff0000, v111
  v_add_f32 v180, v180, v169
  v_add_f32 v181, v181, v169
  v_fma_f32 v238, v238, v167, v180
  v_fma_f32 v239, v239, v167, v181
  v_bfe_u32 v179, v164, 4, 4
  s_movk_i32 s54, 1152
  v_mul_u32_u24 v179, s54, v179
  v_lshrrev_b32 v177, 8, v164
  v_lshl_add_u32 v179, v177, 3, v179
  v_add_u32 v182, 18432, v179
  s_mul_i32 s51, s24, 36864
K3_poll2:
  buffer_load_dwordx4 v[172:175], off, s[12:15], s33 sc1
  s_waitcnt vmcnt(0)
  v_and_b32 v172, v172, v173
  v_and_b32 v174, v174, v175
  v_and_b32 v172, v172, v174
  s_nop 0
  v_readfirstlane_b32 s44, v172
  s_cmp_eq_u32 s44, 1
  s_cbranch_scc0 K3_poll2
  s_lshl_b32 s45, s30, 15
  s_add_u32 s45, s45, s48
  s_xor_b32 s46, s30, 1
  s_lshl_b32 s46, s46, 13
  s_add_u32 s46, s46, s45
  buffer_load_dwordx4 v[16:19], v164, s[12:15], s46 offen offset:0 sc1
  buffer_load_dwordx4 v[20:23], v164, s[12:15], s46 offen offset:1024 sc1
  s_xor_b32 s46, s30, 2
  s_lshl_b32 s46, s46, 13
  s_add_u32 s46, s46, s45
  buffer_load_dwordx4 v[24:27], v164, s[12:15], s46 offen offset:0 sc1
  buffer_load_dwordx4 v[28:31], v164, s[12:15], s46 offen offset:1024 sc1
  s_xor_b32 s46, s30, 3
  s_lshl_b32 s46, s46, 13
  s_add_u32 s46, s46, s45
  buffer_load_dwordx4 v[32:35], v164, s[12:15], s46 offen offset:0 sc1
  buffer_load_dwordx4 v[36:39], v164, s[12:15], s46 offen offset:1024 sc1
  s_waitcnt vmcnt(4)
  v_lshlrev_b32 v180, 16, v16
  v_and_b32 v181, 0xffff0000, v16
  v_add_f32 v0, v0, v180
  v_add_f32 v1, v1, v181
  v_lshlrev_b32 v180, 16, v17
  v_and_b32 v181, 0xffff0000, v17
  v_add_f32 v2, v2, v180
  v_add_f32 v3, v3, v181
  v_lshlrev_b32 v180, 16, v18
  v_and_b32 v181, 0xffff0000, v18
  v_add_f32 v8, v8, v180
  v_add_f32 v9, v9, v181
  v_lshlrev_b32 v180, 16, v19
  v_and_b32 v181, 0xffff0000, v19
  v_add_f32 v10, v10, v180
  v_add_f32 v11, v11, v181
  v_lshlrev_b32 v180, 16, v20
  v_and_b32 v181, 0xffff0000, v20
  v_add_f32 v4, v4, v180
  v_add_f32 v5, v5, v181
  v_lshlrev_b32 v180, 16, v21
  v_and_b32 v181, 0xffff0000, v21
  v_add_f32 v6, v6, v180
  v_add_f32 v7, v7, v181
  v_lshlrev_b32 v180, 16, v22
  v_and_b32 v181, 0xffff0000, v22
  v_add_f32 v12, v12, v180
  v_add_f32 v13, v13, v181
  v_lshlrev_b32 v180, 16, v23
  v_and_b32 v181, 0xffff0000, v23
  v_add_f32 v14, v14, v180
  v_add_f32 v15, v15, v181
  s_waitcnt vmcnt(2)
  v_lshlrev_b32 v180, 16, v24
  v_and_b32 v181, 0xffff0000, v24
  v_add_f32 v0, v0, v180
  v_add_f32 v1, v1, v181
  v_lshlrev_b32 v180, 16, v25
  v_and_b32 v181, 0xffff0000, v25
  v_add_f32 v2, v2, v180
  v_add_f32 v3, v3, v181
  v_lshlrev_b32 v180, 16, v26
  v_and_b32 v181, 0xffff0000, v26
  v_add_f32 v8, v8, v180
  v_add_f32 v9, v9, v181
  v_lshlrev_b32 v180, 16, v27
  v_and_b32 v181, 0xffff0000, v27
  v_add_f32 v10, v10, v180
  v_add_f32 v11, v11, v181
  v_lshlrev_b32 v180, 16, v28
  v_and_b32 v181, 0xffff0000, v28
  v_add_f32 v4, v4, v180
  v_add_f32 v5, v5, v181
  v_lshlrev_b32 v180, 16, v29
  v_and_b32 v181, 0xffff0000, v29
  v_add_f32 v6, v6, v180
  v_add_f32 v7, v7, v181
  v_lshlrev_b32 v180, 16, v30
  v_and_b32 v181, 0xffff0000, v30
  v_add_f32 v12, v12, v180
  v_add_f32 v13, v13, v181
  v_lshlrev_b32 v180, 16, v31
  v_and_b32 v181, 0xffff0000, v31
  v_add_f32 v14, v14, v180
  v_add_f32 v15, v15, v181
  s_waitcnt vmcnt(0)
  v_lshlrev_b32 v180, 16, v32
  v_and_b32 v181, 0xffff0000, v32
  v_add_f32 v0, v0, v180
  v_add_f32 v1, v1, v181
  v_lshlrev_b32 v180, 16, v33
  v_and_b32 v181, 0xffff0000, v33
  v_add_f32 v2, v2, v180
  v_add_f32 v3, v3, v181
  v_lshlrev_b32 v180, 16, v34
  v_and_b32 v181, 0xffff0000, v34
  v_add_f32 v8, v8, v180
  v_add_f32 v9, v9, v181
  v_lshlrev_b32 v180, 16, v35
  v_and_b32 v181, 0xffff0000, v35
  v_add_f32 v10, v10, v180
  v_add_f32 v11, v11, v181
  v_lshlrev_b32 v180, 16, v36
  v_and_b32 v181, 0xffff0000, v36
  v_add_f32 v4, v4, v180
  v_add_f32 v5, v5, v181
  v_lshlrev_b32 v180, 16, v37
  v_and_b32 v181, 0xffff0000, v37
  v_add_f32 v6, v6, v180
  v_add_f32 v7, v7, v181
  v_lshlrev_b32 v180, 16, v38
  v_and_b32 v181, 0xffff0000, v38
  v_add_f32 v12, v12, v180
  v_add_f32 v13, v13, v181
  v_lshlrev_b32 v180, 16, v39
  v_and_b32 v181, 0xffff0000, v39
  v_add_f32 v14, v14, v180
  v_add_f32 v15, v15, v181
  v_cvt_pk_bf16_f32 v96, v0, v1
  v_cvt_pk_bf16_f32 v97, v2, v3
  v_cvt_pk_bf16_f32 v98, v8, v9
  v_cvt_pk_bf16_f32 v99, v10, v11
  v_cvt_pk_bf16_f32 v100, v4, v5
  v_cvt_pk_bf16_f32 v101, v6, v7
  v_cvt_pk_bf16_f32 v102, v12, v13
  v_cvt_pk_bf16_f32 v103, v14, v15
  s_lshl_b32 s45, s53, 6
  s_add_u32 s45, s45, s51
  buffer_store_dwordx2 v[96:97], v179, s[56:59], s45 offen offset:0
  buffer_store_dwordx2 v[98:99], v179, s[56:59], s45 offen offset:32
  buffer_store_dwordx2 v[100:101], v182, s[56:59], s45 offen offset:0
  buffer_store_dwordx2 v[102:103], v182, s[56:59], s45 offen offset:32
  s_cmp_eq_u32 s32, 3
  s_cbranch_scc0 K3_done
  s_cmp_ge_u32 s30, 2
  s_cbranch_scc0 K3_done
  s_sub_u32 s54, s55, 12
  s_waitcnt vmcnt(0)
  s_lshl_b32 s45, s54, 15
  s_add_u32 s45, s45, s48
  s_xor_b32 s46, s30, 1
  s_lshl_b32 s46, s46, 13
  s_add_u32 s46, s46, s45
  buffer_load_dwordx4 v[16:19], v164, s[12:15], s46 offen offset:0 sc1
  buffer_load_dwordx4 v[20:23], v164, s[12:15], s46 offen offset:1024 sc1
  s_xor_b32 s46, s30, 2
  s_lshl_b32 s46, s46, 13
  s_add_u32 s46, s46, s45
  buffer_load_dwordx4 v[24:27], v164, s[12:15], s46 offen offset:0 sc1
  buffer_load_dwordx4 v[28:31], v164, s[12:15], s46 offen offset:1024 sc1
  s_xor_b32 s46, s30, 3
  s_lshl_b32 s46, s46, 13
  s_add_u32 s46, s46, s45
  buffer_load_dwordx4 v[32:35], v164, s[12:15], s46 offen offset:0 sc1
  buffer_load_dwordx4 v[36:39], v164, s[12:15], s46 offen offset:1024 sc1
  s_waitcnt vmcnt(4)
  v_lshlrev_b32 v180, 16, v16
  v_and_b32 v181, 0xffff0000, v16
  v_add_f32 v224, v224, v180
  v_add_f32 v225, v225, v181
  v_lshlrev_b32 v180, 16, v17
  v_and_b32 v181, 0xffff0000, v17
  v_add_f32 v226, v226, v180
  v_add_f32 v227, v227, v181
  v_lshlrev_b32 v180, 16, v18
  v_and_b32 v181, 0xffff0000, v18
  v_add_f32 v232, v232, v180
  v_add_f32 v233, v233, v181
  v_lshlrev_b32 v180, 16, v19
  v_and_b32 v181, 0xffff0000, v19
  v_add_f32 v234, v234, v180
  v_add_f32 v235, v235, v181
  v_lshlrev_b32 v180, 16, v20
  v_and_b32 v181, 0xffff0000, v20
  v_add_f32 v228, v228, v180
  v_add_f32 v229, v229, v181
  v_lshlrev_b32 v180, 16, v21
  v_and_b32 v181, 0xffff0000, v21
  v_add_f32 v230, v230, v180
  v_add_f32 v231, v231, v181
  v_lshlrev_b32 v180, 16, v22
  v_and_b32 v181, 0xffff0000, v22
  v_add_f32 v236, v236, v180
  v_add_f32 v237, v237, v181
  v_lshlrev_b32 v180, 16, v23
  v_and_b32 v181, 0xffff0000, v23
  v_add_f32 v238, v238, v180
  v_add_f32 v239, v239, v181
  s_waitcnt vmcnt(2)
  v_lshlrev_b32 v180, 16, v24
  v_and_b32 v181, 0xffff0000, v24
  v_add_f32 v224, v224, v180
  v_add_f32 v225, v225, v181
  v_lshlrev_b32 v180, 16, v25
  v_and_b32 v181, 0xffff0000, v25
  v_add_f32 v226, v226, v180
  v_add_f32 v227, v227, v181
  v_lshlrev_b32 v180, 16, v26
  v_and_b32 v181, 0xffff0000, v26
  v_add_f32 v232, v232, v180
  v_add_f32 v233, v233, v181
  v_lshlrev_b32 v180, 16, v27
  v_and_b32 v181, 0xffff0000, v27
  v_add_f32 v234, v234, v180
  v_add_f32 v235, v235, v181
  v_lshlrev_b32 v180, 16, v28
  v_and_b32 v181, 0xffff0000, v28
  v_add_f32 v228, v228, v180
  v_add_f32 v229, v229, v181
  v_lshlrev_b32 v180, 16, v29
  v_and_b32 v181, 0xffff0000, v29
  v_add_f32 v230, v230, v180
  v_add_f32 v231, v231, v181
  v_lshlrev_b32 v180, 16, v30
  v_and_b32 v181, 0xffff0000, v30
  v_add_f32 v236, v236, v180
  v_add_f32 v237, v237, v181
  v_lshlrev_b32 v180, 16, v31
  v_and_b32 v181, 0xffff0000, v31
  v_add_f32 v238, v238, v180
  v_add_f32 v239, v239, v181
  s_waitcnt vmcnt(0)
  v_lshlrev_b32 v180, 16, v32
  v_and_b32 v181, 0xffff0000, v32
  v_add_f32 v224, v224, v180
  v_add_f32 v225, v225, v181
  v_lshlrev_b32 v180, 16, v33
  v_and_b32 v181, 0xffff0000, v33
  v_add_f32 v226, v226, v180
  v_add_f32 v227, v227, v181
  v_lshlrev_b32 v180, 16, v34
  v_and_b32 v181, 0xffff0000, v34
  v_add_f32 v232, v232, v180
  v_add_f32 v233, v233, v181
  v_lshlrev_b32 v180, 16, v35
  v_and_b32 v181, 0xffff0000, v35
  v_add_f32 v234, v234, v180
  v_add_f32 v235, v235, v181
  v_lshlrev_b32 v180, 16, v36
  v_and_b32 v181, 0xffff0000, v36
  v_add_f32 v228, v228, v180
  v_add_f32 v229, v229, v181
  v_lshlrev_b32 v180, 16, v37
  v_and_b32 v181, 0xffff0000, v37
  v_add_f32 v230, v230, v180
  v_add_f32 v231, v231, v181
  v_lshlrev_b32 v180, 16, v38
  v_and_b32 v181, 0xffff0000, v38
  v_add_f32 v236, v236, v180
  v_add_f32 v237, v237, v181
  v_lshlrev_b32 v180, 16, v39
  v_and_b32 v181, 0xffff0000, v39
  v_add_f32 v238, v238, v180
  v_add_f32 v239, v239, v181
  v_cvt_pk_bf16_f32 v104, v224, v225
  v_cvt_pk_bf16_f32 v105, v226, v227
  v_cvt_pk_bf16_f32 v106, v232, v233
  v_cvt_pk_bf16_f32 v107, v234, v235
  v_cvt_pk_bf16_f32 v108, v228, v229
  v_cvt_pk_bf16_f32 v109, v230, v231
  v_cvt_pk_bf16_f32 v110, v236, v237
  v_cvt_pk_bf16_f32 v111, v238, v239
  s_lshl_b32 s45, s55, 6
  s_add_u32 s45, s45, s51
  buffer_store_dwordx2 v[104:105], v179, s[56:59], s45 offen offset:0
  buffer_store_dwordx2 v[106:107], v179, s[56:59], s45 offen offset:32
  buffer_store_dwordx2 v[108:109], v182, s[56:59], s45 offen offset:0
  buffer_store_dwordx2 v[110:111], v182, s[56:59], s45 offen offset:32
K3_done:
MK_end:
  s_endpgm
.section .rodata,"a"
.p2align 6
.amdhsa_kernel sequential_preLN__linear_attn_block__glu_gated_bilinear__prompt_kernel
  .amdhsa_next_free_vgpr 512
  .amdhsa_next_free_sgpr 102
  .amdhsa_accum_offset 256
  .amdhsa_group_segment_fixed_size 0
  .amdhsa_kernarg_size 80
  .amdhsa_user_sgpr_count 2
  .amdhsa_user_sgpr_kernarg_segment_ptr 1
  .amdhsa_system_sgpr_workgroup_id_x 1
  .amdhsa_float_denorm_mode_32 3
  .amdhsa_float_denorm_mode_16_64 3
.end_amdhsa_kernel
```
